```python
import torch

def _softmax(x, axis=-1):
    return torch.softmax(x, dim=axis)
def _gelu(x):
    return torch.nn.functional.gelu(x, approximate="tanh")
def _silu(x):
    return torch.nn.functional.silu(x)
def _sigmoid(x):
    return torch.sigmoid(x)
def _layernorm(x, axis=-1, eps=1e-5):
    m = x.mean(dim=axis, keepdim=True)
    v = x.var(dim=axis, keepdim=True, unbiased=False)
    return (x - m) / torch.sqrt(v + eps)
def _scatter_add(tgt, idx, src, axis=0):
    return tgt.clone().index_add_(axis, idx, src)
def _segment_sum(src, seg, n):
    out = torch.zeros((n,) + src.shape[1:], dtype=src.dtype)
    return out.index_add_(0, seg, src)
def _pad(x, pw):
    flat = tuple(v for pair in reversed(pw) for v in pair)
    return torch.nn.functional.pad(x, flat)

kernel_name = 'concat_heads__ssm_conv_h3__compressed_kv_cla__prompt'

def setup_inputs():

    _w = (lambda a: (lambda t: t.to(torch.bfloat16) if t.is_floating_point() else t)(torch.as_tensor(a)))
    def _A_setup():
        B, S, D = 1, 2048, 576
        ks = 4
        return {
            "q": _w((lambda *s: torch.randn(*s, dtype=torch.bfloat16) * 0.05)(B, S, D)),
            "k": _w((lambda *s: torch.randn(*s, dtype=torch.bfloat16) * 0.1)(B, S, D)),
            "v": _w((lambda *s: torch.randn(*s, dtype=torch.bfloat16) * 0.1)(B, S, D)),
            "shift_k": _w((lambda *s: torch.randn(*s, dtype=torch.bfloat16) * 0.1)(D, ks) * 0.5),
            "ssm_k": _w((lambda *s: torch.randn(*s, dtype=torch.bfloat16) * 0.1)(D, S) * (1.0 / S ** 0.5)),
            "ssm_D": _w((lambda *s: torch.randn(*s, dtype=torch.bfloat16) * 0.1)(D)),
        }
    _A_in = _A_setup()

    def _B_setup():
        B, H, Sq, Sk, D, M = 1, 32, 2048, 2048, 128, 576
        Dc = 4 * D
        return {
            "x": _w((lambda *s: torch.randn(*s, dtype=torch.bfloat16) * 3.2)(B, Sq, M)),
            "c_kv": _w((lambda *s: torch.randn(*s, dtype=torch.bfloat16) * 0.05)(B, Sk, Dc)),
            "w_q": _w((lambda *s: torch.randn(*s, dtype=torch.bfloat16) * 3.2)(M, H, D) * (M ** -0.5)),
            "w_uk": _w((lambda *s: torch.randn(*s, dtype=torch.bfloat16) * 3.2)(Dc, H, D) * (Dc ** -0.5)),
            "w_uv": _w((lambda *s: torch.randn(*s, dtype=torch.bfloat16) * 0.05)(Dc, H, D) * (Dc ** -0.5)),
            "w_o": _w((lambda *s: torch.randn(*s, dtype=torch.bfloat16) * 0.05)(H, D, M) * ((H * D) ** -0.5)),
        }
    _B_in = _B_setup()

    return {
        "A_q": _A_in["q"],
        "A_k": _A_in["k"],
        "A_v": _A_in["v"],
        "A_shift_k": _A_in["shift_k"],
        "A_ssm_k": _A_in["ssm_k"],
        "A_ssm_D": _A_in["ssm_D"],
        "B_x": _B_in["x"],
        "B_c_kv": _B_in["c_kv"],
        "B_w_q": _B_in["w_q"],
        "B_w_uk": _B_in["w_uk"],
        "B_w_uv": _B_in["w_uv"],
        "B_w_o": _B_in["w_o"],
    }

def reference(A_q, A_k, A_v, A_shift_k, A_ssm_k, A_ssm_D, B_x, B_c_kv, B_w_q, B_w_uk, B_w_uv, B_w_o):
    def _A_ref(q, k, v, shift_k, ssm_k, ssm_D):
        B, S, D = q.shape
        ks = shift_k.shape[-1]
        k_pad = _pad(k, ((0, 0), (ks - 1, 0), (0, 0)))
        k_shift = torch.zeros_like(k)
        for t in range(ks):
            k_shift = k_shift + k_pad[:, t:t + S, :] * shift_k[:, ks - 1 - t][None, None, :]
        kv = k_shift * v
        L = 2 * S
        kv_pad = _pad(kv, ((0, 0), (0, S), (0, 0)))
        kf_pad = _pad(ssm_k, ((0, 0), (0, S)))
        kv_f = (lambda x, axes=(-2,-1): torch.fft.rfft2(x.float(), dim=axes))(kv_pad[:, None, :, :], axes=(1, 2))
        kf_f = (lambda x, axes=(-2,-1): torch.fft.rfft2(x.float(), dim=axes))(kf_pad[:, None, :], axes=(1, 2))
        kf_f = (lambda x, *d: x.permute(*d))(kf_f, 1, 2, 0)
        y_f = kv_f * kf_f[None, :, :, :]
        y = (lambda x, s, axes=(-2,-1): torch.fft.irfft2(x, s=s, dim=axes).to(torch.bfloat16))(y_f, (1, L), axes=(1, 2))[:, 0, :S, :]
        y = y + kv * ssm_D[None, None, :]
        return q * y

    def _B_ref(x, c_kv, w_q, w_uk, w_uv, w_o):
        B, Sq, M = x.shape[0], x.shape[1], x.shape[2]
        Sk = c_kv.shape[1]
        H, D = w_q.shape[1], w_q.shape[2]
        q = torch.einsum("bqm,mhd->bhqd", x, w_q)
        k = torch.einsum("bkc,chd->bhkd", c_kv, w_uk)
        v = torch.einsum("bkc,chd->bhkd", c_kv, w_uv)
        scores = torch.einsum("bhqd,bhkd->bhqk", q, k) * (D ** -0.5)
        off = Sk - Sq
        qi = torch.arange(Sq)[:, None]
        kj = torch.arange(Sk)[None, :]
        cmask = kj <= (qi + off)
        scores = torch.where(cmask[None, None], scores, -1e9)
        p = _softmax(scores, axis=-1)
        ctx = torch.einsum("bhqk,bhkd->bhqd", p, v)
        return torch.einsum("bhqd,hdm->bqm", ctx, w_o)

    a = _A_ref(A_q, A_k, A_v, A_shift_k, A_ssm_k, A_ssm_D)
    b = _B_ref(B_x, B_c_kv, B_w_q, B_w_uk, B_w_uv, B_w_o)
    return torch.concatenate([a, b], axis=-1)
```

```asm
; @launch grid=(256,1,1) block=(512,1,1) lds=163840
.amdgcn_target "amdgcn-amd-amdhsa--gfx950"
.text
.globl concat_heads__ssm_conv_h3__compressed_kv_cla__prompt_kernel
.p2align 8
.type concat_heads__ssm_conv_h3__compressed_kv_cla__prompt_kernel,@function
concat_heads__ssm_conv_h3__compressed_kv_cla__prompt_kernel:
    s_cmp_ge_u32 s2, 256
    s_cbranch_scc1 ka_kernel_end
    s_load_dwordx8 s[60:67], s[0:1], 48
    s_load_dwordx2 s[68:69], s[0:1], 80
    s_memrealtime s[70:71]
    s_load_dwordx4 s[4:7], s[0:1], 104
    v_lshrrev_b32 v19, 6, v0
    v_and_b32 v1, 63, v0
    v_readfirstlane_b32 s32, v19
    v_lshlrev_b32 v2, 4, v1
    s_and_b32 s37, s2, 7
    s_lshl_b32 s37, s37, 2
    s_lshr_b32 s38, s2, 3
    s_and_b32 s38, s38, 3
    s_add_u32 s33, s37, s38
    s_lshr_b32 s34, s2, 5
    s_lshr_b32 s35, s32, 2
    s_and_b32 s36, s32, 3
    s_lshl_b32 s37, s34, 8
    s_lshl_b32 s38, s32, 5
    s_add_u32 s37, s37, s38
    v_lshrrev_b32 v19, 3, v1
    v_add_u32 v19, s37, v19
    v_mul_u32_u24 v19, 1024, v19
    v_and_b32 v20, 7, v1
    v_lshrrev_b32 v21, 4, v1
    v_xor_b32 v22, v20, v21
    v_xor_b32 v23, 4, v22
    v_lshl_add_u32 v4, v22, 4, v19
    v_lshl_add_u32 v5, v23, 4, v19
    v_add_u32 v5, 7168, v5
    v_lshl_add_u32 v6, v22, 4, v19
    v_add_u32 v6, 14336, v6
    v_lshl_add_u32 v7, v23, 4, v19
    v_add_u32 v7, 21504, v7
    s_lshl_b32 s37, s36, 4
    s_lshl_b32 s38, s33, 8
    v_lshrrev_b32 v21, 4, v1
    v_add_u32 v19, s37, v21
    v_lshlrev_b32 v19, 13, v19
    v_add_u32 v19, s38, v19
    v_and_b32 v20, 15, v1
    v_lshlrev_b32 v22, 1, v21
    v_xor_b32 v20, v20, v22
    v_xor_b32 v22, 8, v20
    v_lshl_add_u32 v8, v20, 4, v19
    v_lshl_add_u32 v9, v20, 4, v19
    v_add_u32 v9, 31744, v9
    v_lshl_add_u32 v10, v22, 4, v19
    v_add_u32 v10, 63488, v10
    v_lshl_add_u32 v11, v22, 4, v19
    v_add_u32 v11, 95232, v11
    s_lshl_b32 s43, s32, 12
    s_add_u32 s44, s43, 32768
    s_mov_b32 s41, 0
    s_mov_b32 s42, 0
    s_waitcnt lgkmcnt(0)
    s_mov_b32 s8, s62
    s_and_b32 s9, s63, 0xffff
    s_mov_b32 s10, 2097152
    s_mov_b32 s11, 0x20000
    s_cmp_lt_u32 s32, 4
    s_cselect_b32 s46, s66, s68
    s_cselect_b32 s47, s67, s69
    s_mov_b32 s12, s46
    s_and_b32 s13, s47, 0xffff
    s_mov_b32 s14, 4194304
    s_mov_b32 s15, 0x20000
    s_mov_b32 m0, s43
    s_nop 0
    buffer_load_dwordx4 v4, s[8:11], s41 offen offset:0 lds
    buffer_load_dwordx4 v5, s[8:11], s41 offen offset:1024 lds
    buffer_load_dwordx4 v6, s[8:11], s41 offen offset:2048 lds
    buffer_load_dwordx4 v7, s[8:11], s41 offen offset:3072 lds
    s_mov_b32 m0, s44
    s_nop 0
    buffer_load_dwordx4 v8, s[12:15], s42 offen offset:0 lds
    buffer_load_dwordx4 v9, s[12:15], s42 offen offset:1024 lds
    buffer_load_dwordx4 v10, s[12:15], s42 offen offset:2048 lds
    buffer_load_dwordx4 v11, s[12:15], s42 offen offset:3072 lds
    s_add_u32 s41, s41, 128
    s_add_u32 s42, s42, 524288
    s_xor_b32 s43, s43, 0x10000
    s_xor_b32 s44, s44, 0x10000
    s_add_u32 s16, s6, 0
    s_addc_u32 s17, s7, 0
    s_mov_b32 s16, s16
    s_and_b32 s17, s17, 0xffff
    s_mov_b32 s18, 33554432
    s_mov_b32 s19, 0x20000
    s_mov_b32 s20, s60
    s_and_b32 s21, s61, 0xffff
    s_mov_b32 s22, 2359296
    s_mov_b32 s23, 0x20000
    s_mov_b32 s24, s64
    s_and_b32 s25, s65, 0xffff
    s_mov_b32 s26, 4718592
    s_mov_b32 s27, 0x20000
    s_mov_b32 s28, s68
    s_and_b32 s29, s69, 0xffff
    s_mov_b32 s30, 4194304
    s_mov_b32 s31, 0x20000
    s_mov_b32 s72, s4
    s_and_b32 s73, s5, 0xffff
    s_mov_b32 s74, 256
    s_mov_b32 s75, 0x20000
    s_and_b32 s37, s32, 1
    s_lshl_b32 s37, s37, 14
    v_and_b32 v19, 15, v1
    v_lshrrev_b32 v20, 4, v1
    v_bfe_u32 v21, v1, 1, 3
    v_xor_b32 v21, v21, v20
    v_lshlrev_b32 v19, 7, v19
    v_add_u32 v19, s37, v19
    v_lshl_add_u32 v12, v21, 4, v19
    v_xor_b32 v21, 4, v21
    v_lshl_add_u32 v13, v21, 4, v19
    s_lshl_b32 s37, s35, 14
    s_add_u32 s37, s37, 32768
    s_and_b32 s38, s32, 2
    s_lshl_b32 s38, s38, 1
    v_bfe_u32 v19, v1, 2, 2
    v_lshrrev_b32 v20, 4, v1
    v_lshl_add_u32 v21, v20, 3, v19
    v_lshlrev_b32 v21, 8, v21
    v_and_b32 v22, 3, v1
    v_lshl_add_u32 v21, v22, 3, v21
    v_add_u32 v21, s37, v21
    v_and_b32 v20, 1, v20
    v_lshl_or_b32 v19, v20, 2, v19
    s_add_u32 s39, s38, 0
    v_xor_b32 v20, s39, v19
    v_lshl_add_u32 v14, v20, 5, v21
    s_add_u32 s39, s38, 1
    v_xor_b32 v20, s39, v19
    v_lshl_add_u32 v15, v20, 5, v21
    s_add_u32 s39, s38, 2
    v_xor_b32 v20, s39, v19
    v_lshl_add_u32 v16, v20, 5, v21
    s_add_u32 s39, s38, 3
    v_xor_b32 v20, s39, v19
    v_lshl_add_u32 v17, v20, 5, v21
    s_lshl_b32 s37, s33, 20
    s_lshl_b32 s38, s34, 17
    s_add_u32 s37, s37, s38
    s_and_b32 s38, s32, 1
    s_lshl_b32 s38, s38, 16
    s_add_u32 s37, s37, s38
    v_add_u32 v18, s37, v2
    s_sub_u32 s37, 15, s34
    s_cmp_eq_u32 s35, 0
    s_cselect_b32 s37, s37, s34
    s_lshl_b32 s37, s37, 7
    s_lshl_b32 s38, s36, 5
    s_add_u32 s37, s37, s38
    v_lshrrev_b32 v19, 3, v1
    v_add_u32 v19, s37, v19
    v_mul_u32_u24 v19, 1152, v19
    v_and_b32 v20, 7, v1
    v_lshrrev_b32 v21, 4, v1
    v_xor_b32 v22, v20, v21
    v_xor_b32 v23, 4, v22
    v_lshl_add_u32 v28, v22, 4, v19
    v_lshl_add_u32 v29, v23, 4, v19
    v_add_u32 v29, 8192, v29
    v_lshl_add_u32 v30, v22, 4, v19
    v_add_u32 v30, 16384, v30
    v_lshl_add_u32 v31, v23, 4, v19
    v_add_u32 v31, 24576, v31
    v_lshrrev_b32 v21, 4, v1
    s_lshl_b32 s37, s32, 3
    v_add_u32 v19, s37, v21
    v_lshlrev_b32 v19, 13, v19
    s_lshl_b32 s38, s33, 8
    v_add_u32 v19, s38, v19
    v_and_b32 v20, 15, v1
    v_lshlrev_b32 v22, 1, v21
    v_xor_b32 v20, v20, v22
    s_and_b32 s37, s32, 1
    s_lshl_b32 s37, s37, 3
    v_xor_b32 v20, s37, v20
    v_lshl_add_u32 v124, v20, 4, v19
    v_add_u32 v125, 31744, v124
    v_mov_b32 v128, 0
    v_mov_b32 v129, 0
    v_mov_b32 v130, 0
    v_mov_b32 v131, 0
    v_mov_b32 v132, 0
    v_mov_b32 v133, 0
    v_mov_b32 v134, 0
    v_mov_b32 v135, 0
    v_mov_b32 v136, 0
    v_mov_b32 v137, 0
    v_mov_b32 v138, 0
    v_mov_b32 v139, 0
    v_mov_b32 v140, 0
    v_mov_b32 v141, 0
    v_mov_b32 v142, 0
    v_mov_b32 v143, 0
    v_mov_b32 v144, 0
    v_mov_b32 v145, 0
    v_mov_b32 v146, 0
    v_mov_b32 v147, 0
    v_mov_b32 v148, 0
    v_mov_b32 v149, 0
    v_mov_b32 v150, 0
    v_mov_b32 v151, 0
    v_mov_b32 v152, 0
    v_mov_b32 v153, 0
    v_mov_b32 v154, 0
    v_mov_b32 v155, 0
    v_mov_b32 v156, 0
    v_mov_b32 v157, 0
    v_mov_b32 v158, 0
    v_mov_b32 v159, 0
    v_mov_b32 v160, 0
    v_mov_b32 v161, 0
    v_mov_b32 v162, 0
    v_mov_b32 v163, 0
    v_mov_b32 v164, 0
    v_mov_b32 v165, 0
    v_mov_b32 v166, 0
    v_mov_b32 v167, 0
    v_mov_b32 v168, 0
    v_mov_b32 v169, 0
    v_mov_b32 v170, 0
    v_mov_b32 v171, 0
    v_mov_b32 v172, 0
    v_mov_b32 v173, 0
    v_mov_b32 v174, 0
    v_mov_b32 v175, 0
    v_mov_b32 v176, 0
    v_mov_b32 v177, 0
    v_mov_b32 v178, 0
    v_mov_b32 v179, 0
    v_mov_b32 v180, 0
    v_mov_b32 v181, 0
    v_mov_b32 v182, 0
    v_mov_b32 v183, 0
    v_mov_b32 v184, 0
    v_mov_b32 v185, 0
    v_mov_b32 v186, 0
    v_mov_b32 v187, 0
    v_mov_b32 v188, 0
    v_mov_b32 v189, 0
    v_mov_b32 v190, 0
    v_mov_b32 v191, 0
    v_mov_b32 v192, 0
    v_mov_b32 v193, 0
    v_mov_b32 v194, 0
    v_mov_b32 v195, 0
    v_mov_b32 v196, 0
    v_mov_b32 v197, 0
    v_mov_b32 v198, 0
    v_mov_b32 v199, 0
    v_mov_b32 v200, 0
    v_mov_b32 v201, 0
    v_mov_b32 v202, 0
    v_mov_b32 v203, 0
    v_mov_b32 v204, 0
    v_mov_b32 v205, 0
    v_mov_b32 v206, 0
    v_mov_b32 v207, 0
    v_mov_b32 v208, 0
    v_mov_b32 v209, 0
    v_mov_b32 v210, 0
    v_mov_b32 v211, 0
    v_mov_b32 v212, 0
    v_mov_b32 v213, 0
    v_mov_b32 v214, 0
    v_mov_b32 v215, 0
    v_mov_b32 v216, 0
    v_mov_b32 v217, 0
    v_mov_b32 v218, 0
    v_mov_b32 v219, 0
    v_mov_b32 v220, 0
    v_mov_b32 v221, 0
    v_mov_b32 v222, 0
    v_mov_b32 v223, 0
    v_mov_b32 v224, 0
    v_mov_b32 v225, 0
    v_mov_b32 v226, 0
    v_mov_b32 v227, 0
    v_mov_b32 v228, 0
    v_mov_b32 v229, 0
    v_mov_b32 v230, 0
    v_mov_b32 v231, 0
    v_mov_b32 v232, 0
    v_mov_b32 v233, 0
    v_mov_b32 v234, 0
    v_mov_b32 v235, 0
    v_mov_b32 v236, 0
    v_mov_b32 v237, 0
    v_mov_b32 v238, 0
    v_mov_b32 v239, 0
    v_mov_b32 v240, 0
    v_mov_b32 v241, 0
    v_mov_b32 v242, 0
    v_mov_b32 v243, 0
    v_mov_b32 v244, 0
    v_mov_b32 v245, 0
    v_mov_b32 v246, 0
    v_mov_b32 v247, 0
    v_mov_b32 v248, 0
    v_mov_b32 v249, 0
    v_mov_b32 v250, 0
    v_mov_b32 v251, 0
    v_mov_b32 v252, 0
    v_mov_b32 v253, 0
    v_mov_b32 v254, 0
    v_mov_b32 v255, 0
    s_cmp_lt_u32 s32, 4
    s_cbranch_scc0 ka_kernel_vp0
    s_mov_b32 m0, s43
    s_add_u32 s45, s41, 131072
    buffer_load_dwordx4 v4, s[8:11], s41 offen offset:0 lds
    buffer_load_dwordx4 v5, s[8:11], s41 offen offset:1024 lds
    buffer_load_dwordx4 v6, s[8:11], s41 offen offset:2048 lds
    buffer_load_dwordx4 v7, s[8:11], s41 offen offset:3072 lds
    s_mov_b32 m0, s44
    s_nop 0
    buffer_load_dwordx4 v8, s[12:15], s42 offen offset:0 lds
    buffer_load_dwordx4 v9, s[12:15], s42 offen offset:1024 lds
    buffer_load_dwordx4 v10, s[12:15], s42 offen offset:2048 lds
    buffer_load_dwordx4 v11, s[12:15], s42 offen offset:3072 lds
    s_add_u32 m0, s43, 16384
    s_nop 0
    buffer_load_dwordx4 v4, s[8:11], s45 offen offset:0 lds
    buffer_load_dwordx4 v5, s[8:11], s45 offen offset:1024 lds
    buffer_load_dwordx4 v6, s[8:11], s45 offen offset:2048 lds
    buffer_load_dwordx4 v7, s[8:11], s45 offen offset:3072 lds
    s_add_u32 m0, s44, 16384
    s_nop 0
    buffer_load_dwordx4 v8, s[28:31], s42 offen offset:0 lds
    buffer_load_dwordx4 v9, s[28:31], s42 offen offset:1024 lds
    buffer_load_dwordx4 v10, s[28:31], s42 offen offset:2048 lds
    buffer_load_dwordx4 v11, s[28:31], s42 offen offset:3072 lds
    s_add_u32 s41, s41, 128
    s_add_u32 s42, s42, 524288
    s_xor_b32 s43, s43, 0x10000
    s_xor_b32 s44, s44, 0x10000
    s_branch ka_kernel_nop0
ka_kernel_vp0:
    s_lshr_b32 s3, s2, 3
    s_lshl_b32 s37, s36, 5
    s_add_u32 s3, s3, s37
    s_and_b32 s59, s2, 7
    s_lshl_b32 s59, s59, 10
    s_mov_b32 s46, s6
    s_mov_b32 s47, s7
    s_mov_b32 s37, 209715200
    s_mov_b32 s48, 1024
    s_sub_u32 s38, s3, 0
    s_lshl_b32 s39, s38, 13
    s_mul_i32 s58, s59, 256
    s_add_u32 s39, s39, s58
    s_cmp_lt_u32 s38, 32
    s_cselect_b32 s37, s39, s37
    s_cselect_b32 s46, s62, s46
    s_cselect_b32 s47, s63, s47
    s_sub_u32 s38, s3, 32
    s_lshl_b32 s39, s38, 16
    s_add_u32 s39, s39, 524288
    s_add_u32 s39, s39, s59
    s_cmp_lt_u32 s38, 16
    s_cselect_b32 s37, s39, s37
    s_cselect_b32 s46, s66, s46
    s_cselect_b32 s47, s67, s47
    s_cselect_b32 s48, 8192, s48
    s_sub_u32 s38, s3, 48
    s_lshl_b32 s39, s38, 16
    s_add_u32 s39, s39, 524288
    s_add_u32 s39, s39, s59
    s_cmp_lt_u32 s38, 16
    s_cselect_b32 s37, s39, s37
    s_cselect_b32 s46, s68, s46
    s_cselect_b32 s47, s69, s47
    s_cselect_b32 s48, 8192, s48
    s_add_u32 s46, s46, s37
    s_addc_u32 s47, s47, 0
    v_lshrrev_b32 v19, 3, v1
    v_and_b32 v20, 7, v1
    v_lshlrev_b32 v20, 7, v20
    v_mad_u32_u24 v19, v19, s48, v20
    global_load_dword v3, v19, s[46:47]
ka_kernel_tsk_1:
    s_getpc_b64 s[28:29]
ka_kernel_pc:
    s_sub_u32 s28, s28, ka_kernel_pc - concat_heads__ssm_conv_h3__compressed_kv_cla__prompt_kernel
    s_subb_u32 s29, s29, 0
    s_and_b32 s29, s29, 0xffff
    s_mov_b32 s30, ka_kernel_code_end - concat_heads__ssm_conv_h3__compressed_kv_cla__prompt_kernel
    s_mov_b32 s31, 0x20000
    s_sub_u32 s37, s3, 88
    s_lshl_b32 s37, s37, 13
    s_min_u32 s37, s37, 2146435072
    v_lshlrev_b32 v19, 7, v1
    buffer_load_dword v3, v19, s[28:31], s37 offen
    s_or_b32 s70, s70, 1
    v_mov_b32 v126, s70
    v_mov_b32 v127, 0
    v_mov_b32 v19, 0
    s_cmp_eq_u32 s32, 7
    s_cselect_b32 s37, 0, 2146435072
    s_mov_b64 exec, 1
    buffer_atomic_cmpswap v[126:127], v19, s[72:75], s37 offen sc0 sc1
    s_mov_b64 exec, -1
ka_kernel_nop0:
    s_cmp_lt_u32 s32, 4
    s_cbranch_scc1 ka_kernel_w3
    s_waitcnt vmcnt(3)
ka_kernel_w3:
    s_waitcnt vmcnt(16)
    s_barrier
    ds_read_b64_tr_b16 v[48:49], v14 offset:0
    ds_read_b64_tr_b16 v[50:51], v14 offset:1024
    ds_read_b64_tr_b16 v[52:53], v15 offset:0
    ds_read_b64_tr_b16 v[54:55], v15 offset:1024
    ds_read_b64_tr_b16 v[56:57], v16 offset:0
    ds_read_b64_tr_b16 v[58:59], v16 offset:1024
    ds_read_b64_tr_b16 v[60:61], v17 offset:0
    ds_read_b64_tr_b16 v[62:63], v17 offset:1024
    ds_read_b128 v[32:35], v12 offset:0
    ds_read_b128 v[36:39], v12 offset:2048
    ds_read_b128 v[40:43], v12 offset:4096
    s_mov_b32 s40, 0
    s_cmp_lt_u32 s32, 4
    s_cbranch_scc0 ka_kernel_vfirst
ka_kernel_kfirst:
    s_waitcnt lgkmcnt(2)
    v_mfma_f32_16x16x32_bf16 v[128:131], v[48:51], v[32:35], v[128:131]
    ds_read_b64_tr_b16 v[64:65], v14 offset:8192
    v_mfma_f32_16x16x32_bf16 v[132:135], v[52:55], v[32:35], v[132:135]
    v_mfma_f32_16x16x32_bf16 v[136:139], v[56:59], v[32:35], v[136:139]
    ds_read_b64_tr_b16 v[66:67], v14 offset:9216
    v_mfma_f32_16x16x32_bf16 v[140:143], v[60:63], v[32:35], v[140:143]
    ds_read_b128 v[44:47], v12 offset:6144
    s_waitcnt lgkmcnt(4)
    v_mfma_f32_16x16x32_bf16 v[144:147], v[48:51], v[36:39], v[144:147]
    ds_read_b64_tr_b16 v[68:69], v15 offset:8192
    v_mfma_f32_16x16x32_bf16 v[148:151], v[52:55], v[36:39], v[148:151]
    v_mfma_f32_16x16x32_bf16 v[152:155], v[56:59], v[36:39], v[152:155]
    ds_read_b64_tr_b16 v[70:71], v15 offset:9216
    v_mfma_f32_16x16x32_bf16 v[156:159], v[60:63], v[36:39], v[156:159]
    ds_read_b128 v[32:35], v12 offset:8192
    s_waitcnt lgkmcnt(6)
    v_mfma_f32_16x16x32_bf16 v[160:163], v[48:51], v[40:43], v[160:163]
    ds_read_b64_tr_b16 v[72:73], v16 offset:8192
    v_mfma_f32_16x16x32_bf16 v[164:167], v[52:55], v[40:43], v[164:167]
    v_mfma_f32_16x16x32_bf16 v[168:171], v[56:59], v[40:43], v[168:171]
    ds_read_b64_tr_b16 v[74:75], v16 offset:9216
    v_mfma_f32_16x16x32_bf16 v[172:175], v[60:63], v[40:43], v[172:175]
    ds_read_b128 v[36:39], v12 offset:10240
    s_waitcnt lgkmcnt(6)
    v_mfma_f32_16x16x32_bf16 v[176:179], v[48:51], v[44:47], v[176:179]
    ds_read_b64_tr_b16 v[76:77], v17 offset:8192
    v_mfma_f32_16x16x32_bf16 v[180:183], v[52:55], v[44:47], v[180:183]
    v_mfma_f32_16x16x32_bf16 v[184:187], v[56:59], v[44:47], v[184:187]
    ds_read_b64_tr_b16 v[78:79], v17 offset:9216
    v_mfma_f32_16x16x32_bf16 v[188:191], v[60:63], v[44:47], v[188:191]
    ds_read_b128 v[40:43], v12 offset:12288
    s_waitcnt lgkmcnt(6)
    v_mfma_f32_16x16x32_bf16 v[192:195], v[48:51], v[32:35], v[192:195]
    v_mfma_f32_16x16x32_bf16 v[196:199], v[52:55], v[32:35], v[196:199]
    v_mfma_f32_16x16x32_bf16 v[200:203], v[56:59], v[32:35], v[200:203]
    v_mfma_f32_16x16x32_bf16 v[204:207], v[60:63], v[32:35], v[204:207]
    ds_read_b128 v[44:47], v12 offset:14336
    s_waitcnt lgkmcnt(4)
    v_mfma_f32_16x16x32_bf16 v[208:211], v[48:51], v[36:39], v[208:211]
    v_mfma_f32_16x16x32_bf16 v[212:215], v[52:55], v[36:39], v[212:215]
    v_mfma_f32_16x16x32_bf16 v[216:219], v[56:59], v[36:39], v[216:219]
    v_mfma_f32_16x16x32_bf16 v[220:223], v[60:63], v[36:39], v[220:223]
    ds_read_b128 v[32:35], v13 offset:0
    s_waitcnt lgkmcnt(2)
    v_mfma_f32_16x16x32_bf16 v[224:227], v[48:51], v[40:43], v[224:227]
    v_mfma_f32_16x16x32_bf16 v[228:231], v[52:55], v[40:43], v[228:231]
    v_mfma_f32_16x16x32_bf16 v[232:235], v[56:59], v[40:43], v[232:235]
    v_mfma_f32_16x16x32_bf16 v[236:239], v[60:63], v[40:43], v[236:239]
    ds_read_b128 v[36:39], v13 offset:2048
    s_waitcnt lgkmcnt(2)
    v_mfma_f32_16x16x32_bf16 v[240:243], v[48:51], v[44:47], v[240:243]
    v_mfma_f32_16x16x32_bf16 v[244:247], v[52:55], v[44:47], v[244:247]
    v_mfma_f32_16x16x32_bf16 v[248:251], v[56:59], v[44:47], v[248:251]
    v_mfma_f32_16x16x32_bf16 v[252:255], v[60:63], v[44:47], v[252:255]
    ds_read_b128 v[40:43], v13 offset:4096
    s_waitcnt lgkmcnt(2)
    v_mfma_f32_16x16x32_bf16 v[128:131], v[64:67], v[32:35], v[128:131]
    v_mfma_f32_16x16x32_bf16 v[132:135], v[68:71], v[32:35], v[132:135]
    v_mfma_f32_16x16x32_bf16 v[136:139], v[72:75], v[32:35], v[136:139]
    v_mfma_f32_16x16x32_bf16 v[140:143], v[76:79], v[32:35], v[140:143]
    ds_read_b128 v[44:47], v13 offset:6144
    s_waitcnt lgkmcnt(2)
    v_mfma_f32_16x16x32_bf16 v[144:147], v[64:67], v[36:39], v[144:147]
    v_mfma_f32_16x16x32_bf16 v[148:151], v[68:71], v[36:39], v[148:151]
    v_mfma_f32_16x16x32_bf16 v[152:155], v[72:75], v[36:39], v[152:155]
    v_mfma_f32_16x16x32_bf16 v[156:159], v[76:79], v[36:39], v[156:159]
    ds_read_b128 v[32:35], v13 offset:8192
    s_waitcnt lgkmcnt(2)
    v_mfma_f32_16x16x32_bf16 v[160:163], v[64:67], v[40:43], v[160:163]
    v_mfma_f32_16x16x32_bf16 v[164:167], v[68:71], v[40:43], v[164:167]
    v_mfma_f32_16x16x32_bf16 v[168:171], v[72:75], v[40:43], v[168:171]
    v_mfma_f32_16x16x32_bf16 v[172:175], v[76:79], v[40:43], v[172:175]
    ds_read_b128 v[36:39], v13 offset:10240
    s_waitcnt lgkmcnt(2)
    v_mfma_f32_16x16x32_bf16 v[176:179], v[64:67], v[44:47], v[176:179]
    v_mfma_f32_16x16x32_bf16 v[180:183], v[68:71], v[44:47], v[180:183]
    v_mfma_f32_16x16x32_bf16 v[184:187], v[72:75], v[44:47], v[184:187]
    v_mfma_f32_16x16x32_bf16 v[188:191], v[76:79], v[44:47], v[188:191]
    ds_read_b128 v[40:43], v13 offset:12288
    s_waitcnt lgkmcnt(2)
    v_mfma_f32_16x16x32_bf16 v[192:195], v[64:67], v[32:35], v[192:195]
    v_mfma_f32_16x16x32_bf16 v[196:199], v[68:71], v[32:35], v[196:199]
    v_mfma_f32_16x16x32_bf16 v[200:203], v[72:75], v[32:35], v[200:203]
    v_mfma_f32_16x16x32_bf16 v[204:207], v[76:79], v[32:35], v[204:207]
    ds_read_b128 v[44:47], v13 offset:14336
    s_waitcnt lgkmcnt(2)
    v_mfma_f32_16x16x32_bf16 v[208:211], v[64:67], v[36:39], v[208:211]
    v_mfma_f32_16x16x32_bf16 v[212:215], v[68:71], v[36:39], v[212:215]
    v_mfma_f32_16x16x32_bf16 v[216:219], v[72:75], v[36:39], v[216:219]
    v_mfma_f32_16x16x32_bf16 v[220:223], v[76:79], v[36:39], v[220:223]
    s_waitcnt lgkmcnt(0) vmcnt(0)
    s_barrier
    v_xor_b32 v12, 0x10000, v12
    v_xor_b32 v13, 0x10000, v13
    v_xor_b32 v14, 0x10000, v14
    v_xor_b32 v15, 0x10000, v15
    v_xor_b32 v16, 0x10000, v16
    v_xor_b32 v17, 0x10000, v17
    v_mfma_f32_16x16x32_bf16 v[224:227], v[64:67], v[40:43], v[224:227]
    ds_read_b64_tr_b16 v[48:49], v14 offset:0
    ds_read_b64_tr_b16 v[50:51], v14 offset:1024
    v_mfma_f32_16x16x32_bf16 v[228:231], v[68:71], v[40:43], v[228:231]
    ds_read_b64_tr_b16 v[52:53], v15 offset:0
    ds_read_b64_tr_b16 v[54:55], v15 offset:1024
    v_mfma_f32_16x16x32_bf16 v[232:235], v[72:75], v[40:43], v[232:235]
    ds_read_b64_tr_b16 v[56:57], v16 offset:0
    ds_read_b64_tr_b16 v[58:59], v16 offset:1024
    v_mfma_f32_16x16x32_bf16 v[236:239], v[76:79], v[40:43], v[236:239]
    ds_read_b64_tr_b16 v[60:61], v17 offset:0
    ds_read_b64_tr_b16 v[62:63], v17 offset:1024
    ds_read_b128 v[32:35], v12 offset:0
    ds_read_b128 v[36:39], v12 offset:2048
    v_mfma_f32_16x16x32_bf16 v[240:243], v[64:67], v[44:47], v[240:243]
    v_mfma_f32_16x16x32_bf16 v[244:247], v[68:71], v[44:47], v[244:247]
    v_mfma_f32_16x16x32_bf16 v[248:251], v[72:75], v[44:47], v[248:251]
    v_mfma_f32_16x16x32_bf16 v[252:255], v[76:79], v[44:47], v[252:255]
    ds_read_b128 v[40:43], v12 offset:4096
    s_mov_b32 s40, 1
ka_kernel_kloop:
    s_waitcnt lgkmcnt(2)
    v_mfma_f32_16x16x32_bf16 v[128:131], v[48:51], v[32:35], v[128:131]
    ds_read_b64_tr_b16 v[64:65], v14 offset:8192
    v_mfma_f32_16x16x32_bf16 v[132:135], v[52:55], v[32:35], v[132:135]
    s_mov_b32 m0, s43
    s_add_u32 s45, s41, 131072
    buffer_load_dwordx4 v4, s[8:11], s41 offen offset:0 lds
    v_mfma_f32_16x16x32_bf16 v[136:139], v[56:59], v[32:35], v[136:139]
    ds_read_b64_tr_b16 v[66:67], v14 offset:9216
    v_mfma_f32_16x16x32_bf16 v[140:143], v[60:63], v[32:35], v[140:143]
    ds_read_b128 v[44:47], v12 offset:6144
    s_waitcnt lgkmcnt(4)
    v_mfma_f32_16x16x32_bf16 v[144:147], v[48:51], v[36:39], v[144:147]
    ds_read_b64_tr_b16 v[68:69], v15 offset:8192
    v_mfma_f32_16x16x32_bf16 v[148:151], v[52:55], v[36:39], v[148:151]
    buffer_load_dwordx4 v5, s[8:11], s41 offen offset:1024 lds
    buffer_load_dwordx4 v6, s[8:11], s41 offen offset:2048 lds
    buffer_load_dwordx4 v7, s[8:11], s41 offen offset:3072 lds
    s_mov_b32 m0, s44
    v_mfma_f32_16x16x32_bf16 v[152:155], v[56:59], v[36:39], v[152:155]
    ds_read_b64_tr_b16 v[70:71], v15 offset:9216
    v_mfma_f32_16x16x32_bf16 v[156:159], v[60:63], v[36:39], v[156:159]
    ds_read_b128 v[32:35], v12 offset:8192
    s_waitcnt lgkmcnt(6)
    v_mfma_f32_16x16x32_bf16 v[160:163], v[48:51], v[40:43], v[160:163]
    ds_read_b64_tr_b16 v[72:73], v16 offset:8192
    v_mfma_f32_16x16x32_bf16 v[164:167], v[52:55], v[40:43], v[164:167]
    s_nop 0
    buffer_load_dwordx4 v8, s[12:15], s42 offen offset:0 lds
    buffer_load_dwordx4 v9, s[12:15], s42 offen offset:1024 lds
    v_mfma_f32_16x16x32_bf16 v[168:171], v[56:59], v[40:43], v[168:171]
    ds_read_b64_tr_b16 v[74:75], v16 offset:9216
    v_mfma_f32_16x16x32_bf16 v[172:175], v[60:63], v[40:43], v[172:175]
    ds_read_b128 v[36:39], v12 offset:10240
    s_waitcnt lgkmcnt(6)
    v_mfma_f32_16x16x32_bf16 v[176:179], v[48:51], v[44:47], v[176:179]
    ds_read_b64_tr_b16 v[76:77], v17 offset:8192
    v_mfma_f32_16x16x32_bf16 v[180:183], v[52:55], v[44:47], v[180:183]
    buffer_load_dwordx4 v10, s[12:15], s42 offen offset:2048 lds
    buffer_load_dwordx4 v11, s[12:15], s42 offen offset:3072 lds
    s_add_u32 m0, s43, 16384
    s_nop 0
    v_mfma_f32_16x16x32_bf16 v[184:187], v[56:59], v[44:47], v[184:187]
    ds_read_b64_tr_b16 v[78:79], v17 offset:9216
    v_mfma_f32_16x16x32_bf16 v[188:191], v[60:63], v[44:47], v[188:191]
    ds_read_b128 v[40:43], v12 offset:12288
    s_waitcnt lgkmcnt(6)
    v_mfma_f32_16x16x32_bf16 v[192:195], v[48:51], v[32:35], v[192:195]
    v_mfma_f32_16x16x32_bf16 v[196:199], v[52:55], v[32:35], v[196:199]
    buffer_load_dwordx4 v4, s[8:11], s45 offen offset:0 lds
    buffer_load_dwordx4 v5, s[8:11], s45 offen offset:1024 lds
    buffer_load_dwordx4 v6, s[8:11], s45 offen offset:2048 lds
    v_mfma_f32_16x16x32_bf16 v[200:203], v[56:59], v[32:35], v[200:203]
    v_mfma_f32_16x16x32_bf16 v[204:207], v[60:63], v[32:35], v[204:207]
    ds_read_b128 v[44:47], v12 offset:14336
    s_waitcnt lgkmcnt(4)
    v_mfma_f32_16x16x32_bf16 v[208:211], v[48:51], v[36:39], v[208:211]
    v_mfma_f32_16x16x32_bf16 v[212:215], v[52:55], v[36:39], v[212:215]
    buffer_load_dwordx4 v7, s[8:11], s45 offen offset:3072 lds
    s_add_u32 m0, s44, 16384
    s_nop 0
    buffer_load_dwordx4 v8, s[28:31], s42 offen offset:0 lds
    v_mfma_f32_16x16x32_bf16 v[216:219], v[56:59], v[36:39], v[216:219]
    v_mfma_f32_16x16x32_bf16 v[220:223], v[60:63], v[36:39], v[220:223]
    ds_read_b128 v[32:35], v13 offset:0
    s_waitcnt lgkmcnt(2)
    v_mfma_f32_16x16x32_bf16 v[224:227], v[48:51], v[40:43], v[224:227]
    v_mfma_f32_16x16x32_bf16 v[228:231], v[52:55], v[40:43], v[228:231]
    buffer_load_dwordx4 v9, s[28:31], s42 offen offset:1024 lds
    buffer_load_dwordx4 v10, s[28:31], s42 offen offset:2048 lds
    buffer_load_dwordx4 v11, s[28:31], s42 offen offset:3072 lds
    v_mfma_f32_16x16x32_bf16 v[232:235], v[56:59], v[40:43], v[232:235]
    v_mfma_f32_16x16x32_bf16 v[236:239], v[60:63], v[40:43], v[236:239]
    ds_read_b128 v[36:39], v13 offset:2048
    s_waitcnt lgkmcnt(2)
    v_mfma_f32_16x16x32_bf16 v[240:243], v[48:51], v[44:47], v[240:243]
    v_mfma_f32_16x16x32_bf16 v[244:247], v[52:55], v[44:47], v[244:247]
    s_add_u32 s41, s41, 128
    s_add_u32 s42, s42, 524288
    s_xor_b32 s43, s43, 0x10000
    s_xor_b32 s44, s44, 0x10000
    v_mfma_f32_16x16x32_bf16 v[248:251], v[56:59], v[44:47], v[248:251]
    v_mfma_f32_16x16x32_bf16 v[252:255], v[60:63], v[44:47], v[252:255]
    ds_read_b128 v[40:43], v13 offset:4096
    s_waitcnt lgkmcnt(2)
    v_mfma_f32_16x16x32_bf16 v[128:131], v[64:67], v[32:35], v[128:131]
    v_mfma_f32_16x16x32_bf16 v[132:135], v[68:71], v[32:35], v[132:135]
    v_mfma_f32_16x16x32_bf16 v[136:139], v[72:75], v[32:35], v[136:139]
    v_mfma_f32_16x16x32_bf16 v[140:143], v[76:79], v[32:35], v[140:143]
    ds_read_b128 v[44:47], v13 offset:6144
    s_waitcnt lgkmcnt(2)
    v_mfma_f32_16x16x32_bf16 v[144:147], v[64:67], v[36:39], v[144:147]
    v_mfma_f32_16x16x32_bf16 v[148:151], v[68:71], v[36:39], v[148:151]
    v_mfma_f32_16x16x32_bf16 v[152:155], v[72:75], v[36:39], v[152:155]
    v_mfma_f32_16x16x32_bf16 v[156:159], v[76:79], v[36:39], v[156:159]
    ds_read_b128 v[32:35], v13 offset:8192
    s_waitcnt lgkmcnt(2)
    v_mfma_f32_16x16x32_bf16 v[160:163], v[64:67], v[40:43], v[160:163]
    v_mfma_f32_16x16x32_bf16 v[164:167], v[68:71], v[40:43], v[164:167]
    v_mfma_f32_16x16x32_bf16 v[168:171], v[72:75], v[40:43], v[168:171]
    v_mfma_f32_16x16x32_bf16 v[172:175], v[76:79], v[40:43], v[172:175]
    ds_read_b128 v[36:39], v13 offset:10240
    s_waitcnt lgkmcnt(2)
    v_mfma_f32_16x16x32_bf16 v[176:179], v[64:67], v[44:47], v[176:179]
    v_mfma_f32_16x16x32_bf16 v[180:183], v[68:71], v[44:47], v[180:183]
    v_mfma_f32_16x16x32_bf16 v[184:187], v[72:75], v[44:47], v[184:187]
    v_mfma_f32_16x16x32_bf16 v[188:191], v[76:79], v[44:47], v[188:191]
    ds_read_b128 v[40:43], v13 offset:12288
    s_waitcnt lgkmcnt(2)
    v_mfma_f32_16x16x32_bf16 v[192:195], v[64:67], v[32:35], v[192:195]
    v_mfma_f32_16x16x32_bf16 v[196:199], v[68:71], v[32:35], v[196:199]
    v_mfma_f32_16x16x32_bf16 v[200:203], v[72:75], v[32:35], v[200:203]
    v_mfma_f32_16x16x32_bf16 v[204:207], v[76:79], v[32:35], v[204:207]
    ds_read_b128 v[44:47], v13 offset:14336
    s_waitcnt lgkmcnt(2)
    v_mfma_f32_16x16x32_bf16 v[208:211], v[64:67], v[36:39], v[208:211]
    v_mfma_f32_16x16x32_bf16 v[212:215], v[68:71], v[36:39], v[212:215]
    v_mfma_f32_16x16x32_bf16 v[216:219], v[72:75], v[36:39], v[216:219]
    v_mfma_f32_16x16x32_bf16 v[220:223], v[76:79], v[36:39], v[220:223]
    s_waitcnt lgkmcnt(0) vmcnt(0)
    s_barrier
    v_xor_b32 v12, 0x10000, v12
    v_xor_b32 v13, 0x10000, v13
    v_xor_b32 v14, 0x10000, v14
    v_xor_b32 v15, 0x10000, v15
    v_xor_b32 v16, 0x10000, v16
    v_xor_b32 v17, 0x10000, v17
    v_mfma_f32_16x16x32_bf16 v[224:227], v[64:67], v[40:43], v[224:227]
    ds_read_b64_tr_b16 v[48:49], v14 offset:0
    ds_read_b64_tr_b16 v[50:51], v14 offset:1024
    v_mfma_f32_16x16x32_bf16 v[228:231], v[68:71], v[40:43], v[228:231]
    ds_read_b64_tr_b16 v[52:53], v15 offset:0
    ds_read_b64_tr_b16 v[54:55], v15 offset:1024
    v_mfma_f32_16x16x32_bf16 v[232:235], v[72:75], v[40:43], v[232:235]
    ds_read_b64_tr_b16 v[56:57], v16 offset:0
    ds_read_b64_tr_b16 v[58:59], v16 offset:1024
    v_mfma_f32_16x16x32_bf16 v[236:239], v[76:79], v[40:43], v[236:239]
    ds_read_b64_tr_b16 v[60:61], v17 offset:0
    ds_read_b64_tr_b16 v[62:63], v17 offset:1024
    ds_read_b128 v[32:35], v12 offset:0
    ds_read_b128 v[36:39], v12 offset:2048
    v_mfma_f32_16x16x32_bf16 v[240:243], v[64:67], v[44:47], v[240:243]
    v_mfma_f32_16x16x32_bf16 v[244:247], v[68:71], v[44:47], v[244:247]
    v_mfma_f32_16x16x32_bf16 v[248:251], v[72:75], v[44:47], v[248:251]
    v_mfma_f32_16x16x32_bf16 v[252:255], v[76:79], v[44:47], v[252:255]
    ds_read_b128 v[40:43], v12 offset:4096
    s_add_u32 s40, s40, 1
    s_cmp_lt_u32 s40, 7
    s_cbranch_scc1 ka_kernel_kloop
    s_waitcnt lgkmcnt(2)
    v_mfma_f32_16x16x32_bf16 v[128:131], v[48:51], v[32:35], v[128:131]
    ds_read_b64_tr_b16 v[64:65], v14 offset:8192
    v_mfma_f32_16x16x32_bf16 v[132:135], v[52:55], v[32:35], v[132:135]
    s_lshl_b32 s37, s32, 12
    s_add_u32 m0, s37, 0
    s_mov_b32 s38, 0
    v_mfma_f32_16x16x32_bf16 v[136:139], v[56:59], v[32:35], v[136:139]
    ds_read_b64_tr_b16 v[66:67], v14 offset:9216
    v_mfma_f32_16x16x32_bf16 v[140:143], v[60:63], v[32:35], v[140:143]
    ds_read_b128 v[44:47], v12 offset:6144
    s_waitcnt lgkmcnt(4)
    v_mfma_f32_16x16x32_bf16 v[144:147], v[48:51], v[36:39], v[144:147]
    ds_read_b64_tr_b16 v[68:69], v15 offset:8192
    v_mfma_f32_16x16x32_bf16 v[148:151], v[52:55], v[36:39], v[148:151]
    buffer_load_dwordx4 v28, s[20:23], s38 offen offset:0 lds
    buffer_load_dwordx4 v29, s[20:23], s38 offen offset:1024 lds
    buffer_load_dwordx4 v30, s[20:23], s38 offen offset:2048 lds
    v_mfma_f32_16x16x32_bf16 v[152:155], v[56:59], v[36:39], v[152:155]
    ds_read_b64_tr_b16 v[70:71], v15 offset:9216
    v_mfma_f32_16x16x32_bf16 v[156:159], v[60:63], v[36:39], v[156:159]
    ds_read_b128 v[32:35], v12 offset:8192
    s_waitcnt lgkmcnt(6)
    v_mfma_f32_16x16x32_bf16 v[160:163], v[48:51], v[40:43], v[160:163]
    ds_read_b64_tr_b16 v[72:73], v16 offset:8192
    v_mfma_f32_16x16x32_bf16 v[164:167], v[52:55], v[40:43], v[164:167]
    buffer_load_dwordx4 v31, s[20:23], s38 offen offset:3072 lds
    s_lshl_b32 s37, s32, 11
    s_add_u32 m0, s37, 32768
    v_mfma_f32_16x16x32_bf16 v[168:171], v[56:59], v[40:43], v[168:171]
    ds_read_b64_tr_b16 v[74:75], v16 offset:9216
    v_mfma_f32_16x16x32_bf16 v[172:175], v[60:63], v[40:43], v[172:175]
    ds_read_b128 v[36:39], v12 offset:10240
    s_waitcnt lgkmcnt(6)
    v_mfma_f32_16x16x32_bf16 v[176:179], v[48:51], v[44:47], v[176:179]
    ds_read_b64_tr_b16 v[76:77], v17 offset:8192
    v_mfma_f32_16x16x32_bf16 v[180:183], v[52:55], v[44:47], v[180:183]
    s_mov_b32 s38, 0
    buffer_load_dwordx4 v124, s[24:27], s38 offen offset:0 lds
    buffer_load_dwordx4 v125, s[24:27], s38 offen offset:1024 lds
    v_mfma_f32_16x16x32_bf16 v[184:187], v[56:59], v[44:47], v[184:187]
    ds_read_b64_tr_b16 v[78:79], v17 offset:9216
    v_mfma_f32_16x16x32_bf16 v[188:191], v[60:63], v[44:47], v[188:191]
    ds_read_b128 v[40:43], v12 offset:12288
    s_waitcnt lgkmcnt(6)
    v_mfma_f32_16x16x32_bf16 v[192:195], v[48:51], v[32:35], v[192:195]
    v_mfma_f32_16x16x32_bf16 v[196:199], v[52:55], v[32:35], v[196:199]
    s_lshl_b32 s37, s32, 12
    s_add_u32 m0, s37, 131072
    s_mov_b32 s38, 128
    v_mfma_f32_16x16x32_bf16 v[200:203], v[56:59], v[32:35], v[200:203]
    v_mfma_f32_16x16x32_bf16 v[204:207], v[60:63], v[32:35], v[204:207]
    ds_read_b128 v[44:47], v12 offset:14336
    s_waitcnt lgkmcnt(4)
    v_mfma_f32_16x16x32_bf16 v[208:211], v[48:51], v[36:39], v[208:211]
    v_mfma_f32_16x16x32_bf16 v[212:215], v[52:55], v[36:39], v[212:215]
    buffer_load_dwordx4 v28, s[20:23], s38 offen offset:0 lds
    buffer_load_dwordx4 v29, s[20:23], s38 offen offset:1024 lds
    buffer_load_dwordx4 v30, s[20:23], s38 offen offset:2048 lds
    v_mfma_f32_16x16x32_bf16 v[216:219], v[56:59], v[36:39], v[216:219]
    v_mfma_f32_16x16x32_bf16 v[220:223], v[60:63], v[36:39], v[220:223]
    ds_read_b128 v[32:35], v13 offset:0
    s_waitcnt lgkmcnt(2)
    v_mfma_f32_16x16x32_bf16 v[224:227], v[48:51], v[40:43], v[224:227]
    v_mfma_f32_16x16x32_bf16 v[228:231], v[52:55], v[40:43], v[228:231]
    buffer_load_dwordx4 v31, s[20:23], s38 offen offset:3072 lds
    s_lshl_b32 s37, s32, 11
    s_add_u32 m0, s37, 49152
    v_mfma_f32_16x16x32_bf16 v[232:235], v[56:59], v[40:43], v[232:235]
    v_mfma_f32_16x16x32_bf16 v[236:239], v[60:63], v[40:43], v[236:239]
    ds_read_b128 v[36:39], v13 offset:2048
    s_waitcnt lgkmcnt(2)
    v_mfma_f32_16x16x32_bf16 v[240:243], v[48:51], v[44:47], v[240:243]
    v_mfma_f32_16x16x32_bf16 v[244:247], v[52:55], v[44:47], v[244:247]
    s_mov_b32 s38, 524288
    buffer_load_dwordx4 v124, s[24:27], s38 offen offset:0 lds
    buffer_load_dwordx4 v125, s[24:27], s38 offen offset:1024 lds
    v_mfma_f32_16x16x32_bf16 v[248:251], v[56:59], v[44:47], v[248:251]
    v_mfma_f32_16x16x32_bf16 v[252:255], v[60:63], v[44:47], v[252:255]
    ds_read_b128 v[40:43], v13 offset:4096
    s_waitcnt lgkmcnt(2)
    v_mfma_f32_16x16x32_bf16 v[128:131], v[64:67], v[32:35], v[128:131]
    v_mfma_f32_16x16x32_bf16 v[132:135], v[68:71], v[32:35], v[132:135]
    v_mfma_f32_16x16x32_bf16 v[136:139], v[72:75], v[32:35], v[136:139]
    v_mfma_f32_16x16x32_bf16 v[140:143], v[76:79], v[32:35], v[140:143]
    ds_read_b128 v[44:47], v13 offset:6144
    s_waitcnt lgkmcnt(2)
    v_mfma_f32_16x16x32_bf16 v[144:147], v[64:67], v[36:39], v[144:147]
    v_mfma_f32_16x16x32_bf16 v[148:151], v[68:71], v[36:39], v[148:151]
    v_mfma_f32_16x16x32_bf16 v[152:155], v[72:75], v[36:39], v[152:155]
    v_mfma_f32_16x16x32_bf16 v[156:159], v[76:79], v[36:39], v[156:159]
    ds_read_b128 v[32:35], v13 offset:8192
    s_waitcnt lgkmcnt(2)
    v_mfma_f32_16x16x32_bf16 v[160:163], v[64:67], v[40:43], v[160:163]
    v_mfma_f32_16x16x32_bf16 v[164:167], v[68:71], v[40:43], v[164:167]
    v_mfma_f32_16x16x32_bf16 v[168:171], v[72:75], v[40:43], v[168:171]
    v_mfma_f32_16x16x32_bf16 v[172:175], v[76:79], v[40:43], v[172:175]
    ds_read_b128 v[36:39], v13 offset:10240
    s_waitcnt lgkmcnt(2)
    v_mfma_f32_16x16x32_bf16 v[176:179], v[64:67], v[44:47], v[176:179]
    v_mfma_f32_16x16x32_bf16 v[180:183], v[68:71], v[44:47], v[180:183]
    v_mfma_f32_16x16x32_bf16 v[184:187], v[72:75], v[44:47], v[184:187]
    v_mfma_f32_16x16x32_bf16 v[188:191], v[76:79], v[44:47], v[188:191]
    ds_read_b128 v[40:43], v13 offset:12288
    s_waitcnt lgkmcnt(2)
    v_mfma_f32_16x16x32_bf16 v[192:195], v[64:67], v[32:35], v[192:195]
    v_mfma_f32_16x16x32_bf16 v[196:199], v[68:71], v[32:35], v[196:199]
    v_mfma_f32_16x16x32_bf16 v[200:203], v[72:75], v[32:35], v[200:203]
    v_mfma_f32_16x16x32_bf16 v[204:207], v[76:79], v[32:35], v[204:207]
    ds_read_b128 v[44:47], v13 offset:14336
    s_waitcnt lgkmcnt(2)
    v_mfma_f32_16x16x32_bf16 v[208:211], v[64:67], v[36:39], v[208:211]
    v_mfma_f32_16x16x32_bf16 v[212:215], v[68:71], v[36:39], v[212:215]
    v_mfma_f32_16x16x32_bf16 v[216:219], v[72:75], v[36:39], v[216:219]
    v_mfma_f32_16x16x32_bf16 v[220:223], v[76:79], v[36:39], v[220:223]
    s_waitcnt lgkmcnt(0) vmcnt(6)
    s_barrier
    v_mfma_f32_16x16x32_bf16 v[224:227], v[64:67], v[40:43], v[224:227]
    s_lshl_b32 s37, s32, 12
    v_mfma_f32_16x16x32_bf16 v[228:231], v[68:71], v[40:43], v[228:231]
    s_add_u32 m0, s37, 65536
    s_mov_b32 s38, 256
    v_mfma_f32_16x16x32_bf16 v[232:235], v[72:75], v[40:43], v[232:235]
    buffer_load_dwordx4 v28, s[20:23], s38 offen offset:0 lds
    v_mfma_f32_16x16x32_bf16 v[236:239], v[76:79], v[40:43], v[236:239]
    buffer_load_dwordx4 v29, s[20:23], s38 offen offset:1024 lds
    buffer_load_dwordx4 v30, s[20:23], s38 offen offset:2048 lds
    v_mfma_f32_16x16x32_bf16 v[240:243], v[64:67], v[44:47], v[240:243]
    buffer_load_dwordx4 v31, s[20:23], s38 offen offset:3072 lds
    v_mfma_f32_16x16x32_bf16 v[244:247], v[68:71], v[44:47], v[244:247]
    s_lshl_b32 s37, s32, 11
    s_add_u32 m0, s37, 98304
    v_mfma_f32_16x16x32_bf16 v[248:251], v[72:75], v[44:47], v[248:251]
    s_mov_b32 s38, 1048576
    v_mfma_f32_16x16x32_bf16 v[252:255], v[76:79], v[44:47], v[252:255]
    buffer_load_dwordx4 v124, s[24:27], s38 offen offset:0 lds
    buffer_load_dwordx4 v125, s[24:27], s38 offen offset:1024 lds
    s_and_b32 s38, s32, 2
    s_lshl_b32 s66, s38, 10
    s_add_u32 s67, s66, 4096
    v_cvt_pk_bf16_f32 v32, v128, v129
    v_cvt_pk_bf16_f32 v33, v130, v131
    v_cvt_pk_bf16_f32 v34, v132, v133
    v_cvt_pk_bf16_f32 v35, v134, v135
    v_cvt_pk_bf16_f32 v36, v136, v137
    v_cvt_pk_bf16_f32 v37, v138, v139
    v_cvt_pk_bf16_f32 v38, v140, v141
    v_cvt_pk_bf16_f32 v39, v142, v143
    v_cvt_pk_bf16_f32 v40, v144, v145
    v_cvt_pk_bf16_f32 v41, v146, v147
    v_cvt_pk_bf16_f32 v42, v148, v149
    v_cvt_pk_bf16_f32 v43, v150, v151
    v_cvt_pk_bf16_f32 v44, v152, v153
    v_cvt_pk_bf16_f32 v45, v154, v155
    v_cvt_pk_bf16_f32 v46, v156, v157
    v_cvt_pk_bf16_f32 v47, v158, v159
    v_cvt_pk_bf16_f32 v48, v160, v161
    v_cvt_pk_bf16_f32 v49, v162, v163
    v_cvt_pk_bf16_f32 v50, v164, v165
    v_cvt_pk_bf16_f32 v51, v166, v167
    v_cvt_pk_bf16_f32 v52, v168, v169
    v_cvt_pk_bf16_f32 v53, v170, v171
    v_cvt_pk_bf16_f32 v54, v172, v173
    v_cvt_pk_bf16_f32 v55, v174, v175
    v_cvt_pk_bf16_f32 v56, v176, v177
    v_cvt_pk_bf16_f32 v57, v178, v179
    v_cvt_pk_bf16_f32 v58, v180, v181
    v_cvt_pk_bf16_f32 v59, v182, v183
    v_cvt_pk_bf16_f32 v60, v184, v185
    v_cvt_pk_bf16_f32 v61, v186, v187
    v_cvt_pk_bf16_f32 v62, v188, v189
    v_cvt_pk_bf16_f32 v63, v190, v191
    v_cvt_pk_bf16_f32 v160, v192, v193
    v_cvt_pk_bf16_f32 v161, v194, v195
    v_cvt_pk_bf16_f32 v162, v196, v197
    v_cvt_pk_bf16_f32 v163, v198, v199
    v_cvt_pk_bf16_f32 v164, v200, v201
    v_cvt_pk_bf16_f32 v165, v202, v203
    v_cvt_pk_bf16_f32 v166, v204, v205
    v_cvt_pk_bf16_f32 v167, v206, v207
    v_cvt_pk_bf16_f32 v168, v208, v209
    v_cvt_pk_bf16_f32 v169, v210, v211
    v_cvt_pk_bf16_f32 v170, v212, v213
    v_cvt_pk_bf16_f32 v171, v214, v215
    v_cvt_pk_bf16_f32 v172, v216, v217
    v_cvt_pk_bf16_f32 v173, v218, v219
    v_cvt_pk_bf16_f32 v174, v220, v221
    v_cvt_pk_bf16_f32 v175, v222, v223
    v_cvt_pk_bf16_f32 v176, v224, v225
    v_cvt_pk_bf16_f32 v177, v226, v227
    v_cvt_pk_bf16_f32 v178, v228, v229
    v_cvt_pk_bf16_f32 v179, v230, v231
    v_cvt_pk_bf16_f32 v180, v232, v233
    v_cvt_pk_bf16_f32 v181, v234, v235
    v_cvt_pk_bf16_f32 v182, v236, v237
    v_cvt_pk_bf16_f32 v183, v238, v239
    v_cvt_pk_bf16_f32 v184, v240, v241
    v_cvt_pk_bf16_f32 v185, v242, v243
    v_cvt_pk_bf16_f32 v186, v244, v245
    v_cvt_pk_bf16_f32 v187, v246, v247
    v_cvt_pk_bf16_f32 v188, v248, v249
    v_cvt_pk_bf16_f32 v189, v250, v251
    v_cvt_pk_bf16_f32 v190, v252, v253
    v_cvt_pk_bf16_f32 v191, v254, v255
    s_branch ka_kernel_qproj
ka_kernel_vfirst:
    s_waitcnt lgkmcnt(2)
    v_mfma_f32_16x16x32_bf16 v[128:131], v[32:35], v[48:51], v[128:131]
    ds_read_b64_tr_b16 v[64:65], v14 offset:8192
    v_mfma_f32_16x16x32_bf16 v[132:135], v[32:35], v[52:55], v[132:135]
    v_mfma_f32_16x16x32_bf16 v[136:139], v[32:35], v[56:59], v[136:139]
    ds_read_b64_tr_b16 v[66:67], v14 offset:9216
    v_mfma_f32_16x16x32_bf16 v[140:143], v[32:35], v[60:63], v[140:143]
    ds_read_b128 v[44:47], v12 offset:6144
    s_waitcnt lgkmcnt(4)
    v_mfma_f32_16x16x32_bf16 v[144:147], v[36:39], v[48:51], v[144:147]
    ds_read_b64_tr_b16 v[68:69], v15 offset:8192
    v_mfma_f32_16x16x32_bf16 v[148:151], v[36:39], v[52:55], v[148:151]
    v_mfma_f32_16x16x32_bf16 v[152:155], v[36:39], v[56:59], v[152:155]
    ds_read_b64_tr_b16 v[70:71], v15 offset:9216
    v_mfma_f32_16x16x32_bf16 v[156:159], v[36:39], v[60:63], v[156:159]
    ds_read_b128 v[32:35], v12 offset:8192
    s_waitcnt lgkmcnt(6)
    v_mfma_f32_16x16x32_bf16 v[160:163], v[40:43], v[48:51], v[160:163]
    ds_read_b64_tr_b16 v[72:73], v16 offset:8192
    v_mfma_f32_16x16x32_bf16 v[164:167], v[40:43], v[52:55], v[164:167]
    v_mfma_f32_16x16x32_bf16 v[168:171], v[40:43], v[56:59], v[168:171]
    ds_read_b64_tr_b16 v[74:75], v16 offset:9216
    v_mfma_f32_16x16x32_bf16 v[172:175], v[40:43], v[60:63], v[172:175]
    ds_read_b128 v[36:39], v12 offset:10240
    s_waitcnt lgkmcnt(6)
    v_mfma_f32_16x16x32_bf16 v[176:179], v[44:47], v[48:51], v[176:179]
    ds_read_b64_tr_b16 v[76:77], v17 offset:8192
    v_mfma_f32_16x16x32_bf16 v[180:183], v[44:47], v[52:55], v[180:183]
    v_mfma_f32_16x16x32_bf16 v[184:187], v[44:47], v[56:59], v[184:187]
    ds_read_b64_tr_b16 v[78:79], v17 offset:9216
    v_mfma_f32_16x16x32_bf16 v[188:191], v[44:47], v[60:63], v[188:191]
    ds_read_b128 v[40:43], v12 offset:12288
    s_waitcnt lgkmcnt(6)
    v_mfma_f32_16x16x32_bf16 v[192:195], v[32:35], v[48:51], v[192:195]
    v_mfma_f32_16x16x32_bf16 v[196:199], v[32:35], v[52:55], v[196:199]
    v_mfma_f32_16x16x32_bf16 v[200:203], v[32:35], v[56:59], v[200:203]
    v_mfma_f32_16x16x32_bf16 v[204:207], v[32:35], v[60:63], v[204:207]
    ds_read_b128 v[44:47], v12 offset:14336
    s_waitcnt lgkmcnt(4)
    v_mfma_f32_16x16x32_bf16 v[208:211], v[36:39], v[48:51], v[208:211]
    v_mfma_f32_16x16x32_bf16 v[212:215], v[36:39], v[52:55], v[212:215]
    v_mfma_f32_16x16x32_bf16 v[216:219], v[36:39], v[56:59], v[216:219]
    v_mfma_f32_16x16x32_bf16 v[220:223], v[36:39], v[60:63], v[220:223]
    ds_read_b128 v[32:35], v13 offset:0
    s_waitcnt lgkmcnt(2)
    v_mfma_f32_16x16x32_bf16 v[224:227], v[40:43], v[48:51], v[224:227]
    v_mfma_f32_16x16x32_bf16 v[228:231], v[40:43], v[52:55], v[228:231]
    v_mfma_f32_16x16x32_bf16 v[232:235], v[40:43], v[56:59], v[232:235]
    v_mfma_f32_16x16x32_bf16 v[236:239], v[40:43], v[60:63], v[236:239]
    ds_read_b128 v[36:39], v13 offset:2048
    s_waitcnt lgkmcnt(2)
    v_mfma_f32_16x16x32_bf16 v[240:243], v[44:47], v[48:51], v[240:243]
    v_mfma_f32_16x16x32_bf16 v[244:247], v[44:47], v[52:55], v[244:247]
    v_mfma_f32_16x16x32_bf16 v[248:251], v[44:47], v[56:59], v[248:251]
    v_mfma_f32_16x16x32_bf16 v[252:255], v[44:47], v[60:63], v[252:255]
    ds_read_b128 v[40:43], v13 offset:4096
    s_waitcnt lgkmcnt(2)
    v_mfma_f32_16x16x32_bf16 v[128:131], v[32:35], v[64:67], v[128:131]
    v_mfma_f32_16x16x32_bf16 v[132:135], v[32:35], v[68:71], v[132:135]
    v_mfma_f32_16x16x32_bf16 v[136:139], v[32:35], v[72:75], v[136:139]
    v_mfma_f32_16x16x32_bf16 v[140:143], v[32:35], v[76:79], v[140:143]
    ds_read_b128 v[44:47], v13 offset:6144
    s_cmp_eq_u32 s40, 0
    s_cbranch_scc1 ka_kernel_h_3
ka_kernel_r_2:
    s_waitcnt lgkmcnt(2)
    v_mfma_f32_16x16x32_bf16 v[144:147], v[36:39], v[64:67], v[144:147]
    v_mfma_f32_16x16x32_bf16 v[148:151], v[36:39], v[68:71], v[148:151]
    v_mfma_f32_16x16x32_bf16 v[152:155], v[36:39], v[72:75], v[152:155]
    v_mfma_f32_16x16x32_bf16 v[156:159], v[36:39], v[76:79], v[156:159]
    ds_read_b128 v[32:35], v13 offset:8192
    s_waitcnt lgkmcnt(2)
    v_mfma_f32_16x16x32_bf16 v[160:163], v[40:43], v[64:67], v[160:163]
    v_mfma_f32_16x16x32_bf16 v[164:167], v[40:43], v[68:71], v[164:167]
    v_mfma_f32_16x16x32_bf16 v[168:171], v[40:43], v[72:75], v[168:171]
    v_mfma_f32_16x16x32_bf16 v[172:175], v[40:43], v[76:79], v[172:175]
    ds_read_b128 v[36:39], v13 offset:10240
    s_waitcnt lgkmcnt(2)
    v_mfma_f32_16x16x32_bf16 v[176:179], v[44:47], v[64:67], v[176:179]
    v_mfma_f32_16x16x32_bf16 v[180:183], v[44:47], v[68:71], v[180:183]
    v_mfma_f32_16x16x32_bf16 v[184:187], v[44:47], v[72:75], v[184:187]
    v_mfma_f32_16x16x32_bf16 v[188:191], v[44:47], v[76:79], v[188:191]
    ds_read_b128 v[40:43], v13 offset:12288
    s_waitcnt lgkmcnt(2)
    v_mfma_f32_16x16x32_bf16 v[192:195], v[32:35], v[64:67], v[192:195]
    v_mfma_f32_16x16x32_bf16 v[196:199], v[32:35], v[68:71], v[196:199]
    v_mfma_f32_16x16x32_bf16 v[200:203], v[32:35], v[72:75], v[200:203]
    v_mfma_f32_16x16x32_bf16 v[204:207], v[32:35], v[76:79], v[204:207]
    ds_read_b128 v[44:47], v13 offset:14336
    s_waitcnt lgkmcnt(2)
    v_mfma_f32_16x16x32_bf16 v[208:211], v[36:39], v[64:67], v[208:211]
    v_mfma_f32_16x16x32_bf16 v[212:215], v[36:39], v[68:71], v[212:215]
    v_mfma_f32_16x16x32_bf16 v[216:219], v[36:39], v[72:75], v[216:219]
    v_mfma_f32_16x16x32_bf16 v[220:223], v[36:39], v[76:79], v[220:223]
    s_waitcnt lgkmcnt(0)
    s_barrier
    v_xor_b32 v12, 0x10000, v12
    v_xor_b32 v13, 0x10000, v13
    v_xor_b32 v14, 0x10000, v14
    v_xor_b32 v15, 0x10000, v15
    v_xor_b32 v16, 0x10000, v16
    v_xor_b32 v17, 0x10000, v17
    v_mfma_f32_16x16x32_bf16 v[224:227], v[40:43], v[64:67], v[224:227]
    ds_read_b64_tr_b16 v[48:49], v14 offset:0
    ds_read_b64_tr_b16 v[50:51], v14 offset:1024
    v_mfma_f32_16x16x32_bf16 v[228:231], v[40:43], v[68:71], v[228:231]
    ds_read_b64_tr_b16 v[52:53], v15 offset:0
    ds_read_b64_tr_b16 v[54:55], v15 offset:1024
    v_mfma_f32_16x16x32_bf16 v[232:235], v[40:43], v[72:75], v[232:235]
    ds_read_b64_tr_b16 v[56:57], v16 offset:0
    ds_read_b64_tr_b16 v[58:59], v16 offset:1024
    v_mfma_f32_16x16x32_bf16 v[236:239], v[40:43], v[76:79], v[236:239]
    ds_read_b64_tr_b16 v[60:61], v17 offset:0
    ds_read_b64_tr_b16 v[62:63], v17 offset:1024
    ds_read_b128 v[32:35], v12 offset:0
    ds_read_b128 v[36:39], v12 offset:2048
    v_mfma_f32_16x16x32_bf16 v[240:243], v[44:47], v[64:67], v[240:243]
    v_mfma_f32_16x16x32_bf16 v[244:247], v[44:47], v[68:71], v[244:247]
    v_mfma_f32_16x16x32_bf16 v[248:251], v[44:47], v[72:75], v[248:251]
    v_mfma_f32_16x16x32_bf16 v[252:255], v[44:47], v[76:79], v[252:255]
    ds_read_b128 v[40:43], v12 offset:4096
    s_mov_b32 s40, 1
ka_kernel_vloop:
    s_waitcnt lgkmcnt(2)
    v_mfma_f32_16x16x32_bf16 v[128:131], v[32:35], v[48:51], v[128:131]
    ds_read_b64_tr_b16 v[64:65], v14 offset:8192
    v_mfma_f32_16x16x32_bf16 v[132:135], v[32:35], v[52:55], v[132:135]
    v_mfma_f32_16x16x32_bf16 v[136:139], v[32:35], v[56:59], v[136:139]
    ds_read_b64_tr_b16 v[66:67], v14 offset:9216
    v_mfma_f32_16x16x32_bf16 v[140:143], v[32:35], v[60:63], v[140:143]
    ds_read_b128 v[44:47], v12 offset:6144
    s_waitcnt lgkmcnt(4)
    v_mfma_f32_16x16x32_bf16 v[144:147], v[36:39], v[48:51], v[144:147]
    ds_read_b64_tr_b16 v[68:69], v15 offset:8192
    v_mfma_f32_16x16x32_bf16 v[148:151], v[36:39], v[52:55], v[148:151]
    v_mfma_f32_16x16x32_bf16 v[152:155], v[36:39], v[56:59], v[152:155]
    ds_read_b64_tr_b16 v[70:71], v15 offset:9216
    v_mfma_f32_16x16x32_bf16 v[156:159], v[36:39], v[60:63], v[156:159]
    ds_read_b128 v[32:35], v12 offset:8192
    s_waitcnt lgkmcnt(6)
    v_mfma_f32_16x16x32_bf16 v[160:163], v[40:43], v[48:51], v[160:163]
    ds_read_b64_tr_b16 v[72:73], v16 offset:8192
    v_mfma_f32_16x16x32_bf16 v[164:167], v[40:43], v[52:55], v[164:167]
    v_mfma_f32_16x16x32_bf16 v[168:171], v[40:43], v[56:59], v[168:171]
    ds_read_b64_tr_b16 v[74:75], v16 offset:9216
    v_mfma_f32_16x16x32_bf16 v[172:175], v[40:43], v[60:63], v[172:175]
    ds_read_b128 v[36:39], v12 offset:10240
    s_waitcnt lgkmcnt(6)
    v_mfma_f32_16x16x32_bf16 v[176:179], v[44:47], v[48:51], v[176:179]
    ds_read_b64_tr_b16 v[76:77], v17 offset:8192
    v_mfma_f32_16x16x32_bf16 v[180:183], v[44:47], v[52:55], v[180:183]
    v_mfma_f32_16x16x32_bf16 v[184:187], v[44:47], v[56:59], v[184:187]
    ds_read_b64_tr_b16 v[78:79], v17 offset:9216
    v_mfma_f32_16x16x32_bf16 v[188:191], v[44:47], v[60:63], v[188:191]
    ds_read_b128 v[40:43], v12 offset:12288
    s_waitcnt lgkmcnt(6)
    v_mfma_f32_16x16x32_bf16 v[192:195], v[32:35], v[48:51], v[192:195]
    v_mfma_f32_16x16x32_bf16 v[196:199], v[32:35], v[52:55], v[196:199]
    v_mfma_f32_16x16x32_bf16 v[200:203], v[32:35], v[56:59], v[200:203]
    v_mfma_f32_16x16x32_bf16 v[204:207], v[32:35], v[60:63], v[204:207]
    ds_read_b128 v[44:47], v12 offset:14336
    s_waitcnt lgkmcnt(4)
    v_mfma_f32_16x16x32_bf16 v[208:211], v[36:39], v[48:51], v[208:211]
    v_mfma_f32_16x16x32_bf16 v[212:215], v[36:39], v[52:55], v[212:215]
    v_mfma_f32_16x16x32_bf16 v[216:219], v[36:39], v[56:59], v[216:219]
    v_mfma_f32_16x16x32_bf16 v[220:223], v[36:39], v[60:63], v[220:223]
    ds_read_b128 v[32:35], v13 offset:0
    s_waitcnt lgkmcnt(2)
    v_mfma_f32_16x16x32_bf16 v[224:227], v[40:43], v[48:51], v[224:227]
    v_mfma_f32_16x16x32_bf16 v[228:231], v[40:43], v[52:55], v[228:231]
    v_mfma_f32_16x16x32_bf16 v[232:235], v[40:43], v[56:59], v[232:235]
    v_mfma_f32_16x16x32_bf16 v[236:239], v[40:43], v[60:63], v[236:239]
    ds_read_b128 v[36:39], v13 offset:2048
    s_waitcnt lgkmcnt(2)
    v_mfma_f32_16x16x32_bf16 v[240:243], v[44:47], v[48:51], v[240:243]
    v_mfma_f32_16x16x32_bf16 v[244:247], v[44:47], v[52:55], v[244:247]
    v_mfma_f32_16x16x32_bf16 v[248:251], v[44:47], v[56:59], v[248:251]
    v_mfma_f32_16x16x32_bf16 v[252:255], v[44:47], v[60:63], v[252:255]
    ds_read_b128 v[40:43], v13 offset:4096
    s_waitcnt lgkmcnt(2)
    v_mfma_f32_16x16x32_bf16 v[128:131], v[32:35], v[64:67], v[128:131]
    v_mfma_f32_16x16x32_bf16 v[132:135], v[32:35], v[68:71], v[132:135]
    v_mfma_f32_16x16x32_bf16 v[136:139], v[32:35], v[72:75], v[136:139]
    v_mfma_f32_16x16x32_bf16 v[140:143], v[32:35], v[76:79], v[140:143]
    ds_read_b128 v[44:47], v13 offset:6144
    s_cmp_eq_u32 s40, 1
    s_cbranch_scc1 ka_kernel_h_5
    s_cmp_eq_u32 s40, 2
    s_cbranch_scc1 ka_kernel_h_6
    s_cmp_eq_u32 s40, 3
    s_cbranch_scc1 ka_kernel_h_7
    s_cmp_eq_u32 s40, 4
    s_cbranch_scc1 ka_kernel_h_8
ka_kernel_r_4:
    s_waitcnt lgkmcnt(2)
    v_mfma_f32_16x16x32_bf16 v[144:147], v[36:39], v[64:67], v[144:147]
    v_mfma_f32_16x16x32_bf16 v[148:151], v[36:39], v[68:71], v[148:151]
    v_mfma_f32_16x16x32_bf16 v[152:155], v[36:39], v[72:75], v[152:155]
    v_mfma_f32_16x16x32_bf16 v[156:159], v[36:39], v[76:79], v[156:159]
    ds_read_b128 v[32:35], v13 offset:8192
    s_waitcnt lgkmcnt(2)
    v_mfma_f32_16x16x32_bf16 v[160:163], v[40:43], v[64:67], v[160:163]
    v_mfma_f32_16x16x32_bf16 v[164:167], v[40:43], v[68:71], v[164:167]
    v_mfma_f32_16x16x32_bf16 v[168:171], v[40:43], v[72:75], v[168:171]
    v_mfma_f32_16x16x32_bf16 v[172:175], v[40:43], v[76:79], v[172:175]
    ds_read_b128 v[36:39], v13 offset:10240
    s_waitcnt lgkmcnt(2)
    v_mfma_f32_16x16x32_bf16 v[176:179], v[44:47], v[64:67], v[176:179]
    v_mfma_f32_16x16x32_bf16 v[180:183], v[44:47], v[68:71], v[180:183]
    v_mfma_f32_16x16x32_bf16 v[184:187], v[44:47], v[72:75], v[184:187]
    v_mfma_f32_16x16x32_bf16 v[188:191], v[44:47], v[76:79], v[188:191]
    ds_read_b128 v[40:43], v13 offset:12288
    s_waitcnt lgkmcnt(2)
    v_mfma_f32_16x16x32_bf16 v[192:195], v[32:35], v[64:67], v[192:195]
    v_mfma_f32_16x16x32_bf16 v[196:199], v[32:35], v[68:71], v[196:199]
    v_mfma_f32_16x16x32_bf16 v[200:203], v[32:35], v[72:75], v[200:203]
    v_mfma_f32_16x16x32_bf16 v[204:207], v[32:35], v[76:79], v[204:207]
    ds_read_b128 v[44:47], v13 offset:14336
    s_waitcnt lgkmcnt(2)
    v_mfma_f32_16x16x32_bf16 v[208:211], v[36:39], v[64:67], v[208:211]
    v_mfma_f32_16x16x32_bf16 v[212:215], v[36:39], v[68:71], v[212:215]
    v_mfma_f32_16x16x32_bf16 v[216:219], v[36:39], v[72:75], v[216:219]
    v_mfma_f32_16x16x32_bf16 v[220:223], v[36:39], v[76:79], v[220:223]
    s_waitcnt lgkmcnt(0)
    s_barrier
    v_xor_b32 v12, 0x10000, v12
    v_xor_b32 v13, 0x10000, v13
    v_xor_b32 v14, 0x10000, v14
    v_xor_b32 v15, 0x10000, v15
    v_xor_b32 v16, 0x10000, v16
    v_xor_b32 v17, 0x10000, v17
    v_mfma_f32_16x16x32_bf16 v[224:227], v[40:43], v[64:67], v[224:227]
    ds_read_b64_tr_b16 v[48:49], v14 offset:0
    ds_read_b64_tr_b16 v[50:51], v14 offset:1024
    v_mfma_f32_16x16x32_bf16 v[228:231], v[40:43], v[68:71], v[228:231]
    ds_read_b64_tr_b16 v[52:53], v15 offset:0
    ds_read_b64_tr_b16 v[54:55], v15 offset:1024
    v_mfma_f32_16x16x32_bf16 v[232:235], v[40:43], v[72:75], v[232:235]
    ds_read_b64_tr_b16 v[56:57], v16 offset:0
    ds_read_b64_tr_b16 v[58:59], v16 offset:1024
    v_mfma_f32_16x16x32_bf16 v[236:239], v[40:43], v[76:79], v[236:239]
    ds_read_b64_tr_b16 v[60:61], v17 offset:0
    ds_read_b64_tr_b16 v[62:63], v17 offset:1024
    ds_read_b128 v[32:35], v12 offset:0
    ds_read_b128 v[36:39], v12 offset:2048
    v_mfma_f32_16x16x32_bf16 v[240:243], v[44:47], v[64:67], v[240:243]
    v_mfma_f32_16x16x32_bf16 v[244:247], v[44:47], v[68:71], v[244:247]
    v_mfma_f32_16x16x32_bf16 v[248:251], v[44:47], v[72:75], v[248:251]
    v_mfma_f32_16x16x32_bf16 v[252:255], v[44:47], v[76:79], v[252:255]
    ds_read_b128 v[40:43], v12 offset:4096
    s_add_u32 s40, s40, 1
    s_cmp_lt_u32 s40, 7
    s_cbranch_scc1 ka_kernel_vloop
    s_waitcnt lgkmcnt(2)
    v_mfma_f32_16x16x32_bf16 v[128:131], v[32:35], v[48:51], v[128:131]
    ds_read_b64_tr_b16 v[64:65], v14 offset:8192
    v_mfma_f32_16x16x32_bf16 v[132:135], v[32:35], v[52:55], v[132:135]
    s_lshl_b32 s37, s32, 12
    s_add_u32 m0, s37, 0
    s_mov_b32 s38, 0
    v_mfma_f32_16x16x32_bf16 v[136:139], v[32:35], v[56:59], v[136:139]
    ds_read_b64_tr_b16 v[66:67], v14 offset:9216
    v_mfma_f32_16x16x32_bf16 v[140:143], v[32:35], v[60:63], v[140:143]
    ds_read_b128 v[44:47], v12 offset:6144
    s_waitcnt lgkmcnt(4)
    v_mfma_f32_16x16x32_bf16 v[144:147], v[36:39], v[48:51], v[144:147]
    ds_read_b64_tr_b16 v[68:69], v15 offset:8192
    v_mfma_f32_16x16x32_bf16 v[148:151], v[36:39], v[52:55], v[148:151]
    buffer_load_dwordx4 v28, s[20:23], s38 offen offset:0 lds
    buffer_load_dwordx4 v29, s[20:23], s38 offen offset:1024 lds
    buffer_load_dwordx4 v30, s[20:23], s38 offen offset:2048 lds
    v_mfma_f32_16x16x32_bf16 v[152:155], v[36:39], v[56:59], v[152:155]
    ds_read_b64_tr_b16 v[70:71], v15 offset:9216
    v_mfma_f32_16x16x32_bf16 v[156:159], v[36:39], v[60:63], v[156:159]
    ds_read_b128 v[32:35], v12 offset:8192
    s_waitcnt lgkmcnt(6)
    v_mfma_f32_16x16x32_bf16 v[160:163], v[40:43], v[48:51], v[160:163]
    ds_read_b64_tr_b16 v[72:73], v16 offset:8192
    v_mfma_f32_16x16x32_bf16 v[164:167], v[40:43], v[52:55], v[164:167]
    buffer_load_dwordx4 v31, s[20:23], s38 offen offset:3072 lds
    s_lshl_b32 s37, s32, 11
    s_add_u32 m0, s37, 32768
    v_mfma_f32_16x16x32_bf16 v[168:171], v[40:43], v[56:59], v[168:171]
    ds_read_b64_tr_b16 v[74:75], v16 offset:9216
    v_mfma_f32_16x16x32_bf16 v[172:175], v[40:43], v[60:63], v[172:175]
    ds_read_b128 v[36:39], v12 offset:10240
    s_waitcnt lgkmcnt(6)
    v_mfma_f32_16x16x32_bf16 v[176:179], v[44:47], v[48:51], v[176:179]
    ds_read_b64_tr_b16 v[76:77], v17 offset:8192
    v_mfma_f32_16x16x32_bf16 v[180:183], v[44:47], v[52:55], v[180:183]
    s_mov_b32 s38, 0
    buffer_load_dwordx4 v124, s[24:27], s38 offen offset:0 lds
    buffer_load_dwordx4 v125, s[24:27], s38 offen offset:1024 lds
    v_mfma_f32_16x16x32_bf16 v[184:187], v[44:47], v[56:59], v[184:187]
    ds_read_b64_tr_b16 v[78:79], v17 offset:9216
    v_mfma_f32_16x16x32_bf16 v[188:191], v[44:47], v[60:63], v[188:191]
    ds_read_b128 v[40:43], v12 offset:12288
    s_waitcnt lgkmcnt(6)
    v_mfma_f32_16x16x32_bf16 v[192:195], v[32:35], v[48:51], v[192:195]
    v_mfma_f32_16x16x32_bf16 v[196:199], v[32:35], v[52:55], v[196:199]
    s_lshl_b32 s37, s32, 12
    s_add_u32 m0, s37, 131072
    s_mov_b32 s38, 128
    v_mfma_f32_16x16x32_bf16 v[200:203], v[32:35], v[56:59], v[200:203]
    v_mfma_f32_16x16x32_bf16 v[204:207], v[32:35], v[60:63], v[204:207]
    ds_read_b128 v[44:47], v12 offset:14336
    s_waitcnt lgkmcnt(4)
    v_mfma_f32_16x16x32_bf16 v[208:211], v[36:39], v[48:51], v[208:211]
    v_mfma_f32_16x16x32_bf16 v[212:215], v[36:39], v[52:55], v[212:215]
    buffer_load_dwordx4 v28, s[20:23], s38 offen offset:0 lds
    buffer_load_dwordx4 v29, s[20:23], s38 offen offset:1024 lds
    buffer_load_dwordx4 v30, s[20:23], s38 offen offset:2048 lds
    v_mfma_f32_16x16x32_bf16 v[216:219], v[36:39], v[56:59], v[216:219]
    v_mfma_f32_16x16x32_bf16 v[220:223], v[36:39], v[60:63], v[220:223]
    ds_read_b128 v[32:35], v13 offset:0
    s_waitcnt lgkmcnt(2)
    v_mfma_f32_16x16x32_bf16 v[224:227], v[40:43], v[48:51], v[224:227]
    v_mfma_f32_16x16x32_bf16 v[228:231], v[40:43], v[52:55], v[228:231]
    buffer_load_dwordx4 v31, s[20:23], s38 offen offset:3072 lds
    s_lshl_b32 s37, s32, 11
    s_add_u32 m0, s37, 49152
    v_mfma_f32_16x16x32_bf16 v[232:235], v[40:43], v[56:59], v[232:235]
    v_mfma_f32_16x16x32_bf16 v[236:239], v[40:43], v[60:63], v[236:239]
    ds_read_b128 v[36:39], v13 offset:2048
    s_waitcnt lgkmcnt(2)
    v_mfma_f32_16x16x32_bf16 v[240:243], v[44:47], v[48:51], v[240:243]
    v_mfma_f32_16x16x32_bf16 v[244:247], v[44:47], v[52:55], v[244:247]
    s_mov_b32 s38, 524288
    buffer_load_dwordx4 v124, s[24:27], s38 offen offset:0 lds
    buffer_load_dwordx4 v125, s[24:27], s38 offen offset:1024 lds
    v_mfma_f32_16x16x32_bf16 v[248:251], v[44:47], v[56:59], v[248:251]
    v_mfma_f32_16x16x32_bf16 v[252:255], v[44:47], v[60:63], v[252:255]
    ds_read_b128 v[40:43], v13 offset:4096
    s_waitcnt lgkmcnt(2)
    v_mfma_f32_16x16x32_bf16 v[128:131], v[32:35], v[64:67], v[128:131]
    v_mfma_f32_16x16x32_bf16 v[132:135], v[32:35], v[68:71], v[132:135]
    v_mfma_f32_16x16x32_bf16 v[136:139], v[32:35], v[72:75], v[136:139]
    v_mfma_f32_16x16x32_bf16 v[140:143], v[32:35], v[76:79], v[140:143]
    ds_read_b128 v[44:47], v13 offset:6144
    s_waitcnt lgkmcnt(2)
    v_mfma_f32_16x16x32_bf16 v[144:147], v[36:39], v[64:67], v[144:147]
    v_mfma_f32_16x16x32_bf16 v[148:151], v[36:39], v[68:71], v[148:151]
    v_mfma_f32_16x16x32_bf16 v[152:155], v[36:39], v[72:75], v[152:155]
    v_mfma_f32_16x16x32_bf16 v[156:159], v[36:39], v[76:79], v[156:159]
    ds_read_b128 v[32:35], v13 offset:8192
    s_waitcnt lgkmcnt(2)
    v_mfma_f32_16x16x32_bf16 v[160:163], v[40:43], v[64:67], v[160:163]
    v_mfma_f32_16x16x32_bf16 v[164:167], v[40:43], v[68:71], v[164:167]
    v_mfma_f32_16x16x32_bf16 v[168:171], v[40:43], v[72:75], v[168:171]
    v_mfma_f32_16x16x32_bf16 v[172:175], v[40:43], v[76:79], v[172:175]
    ds_read_b128 v[36:39], v13 offset:10240
    s_waitcnt lgkmcnt(2)
    v_mfma_f32_16x16x32_bf16 v[176:179], v[44:47], v[64:67], v[176:179]
    v_mfma_f32_16x16x32_bf16 v[180:183], v[44:47], v[68:71], v[180:183]
    v_mfma_f32_16x16x32_bf16 v[184:187], v[44:47], v[72:75], v[184:187]
    v_mfma_f32_16x16x32_bf16 v[188:191], v[44:47], v[76:79], v[188:191]
    ds_read_b128 v[40:43], v13 offset:12288
    s_waitcnt lgkmcnt(2)
    v_mfma_f32_16x16x32_bf16 v[192:195], v[32:35], v[64:67], v[192:195]
    v_mfma_f32_16x16x32_bf16 v[196:199], v[32:35], v[68:71], v[196:199]
    v_mfma_f32_16x16x32_bf16 v[200:203], v[32:35], v[72:75], v[200:203]
    v_mfma_f32_16x16x32_bf16 v[204:207], v[32:35], v[76:79], v[204:207]
    ds_read_b128 v[44:47], v13 offset:14336
    s_waitcnt lgkmcnt(2)
    v_mfma_f32_16x16x32_bf16 v[208:211], v[36:39], v[64:67], v[208:211]
    v_mfma_f32_16x16x32_bf16 v[212:215], v[36:39], v[68:71], v[212:215]
    v_mfma_f32_16x16x32_bf16 v[216:219], v[36:39], v[72:75], v[216:219]
    v_mfma_f32_16x16x32_bf16 v[220:223], v[36:39], v[76:79], v[220:223]
    s_waitcnt lgkmcnt(0) vmcnt(6)
    s_barrier
    v_mfma_f32_16x16x32_bf16 v[224:227], v[40:43], v[64:67], v[224:227]
    s_lshl_b32 s37, s32, 12
    v_mfma_f32_16x16x32_bf16 v[228:231], v[40:43], v[68:71], v[228:231]
    s_add_u32 m0, s37, 65536
    s_mov_b32 s38, 256
    v_mfma_f32_16x16x32_bf16 v[232:235], v[40:43], v[72:75], v[232:235]
    buffer_load_dwordx4 v28, s[20:23], s38 offen offset:0 lds
    v_mfma_f32_16x16x32_bf16 v[236:239], v[40:43], v[76:79], v[236:239]
    buffer_load_dwordx4 v29, s[20:23], s38 offen offset:1024 lds
    buffer_load_dwordx4 v30, s[20:23], s38 offen offset:2048 lds
    v_mfma_f32_16x16x32_bf16 v[240:243], v[44:47], v[64:67], v[240:243]
    buffer_load_dwordx4 v31, s[20:23], s38 offen offset:3072 lds
    v_mfma_f32_16x16x32_bf16 v[244:247], v[44:47], v[68:71], v[244:247]
    s_lshl_b32 s37, s32, 11
    s_add_u32 m0, s37, 98304
    v_mfma_f32_16x16x32_bf16 v[248:251], v[44:47], v[72:75], v[248:251]
    s_mov_b32 s38, 1048576
    v_mfma_f32_16x16x32_bf16 v[252:255], v[44:47], v[76:79], v[252:255]
    buffer_load_dwordx4 v124, s[24:27], s38 offen offset:0 lds
    buffer_load_dwordx4 v125, s[24:27], s38 offen offset:1024 lds
    s_and_b32 s38, s32, 2
    s_lshl_b32 s66, s38, 11
    s_add_u32 s66, s66, 16384
    s_add_u32 s67, s66, 2048
    v_cvt_pk_bf16_f32 v32, v128, v129
    v_cvt_pk_bf16_f32 v33, v130, v131
    v_cvt_pk_bf16_f32 v34, v144, v145
    v_cvt_pk_bf16_f32 v35, v146, v147
    v_cvt_pk_bf16_f32 v36, v132, v133
    v_cvt_pk_bf16_f32 v37, v134, v135
    v_cvt_pk_bf16_f32 v38, v148, v149
    v_cvt_pk_bf16_f32 v39, v150, v151
    v_cvt_pk_bf16_f32 v40, v136, v137
    v_cvt_pk_bf16_f32 v41, v138, v139
    v_cvt_pk_bf16_f32 v42, v152, v153
    v_cvt_pk_bf16_f32 v43, v154, v155
    v_cvt_pk_bf16_f32 v44, v140, v141
    v_cvt_pk_bf16_f32 v45, v142, v143
    v_cvt_pk_bf16_f32 v46, v156, v157
    v_cvt_pk_bf16_f32 v47, v158, v159
    v_cvt_pk_bf16_f32 v48, v160, v161
    v_cvt_pk_bf16_f32 v49, v162, v163
    v_cvt_pk_bf16_f32 v50, v176, v177
    v_cvt_pk_bf16_f32 v51, v178, v179
    v_cvt_pk_bf16_f32 v52, v164, v165
    v_cvt_pk_bf16_f32 v53, v166, v167
    v_cvt_pk_bf16_f32 v54, v180, v181
    v_cvt_pk_bf16_f32 v55, v182, v183
    v_cvt_pk_bf16_f32 v56, v168, v169
    v_cvt_pk_bf16_f32 v57, v170, v171
    v_cvt_pk_bf16_f32 v58, v184, v185
    v_cvt_pk_bf16_f32 v59, v186, v187
    v_cvt_pk_bf16_f32 v60, v172, v173
    v_cvt_pk_bf16_f32 v61, v174, v175
    v_cvt_pk_bf16_f32 v62, v188, v189
    v_cvt_pk_bf16_f32 v63, v190, v191
    v_cvt_pk_bf16_f32 v160, v192, v193
    v_cvt_pk_bf16_f32 v161, v194, v195
    v_cvt_pk_bf16_f32 v162, v208, v209
    v_cvt_pk_bf16_f32 v163, v210, v211
    v_cvt_pk_bf16_f32 v164, v196, v197
    v_cvt_pk_bf16_f32 v165, v198, v199
    v_cvt_pk_bf16_f32 v166, v212, v213
    v_cvt_pk_bf16_f32 v167, v214, v215
    v_cvt_pk_bf16_f32 v168, v200, v201
    v_cvt_pk_bf16_f32 v169, v202, v203
    v_cvt_pk_bf16_f32 v170, v216, v217
    v_cvt_pk_bf16_f32 v171, v218, v219
    v_cvt_pk_bf16_f32 v172, v204, v205
    v_cvt_pk_bf16_f32 v173, v206, v207
    v_cvt_pk_bf16_f32 v174, v220, v221
    v_cvt_pk_bf16_f32 v175, v222, v223
    v_cvt_pk_bf16_f32 v176, v224, v225
    v_cvt_pk_bf16_f32 v177, v226, v227
    v_cvt_pk_bf16_f32 v178, v240, v241
    v_cvt_pk_bf16_f32 v179, v242, v243
    v_cvt_pk_bf16_f32 v180, v228, v229
    v_cvt_pk_bf16_f32 v181, v230, v231
    v_cvt_pk_bf16_f32 v182, v244, v245
    v_cvt_pk_bf16_f32 v183, v246, v247
    v_cvt_pk_bf16_f32 v184, v232, v233
    v_cvt_pk_bf16_f32 v185, v234, v235
    v_cvt_pk_bf16_f32 v186, v248, v249
    v_cvt_pk_bf16_f32 v187, v250, v251
    v_cvt_pk_bf16_f32 v188, v236, v237
    v_cvt_pk_bf16_f32 v189, v238, v239
    v_cvt_pk_bf16_f32 v190, v252, v253
    v_cvt_pk_bf16_f32 v191, v254, v255
ka_kernel_qproj:
    v_mov_b32 v127, 0
    buffer_load_dword v126, v127, s[72:75], 0 offen sc1
    s_add_u32 s58, s6, 33554432
    s_addc_u32 s59, s7, 0
    s_mov_b32 s28, s58
    s_and_b32 s29, s59, 0xffff
    s_mov_b32 s30, 16777216
    s_mov_b32 s31, 0x20000
    s_add_u32 s58, s6, 67108864
    s_addc_u32 s59, s7, 0
    s_mov_b32 s72, s58
    s_and_b32 s73, s59, 0xffff
    s_mov_b32 s74, 65536
    s_mov_b32 s75, 0x20000
    s_lshr_b32 s37, s32, 1
    s_lshl_b32 s37, s37, 13
    v_and_b32 v19, 15, v1
    v_lshrrev_b32 v20, 4, v1
    v_bfe_u32 v21, v1, 1, 3
    v_xor_b32 v21, v21, v20
    v_lshlrev_b32 v19, 7, v19
    v_add_u32 v19, s37, v19
    v_lshl_add_u32 v12, v21, 4, v19
    v_xor_b32 v21, 4, v21
    v_lshl_add_u32 v13, v21, 4, v19
    s_mov_b32 s37, 32768
    s_and_b32 s38, s32, 1
    s_lshl_b32 s38, s38, 2
    v_bfe_u32 v19, v1, 2, 2
    v_lshrrev_b32 v20, 4, v1
    v_lshl_add_u32 v21, v20, 3, v19
    v_lshlrev_b32 v21, 8, v21
    v_and_b32 v22, 3, v1
    v_lshl_add_u32 v21, v22, 3, v21
    v_add_u32 v21, s37, v21
    v_and_b32 v20, 1, v20
    v_lshl_or_b32 v19, v20, 2, v19
    s_add_u32 s39, s38, 0
    v_xor_b32 v20, s39, v19
    v_lshl_add_u32 v14, v20, 5, v21
    s_add_u32 s39, s38, 1
    v_xor_b32 v20, s39, v19
    v_lshl_add_u32 v15, v20, 5, v21
    s_add_u32 s39, s38, 2
    v_xor_b32 v20, s39, v19
    v_lshl_add_u32 v16, v20, 5, v21
    s_add_u32 s39, s38, 3
    v_xor_b32 v20, s39, v19
    v_lshl_add_u32 v17, v20, 5, v21
    ds_read_b64_tr_b16 v[80:81], v14 offset:0
    ds_read_b64_tr_b16 v[82:83], v14 offset:1024
    ds_read_b128 v[64:67], v12 offset:0
    ds_read_b64_tr_b16 v[84:85], v15 offset:0
    ds_read_b64_tr_b16 v[86:87], v15 offset:1024
    ds_read_b128 v[68:71], v12 offset:2048
    ds_read_b64_tr_b16 v[88:89], v16 offset:0
    ds_read_b64_tr_b16 v[90:91], v16 offset:1024
    ds_read_b128 v[72:75], v12 offset:4096
    ds_read_b64_tr_b16 v[92:93], v17 offset:0
    ds_read_b64_tr_b16 v[94:95], v17 offset:1024
    ds_read_b128 v[76:79], v12 offset:6144
    s_lshl_b32 s37, s36, 12
    v_add_u32 v4, s37, v2
    s_lshl_b32 s38, s35, 14
    v_add_u32 v5, s38, v2
    v_add_u32 v6, 65536, v5
    s_add_u32 s46, s37, s38
    s_add_u32 s47, s46, 65536
    s_lshl_b32 s42, s33, 20
    s_add_u32 s43, s42, 16384
    s_add_u32 s49, s42, 557056
    s_mov_b32 s44, 0
    s_mov_b32 s45, 0
    s_lshl_b32 s37, s34, 1
    s_add_u32 s37, s37, 2
    s_sub_u32 s38, 15, s34
    s_cmp_eq_u32 s35, 0
    s_cselect_b32 s48, s37, 99
    s_cselect_b32 s40, s37, 17
    s_cselect_b32 s53, s34, s38
    s_cselect_b32 s50, 0, 1
    s_cselect_b32 s54, 1, 0
    s_sub_u32 s40, s40, 1
    s_lshl_b32 s51, s53, 2
    s_sub_u32 s51, 0, s51
    s_mov_b32 s52, 1317011456
    v_mov_b32 v8, 4048155338
    s_lshl_b32 s37, s36, 4
    v_and_b32 v19, 15, v1
    v_lshrrev_b32 v20, 4, v1
    v_lshlrev_b32 v20, 2, v20
    v_sub_u32 v19, v19, v20
    v_add_u32 v7, s37, v19
    s_sub_u32 s37, 112, s37
    v_add_u32 v0, s37, v19
    s_lshl_b32 s55, s36, 1
    s_sub_u32 s55, 7, s55
    s_lshl_b32 s37, s33, 10
    v_and_b32 v10, 7, v1
    v_lshl_add_u32 v10, v10, 7, s37
    s_waitcnt lgkmcnt(0)
    v_mfma_f32_16x16x32_bf16 v[192:195], v[80:83], v[64:67], 0
    ds_read_b64_tr_b16 v[144:145], v14 offset:8192
    v_mfma_f32_16x16x32_bf16 v[196:199], v[84:87], v[64:67], 0
    ds_read_b64_tr_b16 v[146:147], v14 offset:9216
    v_mfma_f32_16x16x32_bf16 v[200:203], v[88:91], v[64:67], 0
    ds_read_b128 v[128:131], v13 offset:0
    v_mfma_f32_16x16x32_bf16 v[204:207], v[92:95], v[64:67], 0
    s_add_u32 s68, s66, 0
    buffer_store_dwordx4 v[32:35], v18, s[16:19], s68 offen offset:0 sc1
    ds_read_b64_tr_b16 v[148:149], v15 offset:8192
    v_mfma_f32_16x16x32_bf16 v[208:211], v[80:83], v[68:71], 0
    ds_read_b64_tr_b16 v[150:151], v15 offset:9216
    v_mfma_f32_16x16x32_bf16 v[212:215], v[84:87], v[68:71], 0
    ds_read_b128 v[132:135], v13 offset:2048
    v_mfma_f32_16x16x32_bf16 v[216:219], v[88:91], v[68:71], 0
    ds_read_b64_tr_b16 v[152:153], v16 offset:8192
    v_mfma_f32_16x16x32_bf16 v[220:223], v[92:95], v[68:71], 0
    ds_read_b64_tr_b16 v[154:155], v16 offset:9216
    v_mfma_f32_16x16x32_bf16 v[224:227], v[80:83], v[72:75], 0
    ds_read_b128 v[136:139], v13 offset:4096
    v_mfma_f32_16x16x32_bf16 v[228:231], v[84:87], v[72:75], 0
    ds_read_b64_tr_b16 v[156:157], v17 offset:8192
    v_mfma_f32_16x16x32_bf16 v[232:235], v[88:91], v[72:75], 0
    ds_read_b64_tr_b16 v[158:159], v17 offset:9216
    v_mfma_f32_16x16x32_bf16 v[236:239], v[92:95], v[72:75], 0
    s_add_u32 s68, s66, 0
    buffer_store_dwordx4 v[36:39], v18, s[16:19], s68 offen offset:1024 sc1
    ds_read_b128 v[140:143], v13 offset:6144
    v_mfma_f32_16x16x32_bf16 v[240:243], v[80:83], v[76:79], 0
    v_mfma_f32_16x16x32_bf16 v[244:247], v[84:87], v[76:79], 0
    v_mfma_f32_16x16x32_bf16 v[248:251], v[88:91], v[76:79], 0
    v_mfma_f32_16x16x32_bf16 v[252:255], v[92:95], v[76:79], 0
    s_waitcnt lgkmcnt(0) vmcnt(9)
    s_barrier
    v_add_u32 v12, 131072, v12
    v_add_u32 v13, 131072, v13
    v_add_u32 v14, 16384, v14
    v_add_u32 v15, 16384, v15
    v_add_u32 v16, 16384, v16
    v_add_u32 v17, 16384, v17
    v_mfma_f32_16x16x32_bf16 v[192:195], v[144:147], v[128:131], v[192:195]
    ds_read_b64_tr_b16 v[80:81], v14 offset:0
    ds_read_b64_tr_b16 v[82:83], v14 offset:1024
    v_mfma_f32_16x16x32_bf16 v[196:199], v[148:151], v[128:131], v[196:199]
    s_add_u32 s68, s67, 0
    buffer_store_dwordx4 v[40:43], v18, s[16:19], s68 offen offset:0 sc1
    ds_read_b128 v[64:67], v12 offset:0
    v_mfma_f32_16x16x32_bf16 v[200:203], v[152:155], v[128:131], v[200:203]
    ds_read_b64_tr_b16 v[84:85], v15 offset:0
    ds_read_b64_tr_b16 v[86:87], v15 offset:1024
    v_mfma_f32_16x16x32_bf16 v[204:207], v[156:159], v[128:131], v[204:207]
    ds_read_b128 v[68:71], v12 offset:2048
    v_mfma_f32_16x16x32_bf16 v[208:211], v[144:147], v[132:135], v[208:211]
    ds_read_b64_tr_b16 v[88:89], v16 offset:0
    ds_read_b64_tr_b16 v[90:91], v16 offset:1024
    v_mfma_f32_16x16x32_bf16 v[212:215], v[148:151], v[132:135], v[212:215]
    s_add_u32 s68, s67, 0
    buffer_store_dwordx4 v[44:47], v18, s[16:19], s68 offen offset:1024 sc1
    ds_read_b128 v[72:75], v12 offset:4096
    v_mfma_f32_16x16x32_bf16 v[216:219], v[152:155], v[132:135], v[216:219]
    ds_read_b64_tr_b16 v[92:93], v17 offset:0
    ds_read_b64_tr_b16 v[94:95], v17 offset:1024
    v_mfma_f32_16x16x32_bf16 v[220:223], v[156:159], v[132:135], v[220:223]
    ds_read_b128 v[76:79], v12 offset:6144
    v_mfma_f32_16x16x32_bf16 v[224:227], v[144:147], v[136:139], v[224:227]
    s_lshl_b32 s37, s32, 12
    s_add_u32 m0, s37, 0
    v_mfma_f32_16x16x32_bf16 v[228:231], v[148:151], v[136:139], v[228:231]
    s_mov_b32 s38, 384
    v_mfma_f32_16x16x32_bf16 v[232:235], v[152:155], v[136:139], v[232:235]
    buffer_load_dwordx4 v28, s[20:23], s38 offen offset:0 lds
    buffer_load_dwordx4 v29, s[20:23], s38 offen offset:1024 lds
    v_mfma_f32_16x16x32_bf16 v[236:239], v[156:159], v[136:139], v[236:239]
    buffer_load_dwordx4 v30, s[20:23], s38 offen offset:2048 lds
    v_mfma_f32_16x16x32_bf16 v[240:243], v[144:147], v[140:143], v[240:243]
    buffer_load_dwordx4 v31, s[20:23], s38 offen offset:3072 lds
    s_lshl_b32 s37, s32, 11
    v_mfma_f32_16x16x32_bf16 v[244:247], v[148:151], v[140:143], v[244:247]
    s_add_u32 m0, s37, 32768
    v_mfma_f32_16x16x32_bf16 v[248:251], v[152:155], v[140:143], v[248:251]
    s_mov_b32 s38, 1572864
    buffer_load_dwordx4 v124, s[24:27], s38 offen offset:0 lds
    v_mfma_f32_16x16x32_bf16 v[252:255], v[156:159], v[140:143], v[252:255]
    buffer_load_dwordx4 v125, s[24:27], s38 offen offset:1024 lds
    s_waitcnt lgkmcnt(0)
    v_mfma_f32_16x16x32_bf16 v[192:195], v[80:83], v[64:67], v[192:195]
    ds_read_b64_tr_b16 v[144:145], v14 offset:8192
    v_mfma_f32_16x16x32_bf16 v[196:199], v[84:87], v[64:67], v[196:199]
    ds_read_b64_tr_b16 v[146:147], v14 offset:9216
    v_mfma_f32_16x16x32_bf16 v[200:203], v[88:91], v[64:67], v[200:203]
    ds_read_b128 v[128:131], v13 offset:0
    v_mfma_f32_16x16x32_bf16 v[204:207], v[92:95], v[64:67], v[204:207]
    s_add_u32 s68, s66, 8192
    buffer_store_dwordx4 v[48:51], v18, s[16:19], s68 offen offset:0 sc1
    ds_read_b64_tr_b16 v[148:149], v15 offset:8192
    v_mfma_f32_16x16x32_bf16 v[208:211], v[80:83], v[68:71], v[208:211]
    ds_read_b64_tr_b16 v[150:151], v15 offset:9216
    v_mfma_f32_16x16x32_bf16 v[212:215], v[84:87], v[68:71], v[212:215]
    ds_read_b128 v[132:135], v13 offset:2048
    v_mfma_f32_16x16x32_bf16 v[216:219], v[88:91], v[68:71], v[216:219]
    ds_read_b64_tr_b16 v[152:153], v16 offset:8192
    v_mfma_f32_16x16x32_bf16 v[220:223], v[92:95], v[68:71], v[220:223]
    ds_read_b64_tr_b16 v[154:155], v16 offset:9216
    v_mfma_f32_16x16x32_bf16 v[224:227], v[80:83], v[72:75], v[224:227]
    ds_read_b128 v[136:139], v13 offset:4096
    v_mfma_f32_16x16x32_bf16 v[228:231], v[84:87], v[72:75], v[228:231]
    ds_read_b64_tr_b16 v[156:157], v17 offset:8192
    v_mfma_f32_16x16x32_bf16 v[232:235], v[88:91], v[72:75], v[232:235]
    ds_read_b64_tr_b16 v[158:159], v17 offset:9216
    v_mfma_f32_16x16x32_bf16 v[236:239], v[92:95], v[72:75], v[236:239]
    s_add_u32 s68, s66, 8192
    buffer_store_dwordx4 v[52:55], v18, s[16:19], s68 offen offset:1024 sc1
    ds_read_b128 v[140:143], v13 offset:6144
    v_mfma_f32_16x16x32_bf16 v[240:243], v[80:83], v[76:79], v[240:243]
    v_mfma_f32_16x16x32_bf16 v[244:247], v[84:87], v[76:79], v[244:247]
    v_mfma_f32_16x16x32_bf16 v[248:251], v[88:91], v[76:79], v[248:251]
    v_mfma_f32_16x16x32_bf16 v[252:255], v[92:95], v[76:79], v[252:255]
    s_waitcnt lgkmcnt(0) vmcnt(13)
    s_barrier
    v_add_u32 v12, 4294901760, v12
    v_add_u32 v13, 4294901760, v13
    v_add_u32 v14, 49152, v14
    v_add_u32 v15, 49152, v15
    v_add_u32 v16, 49152, v16
    v_add_u32 v17, 49152, v17
    v_mfma_f32_16x16x32_bf16 v[192:195], v[144:147], v[128:131], v[192:195]
    ds_read_b64_tr_b16 v[80:81], v14 offset:0
    ds_read_b64_tr_b16 v[82:83], v14 offset:1024
    v_mfma_f32_16x16x32_bf16 v[196:199], v[148:151], v[128:131], v[196:199]
    s_add_u32 s68, s67, 8192
    buffer_store_dwordx4 v[56:59], v18, s[16:19], s68 offen offset:0 sc1
    ds_read_b128 v[64:67], v12 offset:0
    v_mfma_f32_16x16x32_bf16 v[200:203], v[152:155], v[128:131], v[200:203]
    ds_read_b64_tr_b16 v[84:85], v15 offset:0
    ds_read_b64_tr_b16 v[86:87], v15 offset:1024
    v_mfma_f32_16x16x32_bf16 v[204:207], v[156:159], v[128:131], v[204:207]
    ds_read_b128 v[68:71], v12 offset:2048
    v_mfma_f32_16x16x32_bf16 v[208:211], v[144:147], v[132:135], v[208:211]
    ds_read_b64_tr_b16 v[88:89], v16 offset:0
    ds_read_b64_tr_b16 v[90:91], v16 offset:1024
    v_mfma_f32_16x16x32_bf16 v[212:215], v[148:151], v[132:135], v[212:215]
    s_add_u32 s68, s67, 8192
    buffer_store_dwordx4 v[60:63], v18, s[16:19], s68 offen offset:1024 sc1
    ds_read_b128 v[72:75], v12 offset:4096
    v_mfma_f32_16x16x32_bf16 v[216:219], v[152:155], v[132:135], v[216:219]
    ds_read_b64_tr_b16 v[92:93], v17 offset:0
    ds_read_b64_tr_b16 v[94:95], v17 offset:1024
    v_mfma_f32_16x16x32_bf16 v[220:223], v[156:159], v[132:135], v[220:223]
    ds_read_b128 v[76:79], v12 offset:6144
    v_mfma_f32_16x16x32_bf16 v[224:227], v[144:147], v[136:139], v[224:227]
    s_lshl_b32 s37, s32, 12
    s_add_u32 m0, s37, 131072
    v_mfma_f32_16x16x32_bf16 v[228:231], v[148:151], v[136:139], v[228:231]
    s_mov_b32 s38, 512
    v_mfma_f32_16x16x32_bf16 v[232:235], v[152:155], v[136:139], v[232:235]
    buffer_load_dwordx4 v28, s[20:23], s38 offen offset:0 lds
    buffer_load_dwordx4 v29, s[20:23], s38 offen offset:1024 lds
    v_mfma_f32_16x16x32_bf16 v[236:239], v[156:159], v[136:139], v[236:239]
    buffer_load_dwordx4 v30, s[20:23], s38 offen offset:2048 lds
    v_mfma_f32_16x16x32_bf16 v[240:243], v[144:147], v[140:143], v[240:243]
    buffer_load_dwordx4 v31, s[20:23], s38 offen offset:3072 lds
    s_lshl_b32 s37, s32, 11
    v_mfma_f32_16x16x32_bf16 v[244:247], v[148:151], v[140:143], v[244:247]
    s_add_u32 m0, s37, 49152
    v_mfma_f32_16x16x32_bf16 v[248:251], v[152:155], v[140:143], v[248:251]
    s_mov_b32 s38, 2097152
    buffer_load_dwordx4 v124, s[24:27], s38 offen offset:0 lds
    v_mfma_f32_16x16x32_bf16 v[252:255], v[156:159], v[140:143], v[252:255]
    buffer_load_dwordx4 v125, s[24:27], s38 offen offset:1024 lds
    s_waitcnt lgkmcnt(0)
    v_mfma_f32_16x16x32_bf16 v[192:195], v[80:83], v[64:67], v[192:195]
    ds_read_b64_tr_b16 v[144:145], v14 offset:8192
    v_mfma_f32_16x16x32_bf16 v[196:199], v[84:87], v[64:67], v[196:199]
    ds_read_b64_tr_b16 v[146:147], v14 offset:9216
    v_mfma_f32_16x16x32_bf16 v[200:203], v[88:91], v[64:67], v[200:203]
    ds_read_b128 v[128:131], v13 offset:0
    v_mfma_f32_16x16x32_bf16 v[204:207], v[92:95], v[64:67], v[204:207]
    s_add_u32 s68, s66, 32768
    buffer_store_dwordx4 v[160:163], v18, s[16:19], s68 offen offset:0 sc1
    ds_read_b64_tr_b16 v[148:149], v15 offset:8192
    v_mfma_f32_16x16x32_bf16 v[208:211], v[80:83], v[68:71], v[208:211]
    ds_read_b64_tr_b16 v[150:151], v15 offset:9216
    v_mfma_f32_16x16x32_bf16 v[212:215], v[84:87], v[68:71], v[212:215]
    ds_read_b128 v[132:135], v13 offset:2048
    v_mfma_f32_16x16x32_bf16 v[216:219], v[88:91], v[68:71], v[216:219]
    ds_read_b64_tr_b16 v[152:153], v16 offset:8192
    v_mfma_f32_16x16x32_bf16 v[220:223], v[92:95], v[68:71], v[220:223]
    ds_read_b64_tr_b16 v[154:155], v16 offset:9216
    v_mfma_f32_16x16x32_bf16 v[224:227], v[80:83], v[72:75], v[224:227]
    ds_read_b128 v[136:139], v13 offset:4096
    v_mfma_f32_16x16x32_bf16 v[228:231], v[84:87], v[72:75], v[228:231]
    ds_read_b64_tr_b16 v[156:157], v17 offset:8192
    v_mfma_f32_16x16x32_bf16 v[232:235], v[88:91], v[72:75], v[232:235]
    ds_read_b64_tr_b16 v[158:159], v17 offset:9216
    v_mfma_f32_16x16x32_bf16 v[236:239], v[92:95], v[72:75], v[236:239]
    s_add_u32 s68, s66, 32768
    buffer_store_dwordx4 v[164:167], v18, s[16:19], s68 offen offset:1024 sc1
    ds_read_b128 v[140:143], v13 offset:6144
    v_mfma_f32_16x16x32_bf16 v[240:243], v[80:83], v[76:79], v[240:243]
    v_mfma_f32_16x16x32_bf16 v[244:247], v[84:87], v[76:79], v[244:247]
    v_mfma_f32_16x16x32_bf16 v[248:251], v[88:91], v[76:79], v[248:251]
    v_mfma_f32_16x16x32_bf16 v[252:255], v[92:95], v[76:79], v[252:255]
    s_waitcnt lgkmcnt(0) vmcnt(12)
    s_barrier
    v_add_u32 v12, 4294901760, v12
    v_add_u32 v13, 4294901760, v13
    v_add_u32 v14, 4294901760, v14
    v_add_u32 v15, 4294901760, v15
    v_add_u32 v16, 4294901760, v16
    v_add_u32 v17, 4294901760, v17
    v_readfirstlane_b32 s69, v126
    v_mfma_f32_16x16x32_bf16 v[192:195], v[144:147], v[128:131], v[192:195]
    ds_read_b64_tr_b16 v[80:81], v14 offset:0
    ds_read_b64_tr_b16 v[82:83], v14 offset:1024
    v_mfma_f32_16x16x32_bf16 v[196:199], v[148:151], v[128:131], v[196:199]
    s_add_u32 s68, s67, 32768
    buffer_store_dwordx4 v[168:171], v18, s[16:19], s68 offen offset:0 sc1
    ds_read_b128 v[64:67], v12 offset:0
    v_mfma_f32_16x16x32_bf16 v[200:203], v[152:155], v[128:131], v[200:203]
    ds_read_b64_tr_b16 v[84:85], v15 offset:0
    ds_read_b64_tr_b16 v[86:87], v15 offset:1024
    v_mfma_f32_16x16x32_bf16 v[204:207], v[156:159], v[128:131], v[204:207]
    ds_read_b128 v[68:71], v12 offset:2048
    v_mfma_f32_16x16x32_bf16 v[208:211], v[144:147], v[132:135], v[208:211]
    ds_read_b64_tr_b16 v[88:89], v16 offset:0
    ds_read_b64_tr_b16 v[90:91], v16 offset:1024
    v_mfma_f32_16x16x32_bf16 v[212:215], v[148:151], v[132:135], v[212:215]
    s_add_u32 s68, s67, 32768
    buffer_store_dwordx4 v[172:175], v18, s[16:19], s68 offen offset:1024 sc1
    ds_read_b128 v[72:75], v12 offset:4096
    v_mfma_f32_16x16x32_bf16 v[216:219], v[152:155], v[132:135], v[216:219]
    ds_read_b64_tr_b16 v[92:93], v17 offset:0
    ds_read_b64_tr_b16 v[94:95], v17 offset:1024
    v_mfma_f32_16x16x32_bf16 v[220:223], v[156:159], v[132:135], v[220:223]
    ds_read_b128 v[76:79], v12 offset:6144
    v_mfma_f32_16x16x32_bf16 v[224:227], v[144:147], v[136:139], v[224:227]
    s_lshl_b32 s37, s32, 12
    s_add_u32 m0, s37, 65536
    v_mfma_f32_16x16x32_bf16 v[228:231], v[148:151], v[136:139], v[228:231]
    s_mov_b32 s38, 640
    v_mfma_f32_16x16x32_bf16 v[232:235], v[152:155], v[136:139], v[232:235]
    buffer_load_dwordx4 v28, s[20:23], s38 offen offset:0 lds
    buffer_load_dwordx4 v29, s[20:23], s38 offen offset:1024 lds
    v_mfma_f32_16x16x32_bf16 v[236:239], v[156:159], v[136:139], v[236:239]
    buffer_load_dwordx4 v30, s[20:23], s38 offen offset:2048 lds
    v_mfma_f32_16x16x32_bf16 v[240:243], v[144:147], v[140:143], v[240:243]
    buffer_load_dwordx4 v31, s[20:23], s38 offen offset:3072 lds
    s_lshl_b32 s37, s32, 11
    v_mfma_f32_16x16x32_bf16 v[244:247], v[148:151], v[140:143], v[244:247]
    s_add_u32 m0, s37, 98304
    v_mfma_f32_16x16x32_bf16 v[248:251], v[152:155], v[140:143], v[248:251]
    s_mov_b32 s38, 2621440
    buffer_load_dwordx4 v124, s[24:27], s38 offen offset:0 lds
    v_mfma_f32_16x16x32_bf16 v[252:255], v[156:159], v[140:143], v[252:255]
    buffer_load_dwordx4 v125, s[24:27], s38 offen offset:1024 lds
    s_waitcnt lgkmcnt(0)
    v_mfma_f32_16x16x32_bf16 v[192:195], v[80:83], v[64:67], v[192:195]
    ds_read_b64_tr_b16 v[144:145], v14 offset:8192
    v_mfma_f32_16x16x32_bf16 v[196:199], v[84:87], v[64:67], v[196:199]
    ds_read_b64_tr_b16 v[146:147], v14 offset:9216
    v_mfma_f32_16x16x32_bf16 v[200:203], v[88:91], v[64:67], v[200:203]
    ds_read_b128 v[128:131], v13 offset:0
    v_mfma_f32_16x16x32_bf16 v[204:207], v[92:95], v[64:67], v[204:207]
    s_add_u32 s68, s66, 40960
    buffer_store_dwordx4 v[176:179], v18, s[16:19], s68 offen offset:0 sc1
    ds_read_b64_tr_b16 v[148:149], v15 offset:8192
    v_mfma_f32_16x16x32_bf16 v[208:211], v[80:83], v[68:71], v[208:211]
    ds_read_b64_tr_b16 v[150:151], v15 offset:9216
    v_mfma_f32_16x16x32_bf16 v[212:215], v[84:87], v[68:71], v[212:215]
    ds_read_b128 v[132:135], v13 offset:2048
    v_mfma_f32_16x16x32_bf16 v[216:219], v[88:91], v[68:71], v[216:219]
    ds_read_b64_tr_b16 v[152:153], v16 offset:8192
    v_mfma_f32_16x16x32_bf16 v[220:223], v[92:95], v[68:71], v[220:223]
    ds_read_b64_tr_b16 v[154:155], v16 offset:9216
    v_mfma_f32_16x16x32_bf16 v[224:227], v[80:83], v[72:75], v[224:227]
    ds_read_b128 v[136:139], v13 offset:4096
    v_mfma_f32_16x16x32_bf16 v[228:231], v[84:87], v[72:75], v[228:231]
    ds_read_b64_tr_b16 v[156:157], v17 offset:8192
    v_mfma_f32_16x16x32_bf16 v[232:235], v[88:91], v[72:75], v[232:235]
    ds_read_b64_tr_b16 v[158:159], v17 offset:9216
    v_mfma_f32_16x16x32_bf16 v[236:239], v[92:95], v[72:75], v[236:239]
    s_add_u32 s68, s66, 40960
    buffer_store_dwordx4 v[180:183], v18, s[16:19], s68 offen offset:1024 sc1
    ds_read_b128 v[140:143], v13 offset:6144
    v_mfma_f32_16x16x32_bf16 v[240:243], v[80:83], v[76:79], v[240:243]
    v_mfma_f32_16x16x32_bf16 v[244:247], v[84:87], v[76:79], v[244:247]
    v_mfma_f32_16x16x32_bf16 v[248:251], v[88:91], v[76:79], v[248:251]
    v_mfma_f32_16x16x32_bf16 v[252:255], v[92:95], v[76:79], v[252:255]
    s_waitcnt lgkmcnt(0) vmcnt(12)
    s_barrier
    v_add_u32 v12, 131072, v12
    v_add_u32 v13, 131072, v13
    v_add_u32 v14, 16384, v14
    v_add_u32 v15, 16384, v15
    v_add_u32 v16, 16384, v16
    v_add_u32 v17, 16384, v17
    v_mfma_f32_16x16x32_bf16 v[192:195], v[144:147], v[128:131], v[192:195]
    ds_read_b64_tr_b16 v[80:81], v14 offset:0
    ds_read_b64_tr_b16 v[82:83], v14 offset:1024
    v_mfma_f32_16x16x32_bf16 v[196:199], v[148:151], v[128:131], v[196:199]
    s_add_u32 s68, s67, 40960
    buffer_store_dwordx4 v[184:187], v18, s[16:19], s68 offen offset:0 sc1
    ds_read_b128 v[64:67], v12 offset:0
    v_mfma_f32_16x16x32_bf16 v[200:203], v[152:155], v[128:131], v[200:203]
    ds_read_b64_tr_b16 v[84:85], v15 offset:0
    ds_read_b64_tr_b16 v[86:87], v15 offset:1024
    v_mfma_f32_16x16x32_bf16 v[204:207], v[156:159], v[128:131], v[204:207]
    ds_read_b128 v[68:71], v12 offset:2048
    v_mfma_f32_16x16x32_bf16 v[208:211], v[144:147], v[132:135], v[208:211]
    ds_read_b64_tr_b16 v[88:89], v16 offset:0
    ds_read_b64_tr_b16 v[90:91], v16 offset:1024
    v_mfma_f32_16x16x32_bf16 v[212:215], v[148:151], v[132:135], v[212:215]
    s_add_u32 s68, s67, 40960
    buffer_store_dwordx4 v[188:191], v18, s[16:19], s68 offen offset:1024 sc1
    ds_read_b128 v[72:75], v12 offset:4096
    v_mfma_f32_16x16x32_bf16 v[216:219], v[152:155], v[132:135], v[216:219]
    ds_read_b64_tr_b16 v[92:93], v17 offset:0
    ds_read_b64_tr_b16 v[94:95], v17 offset:1024
    v_mfma_f32_16x16x32_bf16 v[220:223], v[156:159], v[132:135], v[220:223]
    ds_read_b128 v[76:79], v12 offset:6144
    v_mfma_f32_16x16x32_bf16 v[224:227], v[144:147], v[136:139], v[224:227]
    s_lshl_b32 s37, s32, 12
    s_add_u32 m0, s37, 0
    v_mfma_f32_16x16x32_bf16 v[228:231], v[148:151], v[136:139], v[228:231]
    s_mov_b32 s38, 768
    v_mfma_f32_16x16x32_bf16 v[232:235], v[152:155], v[136:139], v[232:235]
    buffer_load_dwordx4 v28, s[20:23], s38 offen offset:0 lds
    buffer_load_dwordx4 v29, s[20:23], s38 offen offset:1024 lds
    v_mfma_f32_16x16x32_bf16 v[236:239], v[156:159], v[136:139], v[236:239]
    buffer_load_dwordx4 v30, s[20:23], s38 offen offset:2048 lds
    v_mfma_f32_16x16x32_bf16 v[240:243], v[144:147], v[140:143], v[240:243]
    buffer_load_dwordx4 v31, s[20:23], s38 offen offset:3072 lds
    s_lshl_b32 s37, s32, 11
    v_mfma_f32_16x16x32_bf16 v[244:247], v[148:151], v[140:143], v[244:247]
    s_add_u32 m0, s37, 32768
    v_mfma_f32_16x16x32_bf16 v[248:251], v[152:155], v[140:143], v[248:251]
    s_mov_b32 s38, 3145728
    buffer_load_dwordx4 v124, s[24:27], s38 offen offset:0 lds
    v_mfma_f32_16x16x32_bf16 v[252:255], v[156:159], v[140:143], v[252:255]
    buffer_load_dwordx4 v125, s[24:27], s38 offen offset:1024 lds
    s_waitcnt lgkmcnt(0)
    v_mfma_f32_16x16x32_bf16 v[192:195], v[80:83], v[64:67], v[192:195]
    ds_read_b64_tr_b16 v[144:145], v14 offset:8192
    v_mfma_f32_16x16x32_bf16 v[196:199], v[84:87], v[64:67], v[196:199]
    ds_read_b64_tr_b16 v[146:147], v14 offset:9216
    v_mfma_f32_16x16x32_bf16 v[200:203], v[88:91], v[64:67], v[200:203]
    ds_read_b128 v[128:131], v13 offset:0
    v_mfma_f32_16x16x32_bf16 v[204:207], v[92:95], v[64:67], v[204:207]
    ds_read_b64_tr_b16 v[148:149], v15 offset:8192
    v_mfma_f32_16x16x32_bf16 v[208:211], v[80:83], v[68:71], v[208:211]
    ds_read_b64_tr_b16 v[150:151], v15 offset:9216
    v_mfma_f32_16x16x32_bf16 v[212:215], v[84:87], v[68:71], v[212:215]
    ds_read_b128 v[132:135], v13 offset:2048
    v_mfma_f32_16x16x32_bf16 v[216:219], v[88:91], v[68:71], v[216:219]
    ds_read_b64_tr_b16 v[152:153], v16 offset:8192
    v_mfma_f32_16x16x32_bf16 v[220:223], v[92:95], v[68:71], v[220:223]
    ds_read_b64_tr_b16 v[154:155], v16 offset:9216
    v_mfma_f32_16x16x32_bf16 v[224:227], v[80:83], v[72:75], v[224:227]
    ds_read_b128 v[136:139], v13 offset:4096
    v_mfma_f32_16x16x32_bf16 v[228:231], v[84:87], v[72:75], v[228:231]
    ds_read_b64_tr_b16 v[156:157], v17 offset:8192
    v_mfma_f32_16x16x32_bf16 v[232:235], v[88:91], v[72:75], v[232:235]
    ds_read_b64_tr_b16 v[158:159], v17 offset:9216
    v_mfma_f32_16x16x32_bf16 v[236:239], v[92:95], v[72:75], v[236:239]
    ds_read_b128 v[140:143], v13 offset:6144
    v_mfma_f32_16x16x32_bf16 v[240:243], v[80:83], v[76:79], v[240:243]
    v_mfma_f32_16x16x32_bf16 v[244:247], v[84:87], v[76:79], v[244:247]
    v_mfma_f32_16x16x32_bf16 v[248:251], v[88:91], v[76:79], v[248:251]
    v_mfma_f32_16x16x32_bf16 v[252:255], v[92:95], v[76:79], v[252:255]
    s_waitcnt lgkmcnt(0) vmcnt(10)
    s_barrier
    v_add_u32 v12, 4294901760, v12
    v_add_u32 v13, 4294901760, v13
    v_add_u32 v14, 49152, v14
    v_add_u32 v15, 49152, v15
    v_add_u32 v16, 49152, v16
    v_add_u32 v17, 49152, v17
    v_mfma_f32_16x16x32_bf16 v[192:195], v[144:147], v[128:131], v[192:195]
    ds_read_b64_tr_b16 v[80:81], v14 offset:0
    ds_read_b64_tr_b16 v[82:83], v14 offset:1024
    v_mfma_f32_16x16x32_bf16 v[196:199], v[148:151], v[128:131], v[196:199]
    ds_read_b128 v[64:67], v12 offset:0
    v_mfma_f32_16x16x32_bf16 v[200:203], v[152:155], v[128:131], v[200:203]
    ds_read_b64_tr_b16 v[84:85], v15 offset:0
    ds_read_b64_tr_b16 v[86:87], v15 offset:1024
    v_mfma_f32_16x16x32_bf16 v[204:207], v[156:159], v[128:131], v[204:207]
    ds_read_b128 v[68:71], v12 offset:2048
    v_mfma_f32_16x16x32_bf16 v[208:211], v[144:147], v[132:135], v[208:211]
    ds_read_b64_tr_b16 v[88:89], v16 offset:0
    ds_read_b64_tr_b16 v[90:91], v16 offset:1024
    v_mfma_f32_16x16x32_bf16 v[212:215], v[148:151], v[132:135], v[212:215]
    ds_read_b128 v[72:75], v12 offset:4096
    v_mfma_f32_16x16x32_bf16 v[216:219], v[152:155], v[132:135], v[216:219]
    ds_read_b64_tr_b16 v[92:93], v17 offset:0
    ds_read_b64_tr_b16 v[94:95], v17 offset:1024
    v_mfma_f32_16x16x32_bf16 v[220:223], v[156:159], v[132:135], v[220:223]
    ds_read_b128 v[76:79], v12 offset:6144
    v_mfma_f32_16x16x32_bf16 v[224:227], v[144:147], v[136:139], v[224:227]
    s_lshl_b32 s37, s32, 12
    s_add_u32 m0, s37, 131072
    v_mfma_f32_16x16x32_bf16 v[228:231], v[148:151], v[136:139], v[228:231]
    s_mov_b32 s38, 896
    v_mfma_f32_16x16x32_bf16 v[232:235], v[152:155], v[136:139], v[232:235]
    buffer_load_dwordx4 v28, s[20:23], s38 offen offset:0 lds
    buffer_load_dwordx4 v29, s[20:23], s38 offen offset:1024 lds
    v_mfma_f32_16x16x32_bf16 v[236:239], v[156:159], v[136:139], v[236:239]
    buffer_load_dwordx4 v30, s[20:23], s38 offen offset:2048 lds
    v_mfma_f32_16x16x32_bf16 v[240:243], v[144:147], v[140:143], v[240:243]
    buffer_load_dwordx4 v31, s[20:23], s38 offen offset:3072 lds
    s_lshl_b32 s37, s32, 11
    v_mfma_f32_16x16x32_bf16 v[244:247], v[148:151], v[140:143], v[244:247]
    s_add_u32 m0, s37, 49152
    v_mfma_f32_16x16x32_bf16 v[248:251], v[152:155], v[140:143], v[248:251]
    s_mov_b32 s38, 3670016
    buffer_load_dwordx4 v124, s[24:27], s38 offen offset:0 lds
    v_mfma_f32_16x16x32_bf16 v[252:255], v[156:159], v[140:143], v[252:255]
    buffer_load_dwordx4 v125, s[24:27], s38 offen offset:1024 lds
    s_waitcnt lgkmcnt(0)
    v_mfma_f32_16x16x32_bf16 v[192:195], v[80:83], v[64:67], v[192:195]
    ds_read_b64_tr_b16 v[144:145], v14 offset:8192
    v_mfma_f32_16x16x32_bf16 v[196:199], v[84:87], v[64:67], v[196:199]
    ds_read_b64_tr_b16 v[146:147], v14 offset:9216
    v_mfma_f32_16x16x32_bf16 v[200:203], v[88:91], v[64:67], v[200:203]
    ds_read_b128 v[128:131], v13 offset:0
    v_mfma_f32_16x16x32_bf16 v[204:207], v[92:95], v[64:67], v[204:207]
    ds_read_b64_tr_b16 v[148:149], v15 offset:8192
    v_mfma_f32_16x16x32_bf16 v[208:211], v[80:83], v[68:71], v[208:211]
    ds_read_b64_tr_b16 v[150:151], v15 offset:9216
    v_mfma_f32_16x16x32_bf16 v[212:215], v[84:87], v[68:71], v[212:215]
    ds_read_b128 v[132:135], v13 offset:2048
    v_mfma_f32_16x16x32_bf16 v[216:219], v[88:91], v[68:71], v[216:219]
    ds_read_b64_tr_b16 v[152:153], v16 offset:8192
    v_mfma_f32_16x16x32_bf16 v[220:223], v[92:95], v[68:71], v[220:223]
    ds_read_b64_tr_b16 v[154:155], v16 offset:9216
    v_mfma_f32_16x16x32_bf16 v[224:227], v[80:83], v[72:75], v[224:227]
    ds_read_b128 v[136:139], v13 offset:4096
    v_mfma_f32_16x16x32_bf16 v[228:231], v[84:87], v[72:75], v[228:231]
    ds_read_b64_tr_b16 v[156:157], v17 offset:8192
    v_mfma_f32_16x16x32_bf16 v[232:235], v[88:91], v[72:75], v[232:235]
    ds_read_b64_tr_b16 v[158:159], v17 offset:9216
    v_mfma_f32_16x16x32_bf16 v[236:239], v[92:95], v[72:75], v[236:239]
    ds_read_b128 v[140:143], v13 offset:6144
    v_mfma_f32_16x16x32_bf16 v[240:243], v[80:83], v[76:79], v[240:243]
    v_mfma_f32_16x16x32_bf16 v[244:247], v[84:87], v[76:79], v[244:247]
    v_mfma_f32_16x16x32_bf16 v[248:251], v[88:91], v[76:79], v[248:251]
    v_mfma_f32_16x16x32_bf16 v[252:255], v[92:95], v[76:79], v[252:255]
    s_waitcnt lgkmcnt(0) vmcnt(6)
    s_barrier
    v_add_u32 v12, 4294901760, v12
    v_add_u32 v13, 4294901760, v13
    v_add_u32 v14, 4294901760, v14
    v_add_u32 v15, 4294901760, v15
    v_add_u32 v16, 4294901760, v16
    v_add_u32 v17, 4294901760, v17
    s_cmp_lg_u32 s32, 7
    s_cbranch_scc1 ka_kernel_sig_9
    v_mov_b32 v9, s69
    s_lshl_b32 s37, s34, 7
    s_mov_b64 exec, 1
    buffer_store_dword v9, v10, s[72:75], s37 offen sc1
    s_mov_b64 exec, -1
ka_kernel_sig_9:
    v_mfma_f32_16x16x32_bf16 v[192:195], v[144:147], v[128:131], v[192:195]
    ds_read_b64_tr_b16 v[80:81], v14 offset:0
    ds_read_b64_tr_b16 v[82:83], v14 offset:1024
    v_mfma_f32_16x16x32_bf16 v[196:199], v[148:151], v[128:131], v[196:199]
    ds_read_b128 v[64:67], v12 offset:0
    v_mfma_f32_16x16x32_bf16 v[200:203], v[152:155], v[128:131], v[200:203]
    ds_read_b64_tr_b16 v[84:85], v15 offset:0
    ds_read_b64_tr_b16 v[86:87], v15 offset:1024
    v_mfma_f32_16x16x32_bf16 v[204:207], v[156:159], v[128:131], v[204:207]
    ds_read_b128 v[68:71], v12 offset:2048
    v_mfma_f32_16x16x32_bf16 v[208:211], v[144:147], v[132:135], v[208:211]
    ds_read_b64_tr_b16 v[88:89], v16 offset:0
    ds_read_b64_tr_b16 v[90:91], v16 offset:1024
    v_mfma_f32_16x16x32_bf16 v[212:215], v[148:151], v[132:135], v[212:215]
    ds_read_b128 v[72:75], v12 offset:4096
    v_mfma_f32_16x16x32_bf16 v[216:219], v[152:155], v[132:135], v[216:219]
    ds_read_b64_tr_b16 v[92:93], v17 offset:0
    ds_read_b64_tr_b16 v[94:95], v17 offset:1024
    v_mfma_f32_16x16x32_bf16 v[220:223], v[156:159], v[132:135], v[220:223]
    ds_read_b128 v[76:79], v12 offset:6144
    v_mfma_f32_16x16x32_bf16 v[224:227], v[144:147], v[136:139], v[224:227]
    s_lshl_b32 s37, s32, 12
    s_add_u32 m0, s37, 65536
    v_mfma_f32_16x16x32_bf16 v[228:231], v[148:151], v[136:139], v[228:231]
    s_mov_b32 s38, 1024
    v_mfma_f32_16x16x32_bf16 v[232:235], v[152:155], v[136:139], v[232:235]
    buffer_load_dwordx4 v28, s[20:23], s38 offen offset:0 lds
    buffer_load_dwordx4 v29, s[20:23], s38 offen offset:1024 lds
    v_mfma_f32_16x16x32_bf16 v[236:239], v[156:159], v[136:139], v[236:239]
    buffer_load_dwordx4 v30, s[20:23], s38 offen offset:2048 lds
    v_mfma_f32_16x16x32_bf16 v[240:243], v[144:147], v[140:143], v[240:243]
    buffer_load_dwordx4 v31, s[20:23], s38 offen offset:3072 lds
    s_lshl_b32 s37, s32, 11
    v_mfma_f32_16x16x32_bf16 v[244:247], v[148:151], v[140:143], v[244:247]
    s_add_u32 m0, s37, 98304
    v_mfma_f32_16x16x32_bf16 v[248:251], v[152:155], v[140:143], v[248:251]
    s_mov_b32 s38, 4194304
    buffer_load_dwordx4 v124, s[24:27], s38 offen offset:0 lds
    v_mfma_f32_16x16x32_bf16 v[252:255], v[156:159], v[140:143], v[252:255]
    buffer_load_dwordx4 v125, s[24:27], s38 offen offset:1024 lds
    s_waitcnt lgkmcnt(0)
    v_mfma_f32_16x16x32_bf16 v[192:195], v[80:83], v[64:67], v[192:195]
    ds_read_b64_tr_b16 v[144:145], v14 offset:8192
    v_mfma_f32_16x16x32_bf16 v[196:199], v[84:87], v[64:67], v[196:199]
    ds_read_b64_tr_b16 v[146:147], v14 offset:9216
    v_mfma_f32_16x16x32_bf16 v[200:203], v[88:91], v[64:67], v[200:203]
    ds_read_b128 v[128:131], v13 offset:0
    v_mfma_f32_16x16x32_bf16 v[204:207], v[92:95], v[64:67], v[204:207]
    ds_read_b64_tr_b16 v[148:149], v15 offset:8192
    v_mfma_f32_16x16x32_bf16 v[208:211], v[80:83], v[68:71], v[208:211]
    ds_read_b64_tr_b16 v[150:151], v15 offset:9216
    v_mfma_f32_16x16x32_bf16 v[212:215], v[84:87], v[68:71], v[212:215]
    ds_read_b128 v[132:135], v13 offset:2048
    v_mfma_f32_16x16x32_bf16 v[216:219], v[88:91], v[68:71], v[216:219]
    ds_read_b64_tr_b16 v[152:153], v16 offset:8192
    v_mfma_f32_16x16x32_bf16 v[220:223], v[92:95], v[68:71], v[220:223]
    ds_read_b64_tr_b16 v[154:155], v16 offset:9216
    v_mfma_f32_16x16x32_bf16 v[224:227], v[80:83], v[72:75], v[224:227]
    ds_read_b128 v[136:139], v13 offset:4096
    v_mfma_f32_16x16x32_bf16 v[228:231], v[84:87], v[72:75], v[228:231]
    ds_read_b64_tr_b16 v[156:157], v17 offset:8192
    v_mfma_f32_16x16x32_bf16 v[232:235], v[88:91], v[72:75], v[232:235]
    ds_read_b64_tr_b16 v[158:159], v17 offset:9216
    v_mfma_f32_16x16x32_bf16 v[236:239], v[92:95], v[72:75], v[236:239]
    ds_read_b128 v[140:143], v13 offset:6144
    v_mfma_f32_16x16x32_bf16 v[240:243], v[80:83], v[76:79], v[240:243]
    v_mfma_f32_16x16x32_bf16 v[244:247], v[84:87], v[76:79], v[244:247]
    v_mfma_f32_16x16x32_bf16 v[248:251], v[88:91], v[76:79], v[248:251]
    v_mfma_f32_16x16x32_bf16 v[252:255], v[92:95], v[76:79], v[252:255]
    s_waitcnt lgkmcnt(0) vmcnt(6)
    s_barrier
    v_add_u32 v12, 131072, v12
    v_add_u32 v13, 131072, v13
    v_add_u32 v14, 16384, v14
    v_add_u32 v15, 16384, v15
    v_add_u32 v16, 16384, v16
    v_add_u32 v17, 16384, v17
    s_cmp_lg_u32 s32, 7
    s_cbranch_scc1 ka_kernel_pl_10
    buffer_load_dword v9, v10, s[72:75], 0 offen sc1
ka_kernel_pl_10:
    v_mfma_f32_16x16x32_bf16 v[192:195], v[144:147], v[128:131], v[192:195]
    ds_read_b64_tr_b16 v[80:81], v14 offset:0
    ds_read_b64_tr_b16 v[82:83], v14 offset:1024
    v_mfma_f32_16x16x32_bf16 v[196:199], v[148:151], v[128:131], v[196:199]
    ds_read_b128 v[64:67], v12 offset:0
    v_mfma_f32_16x16x32_bf16 v[200:203], v[152:155], v[128:131], v[200:203]
    ds_read_b64_tr_b16 v[84:85], v15 offset:0
    ds_read_b64_tr_b16 v[86:87], v15 offset:1024
    v_mfma_f32_16x16x32_bf16 v[204:207], v[156:159], v[128:131], v[204:207]
    ds_read_b128 v[68:71], v12 offset:2048
    v_mfma_f32_16x16x32_bf16 v[208:211], v[144:147], v[132:135], v[208:211]
    ds_read_b64_tr_b16 v[88:89], v16 offset:0
    ds_read_b64_tr_b16 v[90:91], v16 offset:1024
    v_mfma_f32_16x16x32_bf16 v[212:215], v[148:151], v[132:135], v[212:215]
    ds_read_b128 v[72:75], v12 offset:4096
    v_mfma_f32_16x16x32_bf16 v[216:219], v[152:155], v[132:135], v[216:219]
    ds_read_b64_tr_b16 v[92:93], v17 offset:0
    ds_read_b64_tr_b16 v[94:95], v17 offset:1024
    v_mfma_f32_16x16x32_bf16 v[220:223], v[156:159], v[132:135], v[220:223]
    ds_read_b128 v[76:79], v12 offset:6144
    v_mfma_f32_16x16x32_bf16 v[224:227], v[144:147], v[136:139], v[224:227]
    v_mfma_f32_16x16x32_bf16 v[228:231], v[148:151], v[136:139], v[228:231]
    v_mfma_f32_16x16x32_bf16 v[232:235], v[152:155], v[136:139], v[232:235]
    v_mfma_f32_16x16x32_bf16 v[236:239], v[156:159], v[136:139], v[236:239]
    v_mfma_f32_16x16x32_bf16 v[240:243], v[144:147], v[140:143], v[240:243]
    v_mfma_f32_16x16x32_bf16 v[244:247], v[148:151], v[140:143], v[244:247]
    v_mfma_f32_16x16x32_bf16 v[248:251], v[152:155], v[140:143], v[248:251]
    v_mfma_f32_16x16x32_bf16 v[252:255], v[156:159], v[140:143], v[252:255]
    s_waitcnt lgkmcnt(0)
    v_mfma_f32_16x16x32_bf16 v[192:195], v[80:83], v[64:67], v[192:195]
    ds_read_b64_tr_b16 v[144:145], v14 offset:8192
    v_mfma_f32_16x16x32_bf16 v[196:199], v[84:87], v[64:67], v[196:199]
    ds_read_b64_tr_b16 v[146:147], v14 offset:9216
    v_mfma_f32_16x16x32_bf16 v[200:203], v[88:91], v[64:67], v[200:203]
    ds_read_b128 v[128:131], v13 offset:0
    v_mfma_f32_16x16x32_bf16 v[204:207], v[92:95], v[64:67], v[204:207]
    ds_read_b64_tr_b16 v[148:149], v15 offset:8192
    v_mfma_f32_16x16x32_bf16 v[208:211], v[80:83], v[68:71], v[208:211]
    ds_read_b64_tr_b16 v[150:151], v15 offset:9216
    v_mfma_f32_16x16x32_bf16 v[212:215], v[84:87], v[68:71], v[212:215]
    ds_read_b128 v[132:135], v13 offset:2048
    v_mfma_f32_16x16x32_bf16 v[216:219], v[88:91], v[68:71], v[216:219]
    ds_read_b64_tr_b16 v[152:153], v16 offset:8192
    v_mfma_f32_16x16x32_bf16 v[220:223], v[92:95], v[68:71], v[220:223]
    ds_read_b64_tr_b16 v[154:155], v16 offset:9216
    v_mfma_f32_16x16x32_bf16 v[224:227], v[80:83], v[72:75], v[224:227]
    ds_read_b128 v[136:139], v13 offset:4096
    v_mfma_f32_16x16x32_bf16 v[228:231], v[84:87], v[72:75], v[228:231]
    ds_read_b64_tr_b16 v[156:157], v17 offset:8192
    v_mfma_f32_16x16x32_bf16 v[232:235], v[88:91], v[72:75], v[232:235]
    ds_read_b64_tr_b16 v[158:159], v17 offset:9216
    v_mfma_f32_16x16x32_bf16 v[236:239], v[92:95], v[72:75], v[236:239]
    ds_read_b128 v[140:143], v13 offset:6144
    v_mfma_f32_16x16x32_bf16 v[240:243], v[80:83], v[76:79], v[240:243]
    v_mfma_f32_16x16x32_bf16 v[244:247], v[84:87], v[76:79], v[244:247]
    v_mfma_f32_16x16x32_bf16 v[248:251], v[88:91], v[76:79], v[248:251]
    v_mfma_f32_16x16x32_bf16 v[252:255], v[92:95], v[76:79], v[252:255]
    s_cmp_eq_u32 s32, 7
    s_cbranch_scc1 ka_kernel_nw7_11
    s_waitcnt vmcnt(0)
ka_kernel_nw7_11:
    s_waitcnt lgkmcnt(0) vmcnt(1)
    s_barrier
    v_add_u32 v12, 4294901760, v12
    v_add_u32 v13, 4294901760, v13
    v_add_u32 v14, 49152, v14
    v_add_u32 v15, 49152, v15
    v_add_u32 v16, 49152, v16
    v_add_u32 v17, 49152, v17
    v_mfma_f32_16x16x32_bf16 v[192:195], v[144:147], v[128:131], v[192:195]
    ds_read_b64_tr_b16 v[80:81], v14 offset:0
    ds_read_b64_tr_b16 v[82:83], v14 offset:1024
    v_mfma_f32_16x16x32_bf16 v[196:199], v[148:151], v[128:131], v[196:199]
    ds_read_b128 v[64:67], v12 offset:0
    v_mfma_f32_16x16x32_bf16 v[200:203], v[152:155], v[128:131], v[200:203]
    ds_read_b64_tr_b16 v[84:85], v15 offset:0
    ds_read_b64_tr_b16 v[86:87], v15 offset:1024
    v_mfma_f32_16x16x32_bf16 v[204:207], v[156:159], v[128:131], v[204:207]
    ds_read_b128 v[68:71], v12 offset:2048
    v_mfma_f32_16x16x32_bf16 v[208:211], v[144:147], v[132:135], v[208:211]
    ds_read_b64_tr_b16 v[88:89], v16 offset:0
    ds_read_b64_tr_b16 v[90:91], v16 offset:1024
    v_mfma_f32_16x16x32_bf16 v[212:215], v[148:151], v[132:135], v[212:215]
    ds_read_b128 v[72:75], v12 offset:4096
    v_mfma_f32_16x16x32_bf16 v[216:219], v[152:155], v[132:135], v[216:219]
    ds_read_b64_tr_b16 v[92:93], v17 offset:0
    ds_read_b64_tr_b16 v[94:95], v17 offset:1024
    v_mfma_f32_16x16x32_bf16 v[220:223], v[156:159], v[132:135], v[220:223]
    ds_read_b128 v[76:79], v12 offset:6144
    v_mfma_f32_16x16x32_bf16 v[224:227], v[144:147], v[136:139], v[224:227]
    v_mfma_f32_16x16x32_bf16 v[228:231], v[148:151], v[136:139], v[228:231]
    v_mfma_f32_16x16x32_bf16 v[232:235], v[152:155], v[136:139], v[232:235]
    v_mfma_f32_16x16x32_bf16 v[236:239], v[156:159], v[136:139], v[236:239]
    v_mfma_f32_16x16x32_bf16 v[240:243], v[144:147], v[140:143], v[240:243]
    v_mfma_f32_16x16x32_bf16 v[244:247], v[148:151], v[140:143], v[244:247]
    v_mfma_f32_16x16x32_bf16 v[248:251], v[152:155], v[140:143], v[248:251]
    v_mfma_f32_16x16x32_bf16 v[252:255], v[156:159], v[140:143], v[252:255]
    s_waitcnt lgkmcnt(0)
    v_mfma_f32_16x16x32_bf16 v[192:195], v[80:83], v[64:67], v[192:195]
    ds_read_b64_tr_b16 v[144:145], v14 offset:8192
    v_mfma_f32_16x16x32_bf16 v[196:199], v[84:87], v[64:67], v[196:199]
    ds_read_b64_tr_b16 v[146:147], v14 offset:9216
    v_mfma_f32_16x16x32_bf16 v[200:203], v[88:91], v[64:67], v[200:203]
    ds_read_b128 v[128:131], v13 offset:0
    v_mfma_f32_16x16x32_bf16 v[204:207], v[92:95], v[64:67], v[204:207]
    ds_read_b64_tr_b16 v[148:149], v15 offset:8192
    v_mfma_f32_16x16x32_bf16 v[208:211], v[80:83], v[68:71], v[208:211]
    ds_read_b64_tr_b16 v[150:151], v15 offset:9216
    v_mfma_f32_16x16x32_bf16 v[212:215], v[84:87], v[68:71], v[212:215]
    ds_read_b128 v[132:135], v13 offset:2048
    v_mfma_f32_16x16x32_bf16 v[216:219], v[88:91], v[68:71], v[216:219]
    ds_read_b64_tr_b16 v[152:153], v16 offset:8192
    v_mfma_f32_16x16x32_bf16 v[220:223], v[92:95], v[68:71], v[220:223]
    ds_read_b64_tr_b16 v[154:155], v16 offset:9216
    v_mfma_f32_16x16x32_bf16 v[224:227], v[80:83], v[72:75], v[224:227]
    ds_read_b128 v[136:139], v13 offset:4096
    v_mfma_f32_16x16x32_bf16 v[228:231], v[84:87], v[72:75], v[228:231]
    ds_read_b64_tr_b16 v[156:157], v17 offset:8192
    v_mfma_f32_16x16x32_bf16 v[232:235], v[88:91], v[72:75], v[232:235]
    ds_read_b64_tr_b16 v[158:159], v17 offset:9216
    v_mfma_f32_16x16x32_bf16 v[236:239], v[92:95], v[72:75], v[236:239]
    ds_read_b128 v[140:143], v13 offset:6144
    v_mfma_f32_16x16x32_bf16 v[240:243], v[80:83], v[76:79], v[240:243]
    v_mfma_f32_16x16x32_bf16 v[244:247], v[84:87], v[76:79], v[244:247]
    v_mfma_f32_16x16x32_bf16 v[248:251], v[88:91], v[76:79], v[248:251]
    v_mfma_f32_16x16x32_bf16 v[252:255], v[92:95], v[76:79], v[252:255]
    s_waitcnt vmcnt(0)
    s_cmp_lg_u32 s32, 7
    s_cbranch_scc1 ka_kernel_nw7_12
    s_mov_b32 s38, 0
ka_kernel_poll_13:
    v_cmp_ne_u32 vcc, s69, v9
    s_add_u32 s38, s38, 1
    s_cbranch_vccz ka_kernel_nw7_12
    s_cmp_ge_u32 s38, 0x40000
    s_cbranch_scc1 ka_kernel_nw7_12
    buffer_load_dword v9, v10, s[72:75], 0 offen sc1
    s_waitcnt vmcnt(0)
    s_branch ka_kernel_poll_13
ka_kernel_nw7_12:
    s_waitcnt lgkmcnt(0)
    s_barrier
    v_mfma_f32_16x16x32_bf16 v[192:195], v[144:147], v[128:131], v[192:195]
    s_mov_b32 m0, s46
    s_nop 0
    buffer_load_dwordx4 v4, s[16:19], s42 offen offset:0 sc1 lds
    buffer_load_dwordx4 v4, s[16:19], s42 offen offset:1024 sc1 lds
    v_mfma_f32_16x16x32_bf16 v[196:199], v[148:151], v[128:131], v[196:199]
    buffer_load_dwordx4 v4, s[16:19], s42 offen offset:2048 sc1 lds
    buffer_load_dwordx4 v4, s[16:19], s42 offen offset:3072 sc1 lds
    s_xor_b32 s46, s46, 0x8000
    v_mfma_f32_16x16x32_bf16 v[200:203], v[152:155], v[128:131], v[200:203]
    s_add_u32 s44, s44, 1
    s_add_u32 s42, s42, 32768
    s_add_u32 s39, s49, 0
    s_cmp_eq_u32 s44, s48
    v_mfma_f32_16x16x32_bf16 v[204:207], v[156:159], v[128:131], v[204:207]
    s_cselect_b32 s42, s39, s42
    s_cmp_ge_u32 s44, 17
    s_cselect_b32 s42, 2146435072, s42
    v_mfma_f32_16x16x32_bf16 v[208:211], v[144:147], v[132:135], v[208:211]
    s_mov_b32 m0, s46
    s_nop 0
    buffer_load_dwordx4 v4, s[16:19], s42 offen offset:0 sc1 lds
    buffer_load_dwordx4 v4, s[16:19], s42 offen offset:1024 sc1 lds
    v_mfma_f32_16x16x32_bf16 v[212:215], v[148:151], v[132:135], v[212:215]
    buffer_load_dwordx4 v4, s[16:19], s42 offen offset:2048 sc1 lds
    buffer_load_dwordx4 v4, s[16:19], s42 offen offset:3072 sc1 lds
    s_xor_b32 s46, s46, 0x8000
    v_mfma_f32_16x16x32_bf16 v[216:219], v[152:155], v[132:135], v[216:219]
    s_add_u32 s44, s44, 1
    s_add_u32 s42, s42, 32768
    s_add_u32 s39, s49, 0
    s_cmp_eq_u32 s44, s48
    v_mfma_f32_16x16x32_bf16 v[220:223], v[156:159], v[132:135], v[220:223]
    s_cselect_b32 s42, s39, s42
    s_cmp_ge_u32 s44, 17
    s_cselect_b32 s42, 2146435072, s42
    v_mfma_f32_16x16x32_bf16 v[224:227], v[144:147], v[136:139], v[224:227]
    s_mov_b32 m0, s47
    s_nop 0
    buffer_load_dwordx4 v4, s[16:19], s43 offen offset:0 sc1 lds
    buffer_load_dwordx4 v4, s[16:19], s43 offen offset:1024 sc1 lds
    v_mfma_f32_16x16x32_bf16 v[228:231], v[148:151], v[136:139], v[228:231]
    buffer_load_dwordx4 v4, s[16:19], s43 offen offset:2048 sc1 lds
    buffer_load_dwordx4 v4, s[16:19], s43 offen offset:3072 sc1 lds
    s_xor_b32 s47, s47, 0x8000
    v_mfma_f32_16x16x32_bf16 v[232:235], v[152:155], v[136:139], v[232:235]
    s_add_u32 s45, s45, 1
    s_add_u32 s43, s43, 32768
    s_add_u32 s39, s49, 16384
    s_cmp_eq_u32 s45, s48
    v_mfma_f32_16x16x32_bf16 v[236:239], v[156:159], v[136:139], v[236:239]
    s_cselect_b32 s43, s39, s43
    s_cmp_ge_u32 s45, 17
    s_cselect_b32 s43, 2146435072, s43
    v_mfma_f32_16x16x32_bf16 v[240:243], v[144:147], v[140:143], v[240:243]
    v_mfma_f32_16x16x32_bf16 v[244:247], v[148:151], v[140:143], v[244:247]
    v_mfma_f32_16x16x32_bf16 v[248:251], v[152:155], v[140:143], v[248:251]
    v_mfma_f32_16x16x32_bf16 v[252:255], v[156:159], v[140:143], v[252:255]
    s_lshr_b32 s37, s32, 1
    s_and_b32 s38, s37, 1
    s_lshl_b32 s38, s38, 14
    s_lshl_b32 s37, s35, 15
    s_sub_u32 s37, s38, s37
    s_and_b32 s38, s32, 1
    s_lshl_b32 s38, s38, 11
    s_add_u32 s37, s37, s38
    s_add_u32 s37, s37, 131072
    v_add_u32 v19, s37, v2
    s_mov_b32 s38, 1040356334
    v_mov_b32 v22, 1040356334
    v_mov_b32 v23, 1040356334
    s_nop 2
    v_pk_mul_f32 v[192:193], v[192:193], v[22:23]
    v_pk_mul_f32 v[194:195], v[194:195], v[22:23]
    v_pk_mul_f32 v[196:197], v[196:197], v[22:23]
    v_pk_mul_f32 v[198:199], v[198:199], v[22:23]
    v_cvt_pk_bf16_f32 v72, v192, v193
    v_cvt_pk_bf16_f32 v73, v194, v195
    v_cvt_pk_bf16_f32 v74, v196, v197
    v_cvt_pk_bf16_f32 v75, v198, v199
    ds_write_b128 v19, v[72:75] offset:0
    v_pk_mul_f32 v[200:201], v[200:201], v[22:23]
    v_pk_mul_f32 v[202:203], v[202:203], v[22:23]
    v_pk_mul_f32 v[204:205], v[204:205], v[22:23]
    v_pk_mul_f32 v[206:207], v[206:207], v[22:23]
    v_cvt_pk_bf16_f32 v76, v200, v201
    v_cvt_pk_bf16_f32 v77, v202, v203
    v_cvt_pk_bf16_f32 v78, v204, v205
    v_cvt_pk_bf16_f32 v79, v206, v207
    ds_write_b128 v19, v[76:79] offset:1024
    v_pk_mul_f32 v[208:209], v[208:209], v[22:23]
    v_pk_mul_f32 v[210:211], v[210:211], v[22:23]
    v_pk_mul_f32 v[212:213], v[212:213], v[22:23]
    v_pk_mul_f32 v[214:215], v[214:215], v[22:23]
    v_cvt_pk_bf16_f32 v80, v208, v209
    v_cvt_pk_bf16_f32 v81, v210, v211
    v_cvt_pk_bf16_f32 v82, v212, v213
    v_cvt_pk_bf16_f32 v83, v214, v215
    ds_write_b128 v19, v[80:83] offset:4096
    v_pk_mul_f32 v[216:217], v[216:217], v[22:23]
    v_pk_mul_f32 v[218:219], v[218:219], v[22:23]
    v_pk_mul_f32 v[220:221], v[220:221], v[22:23]
    v_pk_mul_f32 v[222:223], v[222:223], v[22:23]
    v_cvt_pk_bf16_f32 v84, v216, v217
    v_cvt_pk_bf16_f32 v85, v218, v219
    v_cvt_pk_bf16_f32 v86, v220, v221
    v_cvt_pk_bf16_f32 v87, v222, v223
    ds_write_b128 v19, v[84:87] offset:5120
    v_pk_mul_f32 v[224:225], v[224:225], v[22:23]
    v_pk_mul_f32 v[226:227], v[226:227], v[22:23]
    v_pk_mul_f32 v[228:229], v[228:229], v[22:23]
    v_pk_mul_f32 v[230:231], v[230:231], v[22:23]
    v_cvt_pk_bf16_f32 v72, v224, v225
    v_cvt_pk_bf16_f32 v73, v226, v227
    v_cvt_pk_bf16_f32 v74, v228, v229
    v_cvt_pk_bf16_f32 v75, v230, v231
    ds_write_b128 v19, v[72:75] offset:8192
    v_pk_mul_f32 v[232:233], v[232:233], v[22:23]
    v_pk_mul_f32 v[234:235], v[234:235], v[22:23]
    v_pk_mul_f32 v[236:237], v[236:237], v[22:23]
    v_pk_mul_f32 v[238:239], v[238:239], v[22:23]
    v_cvt_pk_bf16_f32 v76, v232, v233
    v_cvt_pk_bf16_f32 v77, v234, v235
    v_cvt_pk_bf16_f32 v78, v236, v237
    v_cvt_pk_bf16_f32 v79, v238, v239
    ds_write_b128 v19, v[76:79] offset:9216
    v_pk_mul_f32 v[240:241], v[240:241], v[22:23]
    v_pk_mul_f32 v[242:243], v[242:243], v[22:23]
    v_pk_mul_f32 v[244:245], v[244:245], v[22:23]
    v_pk_mul_f32 v[246:247], v[246:247], v[22:23]
    v_cvt_pk_bf16_f32 v80, v240, v241
    v_cvt_pk_bf16_f32 v81, v242, v243
    v_cvt_pk_bf16_f32 v82, v244, v245
    v_cvt_pk_bf16_f32 v83, v246, v247
    ds_write_b128 v19, v[80:83] offset:12288
    v_pk_mul_f32 v[248:249], v[248:249], v[22:23]
    v_pk_mul_f32 v[250:251], v[250:251], v[22:23]
    v_pk_mul_f32 v[252:253], v[252:253], v[22:23]
    v_pk_mul_f32 v[254:255], v[254:255], v[22:23]
    v_cvt_pk_bf16_f32 v84, v248, v249
    v_cvt_pk_bf16_f32 v85, v250, v251
    v_cvt_pk_bf16_f32 v86, v252, v253
    v_cvt_pk_bf16_f32 v87, v254, v255
    ds_write_b128 v19, v[84:87] offset:13312
    s_waitcnt lgkmcnt(0) vmcnt(8)
    s_barrier
    s_lshl_b32 s37, s36, 12
    s_lshl_b32 s38, s35, 15
    s_add_u32 s37, s37, s38
    s_add_u32 s37, s37, 98304
    v_add_u32 v19, s37, v2
    s_lshl_b32 s38, s55, 12
    v_add_u32 v20, s38, v19
    ds_read_b128 v[160:163], v19 offset:0
    ds_read_b128 v[164:167], v19 offset:1024
    ds_read_b128 v[168:171], v19 offset:2048
    ds_read_b128 v[172:175], v19 offset:3072
    ds_read_b128 v[176:179], v20 offset:0
    ds_read_b128 v[180:183], v20 offset:1024
    ds_read_b128 v[184:187], v20 offset:2048
    ds_read_b128 v[188:191], v20 offset:3072
    s_cmp_eq_u32 s35, 0
    s_cbranch_scc1 ka_kernel_np
    s_setprio 1
ka_kernel_np:
    s_and_b32 s37, s2, 7
    s_add_u32 s37, s37, s34
    s_mul_i32 s38, s37, 52
    s_lshr_b32 s38, s38, 8
    s_mul_i32 s38, s38, 5
    s_sub_u32 s37, s37, s38
    s_lshl_b32 s64, s37, 1
    s_add_u32 s64, s64, 1
    s_mov_b32 s65, 0
    s_add_u32 s37, s64, 3
    s_cmp_eq_u32 s32, 7
    s_cselect_b32 s64, s37, s64
    s_cselect_b32 s65, 2, 0
    s_lshl_b32 s37, s34, 1
    s_add_u32 s37, s37, 2
    s_min_u32 s37, s37, 14
    s_cmp_eq_u32 s32, 6
    s_cselect_b32 s64, s37, s64
    s_cselect_b32 s65, 5, s65
ka_kernel_seg:
    ds_read_b128 v[72:75], v5 offset:0
    ds_read_b128 v[76:79], v5 offset:1024
    ds_read_b128 v[80:83], v5 offset:2048
    ds_read_b128 v[84:87], v5 offset:3072
    ds_read_b128 v[88:91], v5 offset:4096
    s_waitcnt lgkmcnt(4)
    v_mfma_f32_16x16x32_bf16 v[128:131], v[72:75], v[160:163], 0
    v_mov_b32 v192, 0
    v_mov_b32 v193, 0
    v_mov_b32 v194, 0
    v_mov_b32 v195, 0
    v_mfma_f32_16x16x32_bf16 v[132:135], v[72:75], v[176:179], 0
    v_mov_b32 v196, 0
    v_mov_b32 v197, 0
    v_mov_b32 v198, 0
    v_mov_b32 v199, 0
    ds_read_b128 v[92:95], v5 offset:5120
    s_waitcnt lgkmcnt(4)
    v_mfma_f32_16x16x32_bf16 v[128:131], v[76:79], v[164:167], v[128:131]
    v_mov_b32 v200, 0
    v_mov_b32 v201, 0
    v_mov_b32 v202, 0
    v_mov_b32 v203, 0
    v_mfma_f32_16x16x32_bf16 v[132:135], v[76:79], v[180:183], v[132:135]
    v_mov_b32 v204, 0
    v_mov_b32 v205, 0
    v_mov_b32 v206, 0
    v_mov_b32 v207, 0
    ds_read_b128 v[96:99], v5 offset:6144
    s_waitcnt lgkmcnt(4)
    v_mfma_f32_16x16x32_bf16 v[128:131], v[80:83], v[168:171], v[128:131]
    v_mov_b32 v208, 0
    v_mov_b32 v209, 0
    v_mov_b32 v210, 0
    v_mov_b32 v211, 0
    v_mfma_f32_16x16x32_bf16 v[132:135], v[80:83], v[184:187], v[132:135]
    v_mov_b32 v212, 0
    v_mov_b32 v213, 0
    v_mov_b32 v214, 0
    v_mov_b32 v215, 0
    ds_read_b128 v[100:103], v5 offset:7168
    s_waitcnt lgkmcnt(4)
    v_mfma_f32_16x16x32_bf16 v[128:131], v[84:87], v[172:175], v[128:131]
    v_mov_b32 v216, 0
    v_mov_b32 v217, 0
    v_mov_b32 v218, 0
    v_mov_b32 v219, 0
    v_mov_b32 v220, 0
    v_mfma_f32_16x16x32_bf16 v[132:135], v[84:87], v[188:191], v[132:135]
    v_mov_b32 v221, 0
    v_mov_b32 v222, 0
    v_mov_b32 v223, 0
    v_mov_b32 v224, 0
    ds_read_b128 v[72:75], v5 offset:8192
    s_waitcnt lgkmcnt(4)
    v_mfma_f32_16x16x32_bf16 v[136:139], v[88:91], v[160:163], 0
    v_mov_b32 v225, 0
    v_mov_b32 v226, 0
    v_mov_b32 v227, 0
    v_mov_b32 v228, 0
    v_mfma_f32_16x16x32_bf16 v[140:143], v[88:91], v[176:179], 0
    v_mov_b32 v229, 0
    v_mov_b32 v230, 0
    v_mov_b32 v231, 0
    v_mov_b32 v232, 0
    ds_read_b128 v[76:79], v5 offset:9216
    s_waitcnt lgkmcnt(4)
    v_mfma_f32_16x16x32_bf16 v[136:139], v[92:95], v[164:167], v[136:139]
    v_mov_b32 v233, 0
    v_mov_b32 v234, 0
    v_mov_b32 v235, 0
    v_mov_b32 v236, 0
    v_mfma_f32_16x16x32_bf16 v[140:143], v[92:95], v[180:183], v[140:143]
    v_mov_b32 v237, 0
    v_mov_b32 v238, 0
    v_mov_b32 v239, 0
    v_mov_b32 v240, 0
    ds_read_b128 v[80:83], v5 offset:10240
    s_waitcnt lgkmcnt(4)
    v_mfma_f32_16x16x32_bf16 v[136:139], v[96:99], v[168:171], v[136:139]
    v_mov_b32 v241, 0
    v_mov_b32 v242, 0
    v_mov_b32 v243, 0
    v_mov_b32 v244, 0
    v_mfma_f32_16x16x32_bf16 v[140:143], v[96:99], v[184:187], v[140:143]
    v_mov_b32 v245, 0
    v_mov_b32 v246, 0
    v_mov_b32 v247, 0
    v_mov_b32 v248, 0
    ds_read_b128 v[84:87], v5 offset:11264
    s_waitcnt lgkmcnt(4)
    v_mfma_f32_16x16x32_bf16 v[136:139], v[100:103], v[172:175], v[136:139]
    v_mov_b32 v249, 0
    v_mov_b32 v250, 0
    v_mov_b32 v251, 0
    v_mov_b32 v252, 0
    v_mov_b32 v253, 0
    v_mfma_f32_16x16x32_bf16 v[140:143], v[100:103], v[188:191], v[140:143]
    v_mov_b32 v254, 0
    v_mov_b32 v255, 0
    v_mov_b32 v40, 0
    v_mov_b32 v41, 0
    ds_read_b128 v[88:91], v5 offset:12288
    s_nop 3
    s_cmp_ge_i32 s51, 0
    s_cbranch_scc1 ka_kernel_mask_14
ka_kernel_mret_15:
    s_add_u32 s51, s51, 1
    v_max3_f32 v42, v128, v129, v130
    v_max3_f32 v42, v42, v131, v136
    v_max3_f32 v42, v42, v137, v138
    v_max_f32 v42, v42, v139
    v_max3_f32 v43, v132, v133, v134
    v_max3_f32 v43, v43, v135, v140
    v_max3_f32 v43, v43, v141, v142
    v_max_f32 v43, v43, v143
    v_mov_b32 v23, v42
    v_mov_b32 v24, v43
    s_nop 1
    v_permlane16_swap_b32 v42, v23
    v_permlane16_swap_b32 v43, v24
    v_max_f32 v42, v42, v23
    v_max_f32 v43, v43, v24
    v_mov_b32 v23, v42
    v_mov_b32 v24, v43
    s_nop 1
    v_permlane32_swap_b32 v42, v23
    v_permlane32_swap_b32 v43, v24
    v_max_f32 v42, v42, v23
    v_max_f32 v43, v43, v24
    v_sub_f32 v104, 0, v42
    v_sub_f32 v105, 0, v42
    v_sub_f32 v106, 0, v42
    v_sub_f32 v107, 0, v42
    v_sub_f32 v108, 0, v43
    v_sub_f32 v109, 0, v43
    v_sub_f32 v110, 0, v43
    v_sub_f32 v111, 0, v43
    s_waitcnt lgkmcnt(4)
    v_mfma_f32_16x16x32_bf16 v[144:147], v[72:75], v[160:163], v[104:107]
    v_sub_f32 v128, v128, v42
    v_sub_f32 v129, v129, v42
    v_sub_f32 v130, v130, v42
    v_mfma_f32_16x16x32_bf16 v[148:151], v[72:75], v[176:179], v[108:111]
    v_sub_f32 v131, v131, v42
    v_sub_f32 v136, v136, v42
    v_sub_f32 v137, v137, v42
    ds_read_b128 v[92:95], v5 offset:13312
    s_waitcnt lgkmcnt(4)
    v_mfma_f32_16x16x32_bf16 v[144:147], v[76:79], v[164:167], v[144:147]
    v_sub_f32 v138, v138, v42
    v_sub_f32 v139, v139, v42
    v_sub_f32 v132, v132, v43
    v_sub_f32 v133, v133, v43
    v_mfma_f32_16x16x32_bf16 v[148:151], v[76:79], v[180:183], v[148:151]
    v_sub_f32 v134, v134, v43
    v_sub_f32 v135, v135, v43
    v_sub_f32 v140, v140, v43
    ds_read_b128 v[96:99], v5 offset:14336
    s_waitcnt lgkmcnt(4)
    v_mfma_f32_16x16x32_bf16 v[144:147], v[80:83], v[168:171], v[144:147]
    v_sub_f32 v141, v141, v43
    v_sub_f32 v142, v142, v43
    v_sub_f32 v143, v143, v43
    v_exp_f32 v46, v128
    v_mfma_f32_16x16x32_bf16 v[148:151], v[80:83], v[184:187], v[148:151]
    v_exp_f32 v47, v129
    v_exp_f32 v48, v130
    v_add_f32 v44, v46, v47
    ds_read_b128 v[100:103], v5 offset:15360
    s_waitcnt lgkmcnt(4)
    v_mfma_f32_16x16x32_bf16 v[144:147], v[84:87], v[172:175], v[144:147]
    v_exp_f32 v49, v131
    v_cvt_pk_bf16_f32 v112, v46, v47
    v_exp_f32 v50, v136
    v_add_f32 v44, v44, v48
    v_mfma_f32_16x16x32_bf16 v[148:151], v[84:87], v[188:191], v[148:151]
    v_exp_f32 v51, v137
    v_cvt_pk_bf16_f32 v113, v48, v49
    v_add_f32 v44, v44, v49
    s_waitcnt lgkmcnt(3)
    v_mfma_f32_16x16x32_bf16 v[152:155], v[88:91], v[160:163], v[104:107]
    v_exp_f32 v52, v138
    v_add_f32 v44, v44, v50
    v_exp_f32 v53, v139
    v_cvt_pk_bf16_f32 v114, v50, v51
    v_mfma_f32_16x16x32_bf16 v[156:159], v[88:91], v[176:179], v[108:111]
    v_add_f32 v44, v44, v51
    v_exp_f32 v46, v132
    v_add_f32 v44, v44, v52
    s_waitcnt lgkmcnt(0)
    s_cmp_lg_u32 s44, 2
    s_cbranch_scc1 ka_kernel_wa_16
    s_waitcnt vmcnt(0)
ka_kernel_wa_16:
    s_waitcnt vmcnt(8)
    s_barrier
    v_xor_b32 v5, 0x8000, v5
    ds_read_b128 v[72:75], v6 offset:0
    ds_read_b128 v[76:79], v6 offset:1024
    v_mfma_f32_16x16x32_bf16 v[152:155], v[92:95], v[164:167], v[152:155]
    v_exp_f32 v47, v133
    v_cvt_pk_bf16_f32 v115, v52, v53
    v_add_f32 v44, v44, v53
    v_exp_f32 v48, v134
    v_mfma_f32_16x16x32_bf16 v[156:159], v[92:95], v[180:183], v[156:159]
    v_add_f32 v45, v46, v47
    v_exp_f32 v49, v135
    v_cvt_pk_bf16_f32 v116, v46, v47
    ds_read_b128 v[80:83], v6 offset:2048
    v_mfma_f32_16x16x32_bf16 v[152:155], v[96:99], v[168:171], v[152:155]
    v_exp_f32 v50, v140
    v_add_f32 v45, v45, v48
    v_exp_f32 v51, v141
    v_cvt_pk_bf16_f32 v117, v48, v49
    v_mfma_f32_16x16x32_bf16 v[156:159], v[96:99], v[184:187], v[156:159]
    v_add_f32 v45, v45, v49
    v_exp_f32 v52, v142
    v_add_f32 v45, v45, v50
    ds_read_b128 v[84:87], v6 offset:3072
    v_mfma_f32_16x16x32_bf16 v[152:155], v[100:103], v[172:175], v[152:155]
    v_exp_f32 v53, v143
    v_cvt_pk_bf16_f32 v118, v50, v51
    v_add_f32 v45, v45, v51
    s_nop 0
    v_mfma_f32_16x16x32_bf16 v[156:159], v[100:103], v[188:191], v[156:159]
    v_add_f32 v45, v45, v52
    v_cvt_pk_bf16_f32 v119, v52, v53
    v_add_f32 v45, v45, v53
    ds_read_b128 v[88:91], v6 offset:4096
    s_mov_b32 s41, s54
    s_cmp_eq_u32 s40, 0
    s_cbranch_scc1 ka_kernel_tailh
    s_cmp_ge_u32 s41, s40
    s_cbranch_scc1 ka_kernel_lasth
ka_kernel_try:
    s_sub_u32 s37, s40, s41
    s_sub_u32 s38, -1, s51
    s_ashr_i32 s38, s38, 1
    s_min_i32 s37, s37, s38
    s_sub_u32 s38, s64, s45
    s_min_u32 s38, s38, 99
    s_min_i32 s37, s37, s38
    s_cmp_le_i32 s37, 0
    s_cbranch_scc1 ka_kernel_loop
    s_add_u32 s23, s45, s37
    s_add_u32 s41, s41, s37
    s_add_u32 s44, s44, s37
    s_lshl_b32 s37, s37, 1
    s_add_u32 s51, s51, s37
ka_kernel_lean:
    s_waitcnt lgkmcnt(3)
    v_mfma_f32_16x16x32_bf16 v[192:195], v[72:75], v[112:115], v[192:195]
    v_add_f32 v40, v40, v44
    v_add_f32 v41, v41, v45
    s_mov_b32 m0, s46
    v_mfma_f32_16x16x32_bf16 v[196:199], v[72:75], v[116:119], v[196:199]
    s_nop 0
    buffer_load_dwordx4 v4, s[16:19], s42 offen offset:0 sc1 lds
    ds_read_b128 v[92:95], v6 offset:5120
    v_mfma_f32_16x16x32_bf16 v[200:203], v[76:79], v[112:115], v[200:203]
    v_mfma_f32_16x16x32_bf16 v[204:207], v[76:79], v[116:119], v[204:207]
    ds_read_b128 v[96:99], v6 offset:6144
    s_waitcnt lgkmcnt(3)
    v_mfma_f32_16x16x32_bf16 v[208:211], v[80:83], v[112:115], v[208:211]
    v_exp_f32 v46, v144
    v_exp_f32 v47, v145
    v_mfma_f32_16x16x32_bf16 v[212:215], v[80:83], v[116:119], v[212:215]
    buffer_load_dwordx4 v4, s[16:19], s42 offen offset:1024 sc1 lds
    ds_read_b128 v[100:103], v6 offset:7168
    v_mfma_f32_16x16x32_bf16 v[216:219], v[84:87], v[112:115], v[216:219]
    v_exp_f32 v48, v146
    v_add_f32 v44, v46, v47
    v_mfma_f32_16x16x32_bf16 v[220:223], v[84:87], v[116:119], v[220:223]
    v_exp_f32 v49, v147
    ds_read_b128 v[72:75], v5 offset:0
    s_waitcnt lgkmcnt(3)
    v_mfma_f32_16x16x32_bf16 v[224:227], v[88:91], v[112:115], v[224:227]
    v_cvt_pk_bf16_f32 v120, v46, v47
    v_exp_f32 v50, v152
    v_mfma_f32_16x16x32_bf16 v[228:231], v[88:91], v[116:119], v[228:231]
    v_add_f32 v44, v44, v48
    buffer_load_dwordx4 v4, s[16:19], s42 offen offset:2048 sc1 lds
    ds_read_b128 v[76:79], v5 offset:1024
    v_mfma_f32_16x16x32_bf16 v[232:235], v[92:95], v[112:115], v[232:235]
    v_exp_f32 v51, v153
    v_cvt_pk_bf16_f32 v121, v48, v49
    v_mfma_f32_16x16x32_bf16 v[236:239], v[92:95], v[116:119], v[236:239]
    v_add_f32 v44, v44, v49
    ds_read_b128 v[80:83], v5 offset:2048
    s_waitcnt lgkmcnt(3)
    v_mfma_f32_16x16x32_bf16 v[240:243], v[96:99], v[112:115], v[240:243]
    v_exp_f32 v52, v154
    v_add_f32 v44, v44, v50
    v_mfma_f32_16x16x32_bf16 v[244:247], v[96:99], v[116:119], v[244:247]
    buffer_load_dwordx4 v4, s[16:19], s42 offen offset:3072 sc1 lds
    ds_read_b128 v[84:87], v5 offset:3072
    v_mfma_f32_16x16x32_bf16 v[248:251], v[100:103], v[112:115], v[248:251]
    v_exp_f32 v53, v155
    v_cvt_pk_bf16_f32 v122, v50, v51
    v_mfma_f32_16x16x32_bf16 v[252:255], v[100:103], v[116:119], v[252:255]
    v_add_f32 v44, v44, v51
    ds_read_b128 v[88:91], v5 offset:4096
    s_waitcnt lgkmcnt(3)
    v_mfma_f32_16x16x32_bf16 v[128:131], v[72:75], v[160:163], v[104:107]
    v_exp_f32 v46, v148
    v_add_f32 v44, v44, v52
    v_mfma_f32_16x16x32_bf16 v[132:135], v[72:75], v[176:179], v[108:111]
    v_exp_f32 v47, v149
    ds_read_b128 v[92:95], v5 offset:5120
    v_mfma_f32_16x16x32_bf16 v[128:131], v[76:79], v[164:167], v[128:131]
    v_cvt_pk_bf16_f32 v123, v52, v53
    v_add_f32 v44, v44, v53
    v_mfma_f32_16x16x32_bf16 v[132:135], v[76:79], v[180:183], v[132:135]
    v_exp_f32 v48, v150
    ds_read_b128 v[96:99], v5 offset:6144
    s_waitcnt lgkmcnt(3)
    v_mfma_f32_16x16x32_bf16 v[128:131], v[80:83], v[168:171], v[128:131]
    v_add_f32 v45, v46, v47
    v_exp_f32 v49, v151
    v_mfma_f32_16x16x32_bf16 v[132:135], v[80:83], v[184:187], v[132:135]
    v_cvt_pk_bf16_f32 v124, v46, v47
    ds_read_b128 v[100:103], v5 offset:7168
    v_mfma_f32_16x16x32_bf16 v[128:131], v[84:87], v[172:175], v[128:131]
    v_exp_f32 v50, v156
    v_mfma_f32_16x16x32_bf16 v[132:135], v[84:87], v[188:191], v[132:135]
    v_add_f32 v45, v45, v48
    ds_read_b128 v[72:75], v6 offset:8192
    s_waitcnt lgkmcnt(3)
    v_mfma_f32_16x16x32_bf16 v[136:139], v[88:91], v[160:163], v[104:107]
    v_exp_f32 v51, v157
    v_cvt_pk_bf16_f32 v125, v48, v49
    v_mfma_f32_16x16x32_bf16 v[140:143], v[88:91], v[176:179], v[108:111]
    v_add_f32 v45, v45, v49
    ds_read_b128 v[76:79], v6 offset:9216
    v_mfma_f32_16x16x32_bf16 v[136:139], v[92:95], v[164:167], v[136:139]
    v_exp_f32 v52, v158
    v_add_f32 v45, v45, v50
    v_mfma_f32_16x16x32_bf16 v[140:143], v[92:95], v[180:183], v[140:143]
    v_exp_f32 v53, v159
    ds_read_b128 v[80:83], v6 offset:10240
    s_waitcnt lgkmcnt(3)
    v_mfma_f32_16x16x32_bf16 v[136:139], v[96:99], v[168:171], v[136:139]
    v_cvt_pk_bf16_f32 v126, v50, v51
    v_add_f32 v45, v45, v51
    v_mfma_f32_16x16x32_bf16 v[140:143], v[96:99], v[184:187], v[140:143]
    s_nop 0
    ds_read_b128 v[84:87], v6 offset:11264
    v_mfma_f32_16x16x32_bf16 v[136:139], v[100:103], v[172:175], v[136:139]
    v_add_f32 v45, v45, v52
    v_cvt_pk_bf16_f32 v127, v52, v53
    v_mfma_f32_16x16x32_bf16 v[140:143], v[100:103], v[188:191], v[140:143]
    v_add_f32 v45, v45, v53
    ds_read_b128 v[88:91], v6 offset:12288
    v_add_f32 v19, v44, v45
    v_cmp_nge_f32 vcc, s52, v19
    s_cbranch_vccnz ka_kernel_rare_17
ka_kernel_ret_18:
    s_waitcnt lgkmcnt(3)
    v_mfma_f32_16x16x32_bf16 v[192:195], v[72:75], v[120:123], v[192:195]
    v_add_f32 v40, v40, v44
    v_add_f32 v41, v41, v45
    s_mov_b32 m0, s47
    v_mfma_f32_16x16x32_bf16 v[196:199], v[72:75], v[124:127], v[196:199]
    s_nop 0
    buffer_load_dwordx4 v4, s[16:19], s43 offen offset:0 sc1 lds
    ds_read_b128 v[92:95], v6 offset:13312
    v_mfma_f32_16x16x32_bf16 v[200:203], v[76:79], v[120:123], v[200:203]
    v_mfma_f32_16x16x32_bf16 v[204:207], v[76:79], v[124:127], v[204:207]
    ds_read_b128 v[96:99], v6 offset:14336
    s_waitcnt lgkmcnt(3)
    v_mfma_f32_16x16x32_bf16 v[208:211], v[80:83], v[120:123], v[208:211]
    v_exp_f32 v46, v128
    v_exp_f32 v47, v129
    v_mfma_f32_16x16x32_bf16 v[212:215], v[80:83], v[124:127], v[212:215]
    buffer_load_dwordx4 v4, s[16:19], s43 offen offset:1024 sc1 lds
    ds_read_b128 v[100:103], v6 offset:15360
    v_mfma_f32_16x16x32_bf16 v[216:219], v[84:87], v[120:123], v[216:219]
    v_exp_f32 v48, v130
    v_add_f32 v44, v46, v47
    v_mfma_f32_16x16x32_bf16 v[220:223], v[84:87], v[124:127], v[220:223]
    v_exp_f32 v49, v131
    ds_read_b128 v[72:75], v5 offset:8192
    s_waitcnt lgkmcnt(3)
    v_mfma_f32_16x16x32_bf16 v[224:227], v[88:91], v[120:123], v[224:227]
    v_cvt_pk_bf16_f32 v112, v46, v47
    v_exp_f32 v50, v136
    v_mfma_f32_16x16x32_bf16 v[228:231], v[88:91], v[124:127], v[228:231]
    v_add_f32 v44, v44, v48
    buffer_load_dwordx4 v4, s[16:19], s43 offen offset:2048 sc1 lds
    ds_read_b128 v[76:79], v5 offset:9216
    v_mfma_f32_16x16x32_bf16 v[232:235], v[92:95], v[120:123], v[232:235]
    v_exp_f32 v51, v137
    v_cvt_pk_bf16_f32 v113, v48, v49
    v_mfma_f32_16x16x32_bf16 v[236:239], v[92:95], v[124:127], v[236:239]
    v_add_f32 v44, v44, v49
    ds_read_b128 v[80:83], v5 offset:10240
    s_waitcnt lgkmcnt(3)
    v_mfma_f32_16x16x32_bf16 v[240:243], v[96:99], v[120:123], v[240:243]
    v_exp_f32 v52, v138
    v_add_f32 v44, v44, v50
    v_mfma_f32_16x16x32_bf16 v[244:247], v[96:99], v[124:127], v[244:247]
    buffer_load_dwordx4 v4, s[16:19], s43 offen offset:3072 sc1 lds
    ds_read_b128 v[84:87], v5 offset:11264
    v_mfma_f32_16x16x32_bf16 v[248:251], v[100:103], v[120:123], v[248:251]
    v_exp_f32 v53, v139
    v_cvt_pk_bf16_f32 v114, v50, v51
    v_mfma_f32_16x16x32_bf16 v[252:255], v[100:103], v[124:127], v[252:255]
    v_add_f32 v44, v44, v51
    s_add_u32 s43, s42, 16384
    ds_read_b128 v[88:91], v5 offset:12288
    s_waitcnt lgkmcnt(3)
    v_mfma_f32_16x16x32_bf16 v[144:147], v[72:75], v[160:163], v[104:107]
    v_exp_f32 v46, v132
    v_add_f32 v44, v44, v52
    v_mfma_f32_16x16x32_bf16 v[148:151], v[72:75], v[176:179], v[108:111]
    v_exp_f32 v47, v133
    s_xor_b32 s46, s46, 0x8000
    ds_read_b128 v[92:95], v5 offset:13312
    v_mfma_f32_16x16x32_bf16 v[144:147], v[76:79], v[164:167], v[144:147]
    v_cvt_pk_bf16_f32 v115, v52, v53
    v_add_f32 v44, v44, v53
    v_mfma_f32_16x16x32_bf16 v[148:151], v[76:79], v[180:183], v[148:151]
    v_exp_f32 v48, v134
    s_xor_b32 s47, s47, 0x8000
    ds_read_b128 v[96:99], v5 offset:14336
    s_waitcnt lgkmcnt(3)
    v_mfma_f32_16x16x32_bf16 v[144:147], v[80:83], v[168:171], v[144:147]
    v_add_f32 v45, v46, v47
    v_exp_f32 v49, v135
    v_cvt_pk_bf16_f32 v116, v46, v47
    v_mfma_f32_16x16x32_bf16 v[148:151], v[80:83], v[184:187], v[148:151]
    s_add_u32 s45, s45, 1
    s_add_u32 s42, s42, 32768
    ds_read_b128 v[100:103], v5 offset:15360
    v_mfma_f32_16x16x32_bf16 v[144:147], v[84:87], v[172:175], v[144:147]
    v_exp_f32 v50, v140
    v_mfma_f32_16x16x32_bf16 v[148:151], v[84:87], v[188:191], v[148:151]
    v_add_f32 v45, v45, v48
    s_waitcnt lgkmcnt(2)
    v_mfma_f32_16x16x32_bf16 v[152:155], v[88:91], v[160:163], v[104:107]
    v_exp_f32 v51, v141
    v_cvt_pk_bf16_f32 v117, v48, v49
    v_mfma_f32_16x16x32_bf16 v[156:159], v[88:91], v[176:179], v[108:111]
    v_add_f32 v45, v45, v49
    s_waitcnt lgkmcnt(0) vmcnt(0)
    s_barrier
    v_xor_b32 v5, 0x8000, v5
    v_xor_b32 v6, 0x8000, v6
    ds_read_b128 v[72:75], v6 offset:0
    ds_read_b128 v[76:79], v6 offset:1024
    v_mfma_f32_16x16x32_bf16 v[152:155], v[92:95], v[164:167], v[152:155]
    v_exp_f32 v52, v142
    v_add_f32 v45, v45, v50
    v_mfma_f32_16x16x32_bf16 v[156:159], v[92:95], v[180:183], v[156:159]
    v_exp_f32 v53, v143
    ds_read_b128 v[80:83], v6 offset:2048
    v_mfma_f32_16x16x32_bf16 v[152:155], v[96:99], v[168:171], v[152:155]
    v_cvt_pk_bf16_f32 v118, v50, v51
    v_add_f32 v45, v45, v51
    v_mfma_f32_16x16x32_bf16 v[156:159], v[96:99], v[184:187], v[156:159]
    s_nop 0
    ds_read_b128 v[84:87], v6 offset:3072
    v_mfma_f32_16x16x32_bf16 v[152:155], v[100:103], v[172:175], v[152:155]
    v_add_f32 v45, v45, v52
    v_cvt_pk_bf16_f32 v119, v52, v53
    v_mfma_f32_16x16x32_bf16 v[156:159], v[100:103], v[188:191], v[156:159]
    v_add_f32 v45, v45, v53
    ds_read_b128 v[88:91], v6 offset:4096
    v_add_f32 v19, v44, v45
    v_cmp_nge_f32 vcc, s52, v19
    s_cbranch_vccnz ka_kernel_rare_19
ka_kernel_ret_20:
    s_cmp_lt_u32 s45, s23
    s_cbranch_scc1 ka_kernel_lean
    s_cmp_ge_u32 s41, s40
    s_cbranch_scc1 ka_kernel_after
ka_kernel_loop:
    s_cmp_eq_u32 s45, s64
    s_cbranch_scc1 ka_kernel_side_21
ka_kernel_sret_22:
    s_waitcnt lgkmcnt(3)
    v_mfma_f32_16x16x32_bf16 v[192:195], v[72:75], v[112:115], v[192:195]
    v_add_f32 v40, v40, v44
    v_add_f32 v41, v41, v45
    s_mov_b32 m0, s46
    v_mfma_f32_16x16x32_bf16 v[196:199], v[72:75], v[116:119], v[196:199]
    s_nop 0
    buffer_load_dwordx4 v4, s[16:19], s42 offen offset:0 sc1 lds
    ds_read_b128 v[92:95], v6 offset:5120
    v_mfma_f32_16x16x32_bf16 v[200:203], v[76:79], v[112:115], v[200:203]
    v_mfma_f32_16x16x32_bf16 v[204:207], v[76:79], v[116:119], v[204:207]
    ds_read_b128 v[96:99], v6 offset:6144
    s_cmp_ge_i32 s51, 0
    s_cbranch_scc1 ka_kernel_mask_23
ka_kernel_mret_24:
    s_add_u32 s51, s51, 1
    s_waitcnt lgkmcnt(3)
    v_mfma_f32_16x16x32_bf16 v[208:211], v[80:83], v[112:115], v[208:211]
    v_exp_f32 v46, v144
    v_exp_f32 v47, v145
    v_mfma_f32_16x16x32_bf16 v[212:215], v[80:83], v[116:119], v[212:215]
    buffer_load_dwordx4 v4, s[16:19], s42 offen offset:1024 sc1 lds
    ds_read_b128 v[100:103], v6 offset:7168
    v_mfma_f32_16x16x32_bf16 v[216:219], v[84:87], v[112:115], v[216:219]
    v_exp_f32 v48, v146
    v_add_f32 v44, v46, v47
    v_mfma_f32_16x16x32_bf16 v[220:223], v[84:87], v[116:119], v[220:223]
    v_exp_f32 v49, v147
    ds_read_b128 v[72:75], v5 offset:0
    s_waitcnt lgkmcnt(3)
    v_mfma_f32_16x16x32_bf16 v[224:227], v[88:91], v[112:115], v[224:227]
    v_cvt_pk_bf16_f32 v120, v46, v47
    v_exp_f32 v50, v152
    v_mfma_f32_16x16x32_bf16 v[228:231], v[88:91], v[116:119], v[228:231]
    v_add_f32 v44, v44, v48
    buffer_load_dwordx4 v4, s[16:19], s42 offen offset:2048 sc1 lds
    ds_read_b128 v[76:79], v5 offset:1024
    v_mfma_f32_16x16x32_bf16 v[232:235], v[92:95], v[112:115], v[232:235]
    v_exp_f32 v51, v153
    v_cvt_pk_bf16_f32 v121, v48, v49
    v_mfma_f32_16x16x32_bf16 v[236:239], v[92:95], v[116:119], v[236:239]
    v_add_f32 v44, v44, v49
    ds_read_b128 v[80:83], v5 offset:2048
    s_waitcnt lgkmcnt(3)
    v_mfma_f32_16x16x32_bf16 v[240:243], v[96:99], v[112:115], v[240:243]
    v_exp_f32 v52, v154
    v_add_f32 v44, v44, v50
    v_mfma_f32_16x16x32_bf16 v[244:247], v[96:99], v[116:119], v[244:247]
    buffer_load_dwordx4 v4, s[16:19], s42 offen offset:3072 sc1 lds
    ds_read_b128 v[84:87], v5 offset:3072
    v_mfma_f32_16x16x32_bf16 v[248:251], v[100:103], v[112:115], v[248:251]
    v_exp_f32 v53, v155
    v_cvt_pk_bf16_f32 v122, v50, v51
    v_mfma_f32_16x16x32_bf16 v[252:255], v[100:103], v[116:119], v[252:255]
    v_add_f32 v44, v44, v51
    ds_read_b128 v[88:91], v5 offset:4096
    s_waitcnt lgkmcnt(3)
    v_mfma_f32_16x16x32_bf16 v[128:131], v[72:75], v[160:163], v[104:107]
    v_exp_f32 v46, v148
    v_add_f32 v44, v44, v52
    v_mfma_f32_16x16x32_bf16 v[132:135], v[72:75], v[176:179], v[108:111]
    v_exp_f32 v47, v149
    ds_read_b128 v[92:95], v5 offset:5120
    v_mfma_f32_16x16x32_bf16 v[128:131], v[76:79], v[164:167], v[128:131]
    v_cvt_pk_bf16_f32 v123, v52, v53
    v_add_f32 v44, v44, v53
    v_mfma_f32_16x16x32_bf16 v[132:135], v[76:79], v[180:183], v[132:135]
    v_exp_f32 v48, v150
    ds_read_b128 v[96:99], v5 offset:6144
    s_waitcnt lgkmcnt(3)
    v_mfma_f32_16x16x32_bf16 v[128:131], v[80:83], v[168:171], v[128:131]
    v_add_f32 v45, v46, v47
    v_exp_f32 v49, v151
    v_mfma_f32_16x16x32_bf16 v[132:135], v[80:83], v[184:187], v[132:135]
    v_cvt_pk_bf16_f32 v124, v46, v47
    ds_read_b128 v[100:103], v5 offset:7168
    v_mfma_f32_16x16x32_bf16 v[128:131], v[84:87], v[172:175], v[128:131]
    v_exp_f32 v50, v156
    v_mfma_f32_16x16x32_bf16 v[132:135], v[84:87], v[188:191], v[132:135]
    v_add_f32 v45, v45, v48
    ds_read_b128 v[72:75], v6 offset:8192
    s_waitcnt lgkmcnt(3)
    v_mfma_f32_16x16x32_bf16 v[136:139], v[88:91], v[160:163], v[104:107]
    v_exp_f32 v51, v157
    v_cvt_pk_bf16_f32 v125, v48, v49
    v_mfma_f32_16x16x32_bf16 v[140:143], v[88:91], v[176:179], v[108:111]
    v_add_f32 v45, v45, v49
    ds_read_b128 v[76:79], v6 offset:9216
    v_mfma_f32_16x16x32_bf16 v[136:139], v[92:95], v[164:167], v[136:139]
    v_exp_f32 v52, v158
    v_add_f32 v45, v45, v50
    v_mfma_f32_16x16x32_bf16 v[140:143], v[92:95], v[180:183], v[140:143]
    v_exp_f32 v53, v159
    ds_read_b128 v[80:83], v6 offset:10240
    s_waitcnt lgkmcnt(3)
    v_mfma_f32_16x16x32_bf16 v[136:139], v[96:99], v[168:171], v[136:139]
    v_cvt_pk_bf16_f32 v126, v50, v51
    v_add_f32 v45, v45, v51
    v_mfma_f32_16x16x32_bf16 v[140:143], v[96:99], v[184:187], v[140:143]
    s_nop 0
    ds_read_b128 v[84:87], v6 offset:11264
    v_mfma_f32_16x16x32_bf16 v[136:139], v[100:103], v[172:175], v[136:139]
    v_add_f32 v45, v45, v52
    v_cvt_pk_bf16_f32 v127, v52, v53
    v_mfma_f32_16x16x32_bf16 v[140:143], v[100:103], v[188:191], v[140:143]
    v_add_f32 v45, v45, v53
    ds_read_b128 v[88:91], v6 offset:12288
    v_add_f32 v19, v44, v45
    v_cmp_nge_f32 vcc, s52, v19
    s_cbranch_vccnz ka_kernel_rare_27
ka_kernel_ret_28:
    s_waitcnt lgkmcnt(3)
    v_mfma_f32_16x16x32_bf16 v[192:195], v[72:75], v[120:123], v[192:195]
    v_add_f32 v40, v40, v44
    v_add_f32 v41, v41, v45
    s_mov_b32 m0, s47
    v_mfma_f32_16x16x32_bf16 v[196:199], v[72:75], v[124:127], v[196:199]
    s_nop 0
    buffer_load_dwordx4 v4, s[16:19], s43 offen offset:0 sc1 lds
    ds_read_b128 v[92:95], v6 offset:13312
    v_mfma_f32_16x16x32_bf16 v[200:203], v[76:79], v[120:123], v[200:203]
    v_mfma_f32_16x16x32_bf16 v[204:207], v[76:79], v[124:127], v[204:207]
    ds_read_b128 v[96:99], v6 offset:14336
    s_cmp_ge_i32 s51, 0
    s_cbranch_scc1 ka_kernel_mask_25
ka_kernel_mret_26:
    s_add_u32 s51, s51, 1
    s_waitcnt lgkmcnt(3)
    v_mfma_f32_16x16x32_bf16 v[208:211], v[80:83], v[120:123], v[208:211]
    v_exp_f32 v46, v128
    v_exp_f32 v47, v129
    v_mfma_f32_16x16x32_bf16 v[212:215], v[80:83], v[124:127], v[212:215]
    buffer_load_dwordx4 v4, s[16:19], s43 offen offset:1024 sc1 lds
    ds_read_b128 v[100:103], v6 offset:15360
    v_mfma_f32_16x16x32_bf16 v[216:219], v[84:87], v[120:123], v[216:219]
    v_exp_f32 v48, v130
    v_add_f32 v44, v46, v47
    v_mfma_f32_16x16x32_bf16 v[220:223], v[84:87], v[124:127], v[220:223]
    v_exp_f32 v49, v131
    ds_read_b128 v[72:75], v5 offset:8192
    s_waitcnt lgkmcnt(3)
    v_mfma_f32_16x16x32_bf16 v[224:227], v[88:91], v[120:123], v[224:227]
    v_cvt_pk_bf16_f32 v112, v46, v47
    v_exp_f32 v50, v136
    v_mfma_f32_16x16x32_bf16 v[228:231], v[88:91], v[124:127], v[228:231]
    v_add_f32 v44, v44, v48
    buffer_load_dwordx4 v4, s[16:19], s43 offen offset:2048 sc1 lds
    ds_read_b128 v[76:79], v5 offset:9216
    v_mfma_f32_16x16x32_bf16 v[232:235], v[92:95], v[120:123], v[232:235]
    v_exp_f32 v51, v137
    v_cvt_pk_bf16_f32 v113, v48, v49
    v_mfma_f32_16x16x32_bf16 v[236:239], v[92:95], v[124:127], v[236:239]
    v_add_f32 v44, v44, v49
    ds_read_b128 v[80:83], v5 offset:10240
    s_waitcnt lgkmcnt(3)
    v_mfma_f32_16x16x32_bf16 v[240:243], v[96:99], v[120:123], v[240:243]
    v_exp_f32 v52, v138
    v_add_f32 v44, v44, v50
    v_mfma_f32_16x16x32_bf16 v[244:247], v[96:99], v[124:127], v[244:247]
    buffer_load_dwordx4 v4, s[16:19], s43 offen offset:3072 sc1 lds
    ds_read_b128 v[84:87], v5 offset:11264
    v_mfma_f32_16x16x32_bf16 v[248:251], v[100:103], v[120:123], v[248:251]
    v_exp_f32 v53, v139
    v_cvt_pk_bf16_f32 v114, v50, v51
    v_add_f32 v44, v44, v51
    v_mfma_f32_16x16x32_bf16 v[252:255], v[100:103], v[124:127], v[252:255]
    s_add_u32 s43, s42, 16384
    s_xor_b32 s46, s46, 0x8000
    ds_read_b128 v[88:91], v5 offset:12288
    s_waitcnt lgkmcnt(3)
    v_mfma_f32_16x16x32_bf16 v[144:147], v[72:75], v[160:163], v[104:107]
    v_exp_f32 v46, v132
    v_add_f32 v44, v44, v52
    v_exp_f32 v47, v133
    v_mfma_f32_16x16x32_bf16 v[148:151], v[72:75], v[176:179], v[108:111]
    s_xor_b32 s47, s47, 0x8000
    s_add_u32 s44, s44, 1
    ds_read_b128 v[92:95], v5 offset:13312
    v_mfma_f32_16x16x32_bf16 v[144:147], v[76:79], v[164:167], v[144:147]
    v_cvt_pk_bf16_f32 v115, v52, v53
    v_add_f32 v44, v44, v53
    v_exp_f32 v48, v134
    v_mfma_f32_16x16x32_bf16 v[148:151], v[76:79], v[180:183], v[148:151]
    s_add_u32 s45, s45, 1
    s_add_u32 s42, s42, 32768
    ds_read_b128 v[96:99], v5 offset:14336
    s_waitcnt lgkmcnt(3)
    v_mfma_f32_16x16x32_bf16 v[144:147], v[80:83], v[168:171], v[144:147]
    v_add_f32 v45, v46, v47
    v_exp_f32 v49, v135
    v_cvt_pk_bf16_f32 v116, v46, v47
    v_mfma_f32_16x16x32_bf16 v[148:151], v[80:83], v[184:187], v[148:151]
    s_cmp_eq_u32 s44, s48
    s_cselect_b32 s42, s49, s42
    s_add_u32 s41, s41, 1
    ds_read_b128 v[100:103], v5 offset:15360
    v_mfma_f32_16x16x32_bf16 v[144:147], v[84:87], v[172:175], v[144:147]
    v_exp_f32 v50, v140
    v_mfma_f32_16x16x32_bf16 v[148:151], v[84:87], v[188:191], v[148:151]
    v_add_f32 v45, v45, v48
    s_waitcnt lgkmcnt(2)
    v_mfma_f32_16x16x32_bf16 v[152:155], v[88:91], v[160:163], v[104:107]
    v_exp_f32 v51, v141
    v_cvt_pk_bf16_f32 v117, v48, v49
    v_mfma_f32_16x16x32_bf16 v[156:159], v[88:91], v[176:179], v[108:111]
    v_add_f32 v45, v45, v49
    s_waitcnt lgkmcnt(0) vmcnt(0)
    s_barrier
    v_xor_b32 v5, 0x8000, v5
    v_xor_b32 v6, 0x8000, v6
    ds_read_b128 v[72:75], v6 offset:0
    ds_read_b128 v[76:79], v6 offset:1024
    v_mfma_f32_16x16x32_bf16 v[152:155], v[92:95], v[164:167], v[152:155]
    v_exp_f32 v52, v142
    v_add_f32 v45, v45, v50
    v_mfma_f32_16x16x32_bf16 v[156:159], v[92:95], v[180:183], v[156:159]
    v_exp_f32 v53, v143
    ds_read_b128 v[80:83], v6 offset:2048
    v_mfma_f32_16x16x32_bf16 v[152:155], v[96:99], v[168:171], v[152:155]
    v_cvt_pk_bf16_f32 v118, v50, v51
    v_add_f32 v45, v45, v51
    v_mfma_f32_16x16x32_bf16 v[156:159], v[96:99], v[184:187], v[156:159]
    s_nop 0
    ds_read_b128 v[84:87], v6 offset:3072
    v_mfma_f32_16x16x32_bf16 v[152:155], v[100:103], v[172:175], v[152:155]
    v_add_f32 v45, v45, v52
    v_cvt_pk_bf16_f32 v119, v52, v53
    v_mfma_f32_16x16x32_bf16 v[156:159], v[100:103], v[188:191], v[156:159]
    v_add_f32 v45, v45, v53
    ds_read_b128 v[88:91], v6 offset:4096
    v_add_f32 v19, v44, v45
    v_cmp_nge_f32 vcc, s52, v19
    s_cbranch_vccnz ka_kernel_rare_29
ka_kernel_ret_30:
    s_cmp_lt_u32 s41, s40
    s_cbranch_scc1 ka_kernel_try
ka_kernel_after:
    s_cmp_lg_u32 s54, 0
    s_cbranch_scc1 ka_kernel_lasth
ka_kernel_tail:
    s_waitcnt lgkmcnt(4)
    v_mfma_f32_16x16x32_bf16 v[192:195], v[72:75], v[112:115], v[192:195]
    v_add_f32 v40, v40, v44
    v_mfma_f32_16x16x32_bf16 v[196:199], v[72:75], v[116:119], v[196:199]
    v_add_f32 v41, v41, v45
    ds_read_b128 v[92:95], v6 offset:5120
    s_waitcnt lgkmcnt(4)
    v_mfma_f32_16x16x32_bf16 v[200:203], v[76:79], v[112:115], v[200:203]
    v_mfma_f32_16x16x32_bf16 v[204:207], v[76:79], v[116:119], v[204:207]
    ds_read_b128 v[96:99], v6 offset:6144
    s_cmp_ge_i32 s51, 0
    s_cbranch_scc1 ka_kernel_mask_31
ka_kernel_mret_32:
    s_add_u32 s51, s51, 1
    s_waitcnt lgkmcnt(4)
    v_mfma_f32_16x16x32_bf16 v[208:211], v[80:83], v[112:115], v[208:211]
    v_exp_f32 v46, v144
    v_exp_f32 v47, v145
    v_exp_f32 v48, v146
    v_mfma_f32_16x16x32_bf16 v[212:215], v[80:83], v[116:119], v[212:215]
    v_add_f32 v44, v46, v47
    v_exp_f32 v49, v147
    v_cvt_pk_bf16_f32 v120, v46, v47
    ds_read_b128 v[100:103], v6 offset:7168
    s_waitcnt lgkmcnt(4)
    v_mfma_f32_16x16x32_bf16 v[216:219], v[84:87], v[112:115], v[216:219]
    v_exp_f32 v50, v152
    v_add_f32 v44, v44, v48
    v_exp_f32 v51, v153
    v_cvt_pk_bf16_f32 v121, v48, v49
    v_mfma_f32_16x16x32_bf16 v[220:223], v[84:87], v[116:119], v[220:223]
    v_add_f32 v44, v44, v49
    v_exp_f32 v52, v154
    v_add_f32 v44, v44, v50
    ds_read_b128 v[72:75], v6 offset:8192
    s_waitcnt lgkmcnt(4)
    v_mfma_f32_16x16x32_bf16 v[224:227], v[88:91], v[112:115], v[224:227]
    v_exp_f32 v53, v155
    v_cvt_pk_bf16_f32 v122, v50, v51
    v_add_f32 v44, v44, v51
    v_mfma_f32_16x16x32_bf16 v[228:231], v[88:91], v[116:119], v[228:231]
    v_exp_f32 v46, v148
    v_add_f32 v44, v44, v52
    v_exp_f32 v47, v149
    ds_read_b128 v[76:79], v6 offset:9216
    s_waitcnt lgkmcnt(4)
    v_mfma_f32_16x16x32_bf16 v[232:235], v[92:95], v[112:115], v[232:235]
    v_cvt_pk_bf16_f32 v123, v52, v53
    v_add_f32 v44, v44, v53
    v_exp_f32 v48, v150
    v_add_f32 v45, v46, v47
    v_mfma_f32_16x16x32_bf16 v[236:239], v[92:95], v[116:119], v[236:239]
    v_exp_f32 v49, v151
    v_cvt_pk_bf16_f32 v124, v46, v47
    v_exp_f32 v50, v156
    ds_read_b128 v[80:83], v6 offset:10240
    s_waitcnt lgkmcnt(4)
    v_mfma_f32_16x16x32_bf16 v[240:243], v[96:99], v[112:115], v[240:243]
    v_add_f32 v45, v45, v48
    v_exp_f32 v51, v157
    v_cvt_pk_bf16_f32 v125, v48, v49
    v_mfma_f32_16x16x32_bf16 v[244:247], v[96:99], v[116:119], v[244:247]
    v_add_f32 v45, v45, v49
    v_exp_f32 v52, v158
    v_add_f32 v45, v45, v50
    ds_read_b128 v[84:87], v6 offset:11264
    s_waitcnt lgkmcnt(4)
    v_mfma_f32_16x16x32_bf16 v[248:251], v[100:103], v[112:115], v[248:251]
    v_exp_f32 v53, v159
    v_cvt_pk_bf16_f32 v126, v50, v51
    v_add_f32 v45, v45, v51
    s_nop 0
    v_mfma_f32_16x16x32_bf16 v[252:255], v[100:103], v[116:119], v[252:255]
    v_add_f32 v45, v45, v52
    v_cvt_pk_bf16_f32 v127, v52, v53
    v_add_f32 v45, v45, v53
    ds_read_b128 v[88:91], v6 offset:12288
    v_add_f32 v19, v44, v45
    v_cmp_nge_f32 vcc, s52, v19
    s_cbranch_vccnz ka_kernel_rare_33
ka_kernel_ret_34:
    s_nop 0
    s_waitcnt lgkmcnt(4)
    v_mfma_f32_16x16x32_bf16 v[192:195], v[72:75], v[120:123], v[192:195]
    v_add_f32 v40, v40, v44
    v_mfma_f32_16x16x32_bf16 v[196:199], v[72:75], v[124:127], v[196:199]
    v_add_f32 v41, v41, v45
    ds_read_b128 v[92:95], v6 offset:13312
    s_waitcnt lgkmcnt(4)
    v_mfma_f32_16x16x32_bf16 v[200:203], v[76:79], v[120:123], v[200:203]
    v_mov_b32 v23, v40
    v_mov_b32 v24, v41
    v_mfma_f32_16x16x32_bf16 v[204:207], v[76:79], v[124:127], v[204:207]
    s_nop 1
    ds_read_b128 v[96:99], v6 offset:14336
    s_waitcnt lgkmcnt(4)
    v_mfma_f32_16x16x32_bf16 v[208:211], v[80:83], v[120:123], v[208:211]
    v_permlane16_swap_b32 v40, v23
    v_permlane16_swap_b32 v41, v24
    v_mfma_f32_16x16x32_bf16 v[212:215], v[80:83], v[124:127], v[212:215]
    v_add_f32 v40, v40, v23
    v_add_f32 v41, v41, v24
    ds_read_b128 v[100:103], v6 offset:15360
    s_waitcnt lgkmcnt(4)
    v_mfma_f32_16x16x32_bf16 v[216:219], v[84:87], v[120:123], v[216:219]
    v_mov_b32 v23, v40
    v_mov_b32 v24, v41
    v_mfma_f32_16x16x32_bf16 v[220:223], v[84:87], v[124:127], v[220:223]
    s_nop 1
    s_waitcnt lgkmcnt(3)
    v_mfma_f32_16x16x32_bf16 v[224:227], v[88:91], v[120:123], v[224:227]
    v_permlane32_swap_b32 v40, v23
    v_permlane32_swap_b32 v41, v24
    v_mfma_f32_16x16x32_bf16 v[228:231], v[88:91], v[124:127], v[228:231]
    v_add_f32 v40, v40, v23
    v_add_f32 v41, v41, v24
    s_waitcnt lgkmcnt(2)
    v_mfma_f32_16x16x32_bf16 v[232:235], v[92:95], v[120:123], v[232:235]
    v_rcp_f32 v19, v40
    v_rcp_f32 v22, v41
    v_mfma_f32_16x16x32_bf16 v[236:239], v[92:95], v[124:127], v[236:239]
    s_nop 0
    s_waitcnt lgkmcnt(1)
    v_mfma_f32_16x16x32_bf16 v[240:243], v[96:99], v[120:123], v[240:243]
    v_mov_b32 v21, v19
    v_mov_b32 v20, v19
    v_mfma_f32_16x16x32_bf16 v[244:247], v[96:99], v[124:127], v[244:247]
    v_mov_b32 v23, v22
    s_lshl_b32 s37, s53, 3
    s_waitcnt lgkmcnt(0)
    v_mfma_f32_16x16x32_bf16 v[248:251], v[100:103], v[120:123], v[248:251]
    s_add_u32 s37, s37, s36
    s_lshl_b32 s37, s37, 17
    v_mfma_f32_16x16x32_bf16 v[252:255], v[100:103], v[124:127], v[252:255]
    s_lshl_b32 s38, s33, 12
    s_add_u32 s37, s37, s38
    s_branch ka_kernel_final
ka_kernel_lasth:
    s_cmp_eq_u32 s45, s64
    s_cbranch_scc1 ka_kernel_side_35
ka_kernel_sret_36:
    s_waitcnt lgkmcnt(3)
    v_mfma_f32_16x16x32_bf16 v[192:195], v[72:75], v[112:115], v[192:195]
    s_nop 1
    v_add_f32 v40, v40, v44
    v_add_f32 v41, v41, v45
    v_mfma_f32_16x16x32_bf16 v[196:199], v[72:75], v[116:119], v[196:199]
    s_mov_b32 m0, s46
    s_nop 0
    buffer_load_dwordx4 v4, s[16:19], s42 offen offset:0 sc1 lds
    ds_read_b128 v[92:95], v6 offset:5120
    v_mfma_f32_16x16x32_bf16 v[200:203], v[76:79], v[112:115], v[200:203]
    v_mfma_f32_16x16x32_bf16 v[204:207], v[76:79], v[116:119], v[204:207]
    ds_read_b128 v[96:99], v6 offset:6144
    s_cmp_ge_i32 s51, 0
    s_cbranch_scc1 ka_kernel_mask_37
ka_kernel_mret_38:
    s_add_u32 s51, s51, 1
    s_waitcnt lgkmcnt(3)
    v_mfma_f32_16x16x32_bf16 v[208:211], v[80:83], v[112:115], v[208:211]
    v_exp_f32 v46, v144
    v_exp_f32 v47, v145
    v_mfma_f32_16x16x32_bf16 v[212:215], v[80:83], v[116:119], v[212:215]
    buffer_load_dwordx4 v4, s[16:19], s42 offen offset:1024 sc1 lds
    ds_read_b128 v[100:103], v6 offset:7168
    v_mfma_f32_16x16x32_bf16 v[216:219], v[84:87], v[112:115], v[216:219]
    v_exp_f32 v48, v146
    v_add_f32 v44, v46, v47
    v_mfma_f32_16x16x32_bf16 v[220:223], v[84:87], v[116:119], v[220:223]
    v_exp_f32 v49, v147
    ds_read_b128 v[72:75], v5 offset:0
    s_waitcnt lgkmcnt(3)
    v_mfma_f32_16x16x32_bf16 v[224:227], v[88:91], v[112:115], v[224:227]
    v_cvt_pk_bf16_f32 v120, v46, v47
    v_exp_f32 v50, v152
    v_mfma_f32_16x16x32_bf16 v[228:231], v[88:91], v[116:119], v[228:231]
    v_add_f32 v44, v44, v48
    buffer_load_dwordx4 v4, s[16:19], s42 offen offset:2048 sc1 lds
    ds_read_b128 v[76:79], v5 offset:1024
    v_mfma_f32_16x16x32_bf16 v[232:235], v[92:95], v[112:115], v[232:235]
    v_exp_f32 v51, v153
    v_cvt_pk_bf16_f32 v121, v48, v49
    v_mfma_f32_16x16x32_bf16 v[236:239], v[92:95], v[116:119], v[236:239]
    v_add_f32 v44, v44, v49
    ds_read_b128 v[80:83], v5 offset:2048
    s_waitcnt lgkmcnt(3)
    v_mfma_f32_16x16x32_bf16 v[240:243], v[96:99], v[112:115], v[240:243]
    v_exp_f32 v52, v154
    v_add_f32 v44, v44, v50
    v_mfma_f32_16x16x32_bf16 v[244:247], v[96:99], v[116:119], v[244:247]
    buffer_load_dwordx4 v4, s[16:19], s42 offen offset:3072 sc1 lds
    ds_read_b128 v[84:87], v5 offset:3072
    v_mfma_f32_16x16x32_bf16 v[248:251], v[100:103], v[112:115], v[248:251]
    v_exp_f32 v53, v155
    v_cvt_pk_bf16_f32 v122, v50, v51
    v_mfma_f32_16x16x32_bf16 v[252:255], v[100:103], v[116:119], v[252:255]
    v_add_f32 v44, v44, v51
    ds_read_b128 v[88:91], v5 offset:4096
    s_waitcnt lgkmcnt(3)
    v_mfma_f32_16x16x32_bf16 v[132:135], v[72:75], v[176:179], v[108:111]
    v_exp_f32 v46, v148
    v_add_f32 v44, v44, v52
    v_exp_f32 v47, v149
    ds_read_b128 v[92:95], v5 offset:5120
    v_mfma_f32_16x16x32_bf16 v[132:135], v[76:79], v[180:183], v[132:135]
    v_cvt_pk_bf16_f32 v123, v52, v53
    v_add_f32 v44, v44, v53
    v_exp_f32 v48, v150
    ds_read_b128 v[96:99], v5 offset:6144
    s_waitcnt lgkmcnt(3)
    v_mfma_f32_16x16x32_bf16 v[132:135], v[80:83], v[184:187], v[132:135]
    v_add_f32 v45, v46, v47
    v_exp_f32 v49, v151
    v_cvt_pk_bf16_f32 v124, v46, v47
    ds_read_b128 v[100:103], v5 offset:7168
    v_mfma_f32_16x16x32_bf16 v[132:135], v[84:87], v[188:191], v[132:135]
    v_exp_f32 v50, v156
    v_add_f32 v45, v45, v48
    ds_read_b128 v[72:75], v6 offset:8192
    s_waitcnt lgkmcnt(3)
    v_mfma_f32_16x16x32_bf16 v[140:143], v[88:91], v[176:179], v[108:111]
    v_exp_f32 v51, v157
    v_cvt_pk_bf16_f32 v125, v48, v49
    v_add_f32 v45, v45, v49
    ds_read_b128 v[76:79], v6 offset:9216
    v_mfma_f32_16x16x32_bf16 v[140:143], v[92:95], v[180:183], v[140:143]
    v_exp_f32 v52, v158
    v_add_f32 v45, v45, v50
    v_exp_f32 v53, v159
    ds_read_b128 v[80:83], v6 offset:10240
    s_waitcnt lgkmcnt(3)
    v_mfma_f32_16x16x32_bf16 v[140:143], v[96:99], v[184:187], v[140:143]
    v_cvt_pk_bf16_f32 v126, v50, v51
    v_add_f32 v45, v45, v51
    s_nop 0
    ds_read_b128 v[84:87], v6 offset:11264
    v_mfma_f32_16x16x32_bf16 v[140:143], v[100:103], v[188:191], v[140:143]
    v_add_f32 v45, v45, v52
    v_cvt_pk_bf16_f32 v127, v52, v53
    v_add_f32 v45, v45, v53
    ds_read_b128 v[88:91], v6 offset:12288
    v_add_f32 v19, v44, v45
    v_cmp_nge_f32 vcc, s52, v19
    s_cbranch_vccnz ka_kernel_rare_41
ka_kernel_ret_42:
    s_waitcnt lgkmcnt(3)
    v_mfma_f32_16x16x32_bf16 v[192:195], v[72:75], v[120:123], v[192:195]
    v_add_f32 v40, v40, v44
    v_add_f32 v41, v41, v45
    s_mov_b32 m0, s47
    v_mfma_f32_16x16x32_bf16 v[196:199], v[72:75], v[124:127], v[196:199]
    s_nop 0
    buffer_load_dwordx4 v4, s[16:19], s43 offen offset:0 sc1 lds
    ds_read_b128 v[92:95], v6 offset:13312
    v_mfma_f32_16x16x32_bf16 v[200:203], v[76:79], v[120:123], v[200:203]
    v_mfma_f32_16x16x32_bf16 v[204:207], v[76:79], v[124:127], v[204:207]
    ds_read_b128 v[96:99], v6 offset:14336
    s_cmp_ge_i32 s51, 0
    s_cbranch_scc1 ka_kernel_mask_39
ka_kernel_mret_40:
    s_add_u32 s51, s51, 1
    s_waitcnt lgkmcnt(3)
    v_mfma_f32_16x16x32_bf16 v[208:211], v[80:83], v[120:123], v[208:211]
    v_exp_f32 v46, v132
    v_mfma_f32_16x16x32_bf16 v[212:215], v[80:83], v[124:127], v[212:215]
    buffer_load_dwordx4 v4, s[16:19], s43 offen offset:1024 sc1 lds
    ds_read_b128 v[100:103], v6 offset:15360
    v_mfma_f32_16x16x32_bf16 v[216:219], v[84:87], v[120:123], v[216:219]
    v_exp_f32 v47, v133
    v_mfma_f32_16x16x32_bf16 v[220:223], v[84:87], v[124:127], v[220:223]
    ds_read_b128 v[72:75], v5 offset:8192
    s_waitcnt lgkmcnt(3)
    v_mfma_f32_16x16x32_bf16 v[224:227], v[88:91], v[120:123], v[224:227]
    v_exp_f32 v48, v134
    v_add_f32 v45, v46, v47
    v_mfma_f32_16x16x32_bf16 v[228:231], v[88:91], v[124:127], v[228:231]
    buffer_load_dwordx4 v4, s[16:19], s43 offen offset:2048 sc1 lds
    ds_read_b128 v[76:79], v5 offset:9216
    v_mfma_f32_16x16x32_bf16 v[232:235], v[92:95], v[120:123], v[232:235]
    v_exp_f32 v49, v135
    v_mfma_f32_16x16x32_bf16 v[236:239], v[92:95], v[124:127], v[236:239]
    ds_read_b128 v[80:83], v5 offset:10240
    s_waitcnt lgkmcnt(3)
    v_mfma_f32_16x16x32_bf16 v[240:243], v[96:99], v[120:123], v[240:243]
    v_cvt_pk_bf16_f32 v116, v46, v47
    v_exp_f32 v50, v140
    v_mfma_f32_16x16x32_bf16 v[244:247], v[96:99], v[124:127], v[244:247]
    buffer_load_dwordx4 v4, s[16:19], s43 offen offset:3072 sc1 lds
    ds_read_b128 v[84:87], v5 offset:11264
    v_mfma_f32_16x16x32_bf16 v[248:251], v[100:103], v[120:123], v[248:251]
    v_add_f32 v45, v45, v48
    s_add_u32 s43, s42, 16384
    v_mfma_f32_16x16x32_bf16 v[252:255], v[100:103], v[124:127], v[252:255]
    s_xor_b32 s46, s46, 0x8000
    ds_read_b128 v[88:91], v5 offset:12288
    s_waitcnt lgkmcnt(3)
    v_mfma_f32_16x16x32_bf16 v[148:151], v[72:75], v[176:179], v[108:111]
    v_exp_f32 v51, v141
    v_cvt_pk_bf16_f32 v117, v48, v49
    s_xor_b32 s47, s47, 0x8000
    s_add_u32 s44, s44, 1
    ds_read_b128 v[92:95], v5 offset:13312
    v_mfma_f32_16x16x32_bf16 v[148:151], v[76:79], v[180:183], v[148:151]
    v_add_f32 v45, v45, v49
    s_add_u32 s45, s45, 1
    s_add_u32 s42, s42, 32768
    ds_read_b128 v[96:99], v5 offset:14336
    s_waitcnt lgkmcnt(3)
    v_mfma_f32_16x16x32_bf16 v[148:151], v[80:83], v[184:187], v[148:151]
    v_exp_f32 v52, v142
    s_cmp_eq_u32 s44, s48
    s_cselect_b32 s42, s49, s42
    s_add_u32 s41, s41, 1
    ds_read_b128 v[100:103], v5 offset:15360
    v_mfma_f32_16x16x32_bf16 v[148:151], v[84:87], v[188:191], v[148:151]
    v_add_f32 v45, v45, v50
    v_exp_f32 v53, v143
    s_waitcnt lgkmcnt(2)
    v_mfma_f32_16x16x32_bf16 v[156:159], v[88:91], v[176:179], v[108:111]
    v_cvt_pk_bf16_f32 v118, v50, v51
    s_waitcnt lgkmcnt(0) vmcnt(0)
    s_barrier
    v_xor_b32 v5, 0x8000, v5
    v_xor_b32 v6, 0x8000, v6
    ds_read_b128 v[72:75], v6 offset:0
    ds_read_b128 v[76:79], v6 offset:1024
    v_mfma_f32_16x16x32_bf16 v[156:159], v[92:95], v[180:183], v[156:159]
    v_add_f32 v45, v45, v51
    s_nop 0
    ds_read_b128 v[80:83], v6 offset:2048
    v_mfma_f32_16x16x32_bf16 v[156:159], v[96:99], v[184:187], v[156:159]
    v_add_f32 v45, v45, v52
    ds_read_b128 v[84:87], v6 offset:3072
    v_mfma_f32_16x16x32_bf16 v[156:159], v[100:103], v[188:191], v[156:159]
    v_cvt_pk_bf16_f32 v119, v52, v53
    v_add_f32 v45, v45, v53
    ds_read_b128 v[88:91], v6 offset:4096
    v_cmp_nge_f32 vcc, s52, v45
    s_cbranch_vccnz ka_kernel_rare_43
ka_kernel_ret_44:
ka_kernel_tailh:
    s_cmp_lg_u32 s50, 0
    s_cbranch_scc1 ka_kernel_nd_45
    s_mov_b32 m0, s46
    s_nop 0
    buffer_load_dwordx4 v4, s[16:19], s42 offen offset:0 sc1 lds
    buffer_load_dwordx4 v4, s[16:19], s42 offen offset:1024 sc1 lds
    buffer_load_dwordx4 v4, s[16:19], s42 offen offset:2048 sc1 lds
    buffer_load_dwordx4 v4, s[16:19], s42 offen offset:3072 sc1 lds
    s_mov_b32 m0, s47
    s_nop 0
    buffer_load_dwordx4 v4, s[16:19], s43 offen offset:0 sc1 lds
    buffer_load_dwordx4 v4, s[16:19], s43 offen offset:1024 sc1 lds
    buffer_load_dwordx4 v4, s[16:19], s43 offen offset:2048 sc1 lds
    buffer_load_dwordx4 v4, s[16:19], s43 offen offset:3072 sc1 lds
    s_add_u32 s43, s42, 16384
    s_xor_b32 s46, s46, 0x8000
    s_xor_b32 s47, s47, 0x8000
    s_add_u32 s44, s44, 1
    s_add_u32 s45, s45, 1
    s_add_u32 s42, s42, 32768
    s_cmp_eq_u32 s44, s48
    s_cselect_b32 s42, s49, s42
ka_kernel_nd_45:
    s_waitcnt lgkmcnt(4)
    v_mfma_f32_16x16x32_bf16 v[196:199], v[72:75], v[116:119], v[196:199]
    v_add_f32 v41, v41, v45
    ds_read_b128 v[92:95], v6 offset:5120
    s_waitcnt lgkmcnt(4)
    v_mfma_f32_16x16x32_bf16 v[204:207], v[76:79], v[116:119], v[204:207]
    ds_read_b128 v[96:99], v6 offset:6144
    s_waitcnt lgkmcnt(4)
    v_mfma_f32_16x16x32_bf16 v[212:215], v[80:83], v[116:119], v[212:215]
    ds_read_b128 v[100:103], v6 offset:7168
    s_cmp_ge_i32 s51, 0
    s_cbranch_scc1 ka_kernel_mask_46
ka_kernel_mret_47:
    s_add_u32 s51, s51, 1
    s_waitcnt lgkmcnt(4)
    v_mfma_f32_16x16x32_bf16 v[220:223], v[84:87], v[116:119], v[220:223]
    v_exp_f32 v46, v148
    v_exp_f32 v47, v149
    v_exp_f32 v48, v150
    v_add_f32 v45, v46, v47
    ds_read_b128 v[72:75], v6 offset:8192
    s_waitcnt lgkmcnt(4)
    v_mfma_f32_16x16x32_bf16 v[228:231], v[88:91], v[116:119], v[228:231]
    v_exp_f32 v49, v151
    v_cvt_pk_bf16_f32 v124, v46, v47
    v_exp_f32 v50, v156
    v_add_f32 v45, v45, v48
    ds_read_b128 v[76:79], v6 offset:9216
    s_waitcnt lgkmcnt(4)
    v_mfma_f32_16x16x32_bf16 v[236:239], v[92:95], v[116:119], v[236:239]
    v_exp_f32 v51, v157
    v_cvt_pk_bf16_f32 v125, v48, v49
    v_add_f32 v45, v45, v49
    v_exp_f32 v52, v158
    ds_read_b128 v[80:83], v6 offset:10240
    s_waitcnt lgkmcnt(4)
    v_mfma_f32_16x16x32_bf16 v[244:247], v[96:99], v[116:119], v[244:247]
    v_add_f32 v45, v45, v50
    v_exp_f32 v53, v159
    v_cvt_pk_bf16_f32 v126, v50, v51
    v_add_f32 v45, v45, v51
    ds_read_b128 v[84:87], v6 offset:11264
    s_waitcnt lgkmcnt(4)
    v_mfma_f32_16x16x32_bf16 v[252:255], v[100:103], v[116:119], v[252:255]
    s_nop 0
    v_add_f32 v45, v45, v52
    v_cvt_pk_bf16_f32 v127, v52, v53
    v_add_f32 v45, v45, v53
    ds_read_b128 v[88:91], v6 offset:12288
    v_cmp_nge_f32 vcc, s52, v45
    s_cbranch_vccnz ka_kernel_rare_48
ka_kernel_ret_49:
    s_nop 0
    s_waitcnt lgkmcnt(4)
    v_mfma_f32_16x16x32_bf16 v[196:199], v[72:75], v[124:127], v[196:199]
    v_add_f32 v41, v41, v45
    ds_read_b128 v[92:95], v6 offset:13312
    s_waitcnt lgkmcnt(4)
    v_mfma_f32_16x16x32_bf16 v[204:207], v[76:79], v[124:127], v[204:207]
    v_mov_b32 v23, v40
    v_mov_b32 v24, v41
    s_nop 1
    ds_read_b128 v[96:99], v6 offset:14336
    s_waitcnt lgkmcnt(4)
    v_mfma_f32_16x16x32_bf16 v[212:215], v[80:83], v[124:127], v[212:215]
    v_permlane16_swap_b32 v40, v23
    v_permlane16_swap_b32 v41, v24
    v_add_f32 v40, v40, v23
    v_add_f32 v41, v41, v24
    ds_read_b128 v[100:103], v6 offset:15360
    s_waitcnt lgkmcnt(4)
    v_mfma_f32_16x16x32_bf16 v[220:223], v[84:87], v[124:127], v[220:223]
    v_mov_b32 v23, v40
    v_mov_b32 v24, v41
    s_nop 1
    s_waitcnt lgkmcnt(3)
    v_mfma_f32_16x16x32_bf16 v[228:231], v[88:91], v[124:127], v[228:231]
    v_permlane32_swap_b32 v40, v23
    v_permlane32_swap_b32 v41, v24
    v_add_f32 v40, v40, v23
    v_add_f32 v41, v41, v24
    s_waitcnt lgkmcnt(2)
    v_mfma_f32_16x16x32_bf16 v[236:239], v[92:95], v[124:127], v[236:239]
    v_rcp_f32 v19, v40
    v_rcp_f32 v22, v41
    s_nop 0
    s_waitcnt lgkmcnt(1)
    v_mfma_f32_16x16x32_bf16 v[244:247], v[96:99], v[124:127], v[244:247]
    v_mov_b32 v21, v19
    v_mov_b32 v20, v19
    v_mov_b32 v23, v22
    s_lshl_b32 s37, s53, 3
    s_waitcnt lgkmcnt(0)
    v_mfma_f32_16x16x32_bf16 v[252:255], v[100:103], v[124:127], v[252:255]
    s_add_u32 s37, s37, s36
    s_lshl_b32 s37, s37, 17
    s_lshl_b32 s38, s33, 12
    s_add_u32 s37, s37, s38
    s_nop 3
    s_cmp_lg_u32 s50, 0
    s_cbranch_scc1 ka_kernel_final
    s_lshl_b32 s38, s36, 12
    s_add_u32 s38, s38, 131072
    v_add_u32 v25, s38, v2
    s_lshl_b32 s38, s55, 12
    v_add_u32 v26, s38, v25
    ds_read_b128 v[160:163], v25 offset:0
    ds_read_b128 v[164:167], v25 offset:1024
    ds_read_b128 v[168:171], v25 offset:2048
    ds_read_b128 v[172:175], v25 offset:3072
    ds_read_b128 v[176:179], v26 offset:0
    ds_read_b128 v[180:183], v26 offset:1024
    ds_read_b128 v[184:187], v26 offset:2048
    ds_read_b128 v[188:191], v26 offset:3072
    s_lshl_b32 s38, s55, 17
    s_add_u32 s38, s38, s37
    v_pk_mul_f32 v[192:193], v[192:193], v[20:21]
    v_pk_mul_f32 v[194:195], v[194:195], v[20:21]
    v_pk_mul_f32 v[200:201], v[200:201], v[20:21]
    v_pk_mul_f32 v[202:203], v[202:203], v[20:21]
    v_cvt_pk_bf16_f32 v128, v192, v193
    v_cvt_pk_bf16_f32 v129, v194, v195
    v_cvt_pk_bf16_f32 v130, v200, v201
    v_cvt_pk_bf16_f32 v131, v202, v203
    buffer_store_dwordx4 v[128:131], v2, s[28:31], s37 offen offset:0 sc1
    v_pk_mul_f32 v[196:197], v[196:197], v[22:23]
    v_pk_mul_f32 v[198:199], v[198:199], v[22:23]
    v_pk_mul_f32 v[204:205], v[204:205], v[22:23]
    v_pk_mul_f32 v[206:207], v[206:207], v[22:23]
    v_cvt_pk_bf16_f32 v132, v196, v197
    v_cvt_pk_bf16_f32 v133, v198, v199
    v_cvt_pk_bf16_f32 v134, v204, v205
    v_cvt_pk_bf16_f32 v135, v206, v207
    buffer_store_dwordx4 v[132:135], v2, s[28:31], s38 offen offset:0 sc1
    v_pk_mul_f32 v[208:209], v[208:209], v[20:21]
    v_pk_mul_f32 v[210:211], v[210:211], v[20:21]
    v_pk_mul_f32 v[216:217], v[216:217], v[20:21]
    v_pk_mul_f32 v[218:219], v[218:219], v[20:21]
    v_cvt_pk_bf16_f32 v136, v208, v209
    v_cvt_pk_bf16_f32 v137, v210, v211
    v_cvt_pk_bf16_f32 v138, v216, v217
    v_cvt_pk_bf16_f32 v139, v218, v219
    buffer_store_dwordx4 v[136:139], v2, s[28:31], s37 offen offset:1024 sc1
    v_pk_mul_f32 v[212:213], v[212:213], v[22:23]
    v_pk_mul_f32 v[214:215], v[214:215], v[22:23]
    v_pk_mul_f32 v[220:221], v[220:221], v[22:23]
    v_pk_mul_f32 v[222:223], v[222:223], v[22:23]
    v_cvt_pk_bf16_f32 v140, v212, v213
    v_cvt_pk_bf16_f32 v141, v214, v215
    v_cvt_pk_bf16_f32 v142, v220, v221
    v_cvt_pk_bf16_f32 v143, v222, v223
    buffer_store_dwordx4 v[140:143], v2, s[28:31], s38 offen offset:1024 sc1
    v_pk_mul_f32 v[224:225], v[224:225], v[20:21]
    v_pk_mul_f32 v[226:227], v[226:227], v[20:21]
    v_pk_mul_f32 v[232:233], v[232:233], v[20:21]
    v_pk_mul_f32 v[234:235], v[234:235], v[20:21]
    v_cvt_pk_bf16_f32 v144, v224, v225
    v_cvt_pk_bf16_f32 v145, v226, v227
    v_cvt_pk_bf16_f32 v146, v232, v233
    v_cvt_pk_bf16_f32 v147, v234, v235
    buffer_store_dwordx4 v[144:147], v2, s[28:31], s37 offen offset:2048 sc1
    v_pk_mul_f32 v[228:229], v[228:229], v[22:23]
    v_pk_mul_f32 v[230:231], v[230:231], v[22:23]
    v_pk_mul_f32 v[236:237], v[236:237], v[22:23]
    v_pk_mul_f32 v[238:239], v[238:239], v[22:23]
    v_cvt_pk_bf16_f32 v148, v228, v229
    v_cvt_pk_bf16_f32 v149, v230, v231
    v_cvt_pk_bf16_f32 v150, v236, v237
    v_cvt_pk_bf16_f32 v151, v238, v239
    buffer_store_dwordx4 v[148:151], v2, s[28:31], s38 offen offset:2048 sc1
    v_pk_mul_f32 v[240:241], v[240:241], v[20:21]
    v_pk_mul_f32 v[242:243], v[242:243], v[20:21]
    v_pk_mul_f32 v[248:249], v[248:249], v[20:21]
    v_pk_mul_f32 v[250:251], v[250:251], v[20:21]
    v_cvt_pk_bf16_f32 v152, v240, v241
    v_cvt_pk_bf16_f32 v153, v242, v243
    v_cvt_pk_bf16_f32 v154, v248, v249
    v_cvt_pk_bf16_f32 v155, v250, v251
    buffer_store_dwordx4 v[152:155], v2, s[28:31], s37 offen offset:3072 sc1
    v_pk_mul_f32 v[244:245], v[244:245], v[22:23]
    v_pk_mul_f32 v[246:247], v[246:247], v[22:23]
    v_pk_mul_f32 v[252:253], v[252:253], v[22:23]
    v_pk_mul_f32 v[254:255], v[254:255], v[22:23]
    v_cvt_pk_bf16_f32 v156, v244, v245
    v_cvt_pk_bf16_f32 v157, v246, v247
    v_cvt_pk_bf16_f32 v158, v252, v253
    v_cvt_pk_bf16_f32 v159, v254, v255
    buffer_store_dwordx4 v[156:159], v2, s[28:31], s38 offen offset:3072 sc1
    v_xor_b32 v6, 0x8000, v6
    s_mov_b32 s50, 1
    s_sub_u32 s53, 15, s34
    s_lshl_b32 s37, s34, 1
    s_sub_u32 s40, 14, s37
    s_lshl_b32 s51, s53, 2
    s_sub_u32 s51, 34, s51
    s_branch ka_kernel_seg
ka_kernel_final:
    s_load_dwordx2 s[4:5], s[0:1], 88
    s_load_dwordx2 s[16:17], s[0:1], 96
    s_lshr_b32 s53, s33, 2
    s_lshl_b32 s56, s53, 4
    s_add_u32 s56, s56, 36864
    s_lshl_b32 s71, s34, 7
    s_add_u32 s70, s56, s71
    s_sub_u32 s71, 1920, s71
    s_add_u32 s71, s71, s56
    s_mov_b32 s52, 32768
    v_and_b32 v65, 3, v1
    v_lshlrev_b32 v65, 2, v65
    buffer_load_dword v64, v65, s[72:75], s70 offen sc1
    s_lshl_b32 s38, s32, 13
    v_add_u32 v25, s38, v2
    v_xor_b32 v26, 0x8000, v25
    s_lshl_b32 s38, s32, 10
    s_add_u32 s38, s38, 155648
    v_add_u32 v27, s38, v2
    v_xor_b32 v19, 0x1000, v27
    ds_write_b128 v27, v[40:43]
    s_lshl_b32 s38, s35, 11
    s_add_u32 s37, s37, s38
    s_lshl_b32 s38, s55, 17
    s_add_u32 s38, s38, s37
    s_cmp_eq_u32 s35, 0
    s_cbranch_scc0 ka_kernel_g1_50
    ds_write_b128 v25, v[224:227] offset:0
    ds_write_b128 v25, v[228:231] offset:1024
    ds_write_b128 v25, v[232:235] offset:2048
    ds_write_b128 v25, v[236:239] offset:3072
    ds_write_b128 v25, v[240:243] offset:4096
    ds_write_b128 v25, v[244:247] offset:5120
    ds_write_b128 v25, v[248:251] offset:6144
    ds_write_b128 v25, v[252:255] offset:7168
    s_waitcnt lgkmcnt(0)
    s_and_b32 s66, s2, 7
    s_mul_i32 s50, s66, 18
    s_lshr_b32 s67, s2, 3
    s_sub_u32 s67, s67, 7
    s_add_u32 s50, s50, s67
    s_cmp_lt_u32 s67, 18
    s_cselect_b32 s50, s50, -1
    s_and_b32 s51, s33, 3
    s_add_u32 s44, s6, 33554432
    s_addc_u32 s45, s7, 0
    s_mov_b32 s8, s44
    s_and_b32 s9, s45, 0xffff
    s_mov_b32 s10, 16777216
    s_mov_b32 s11, 0x20000
    s_mov_b32 s12, s4
    s_and_b32 s13, s5, 0xffff
    s_mov_b32 s14, 4718592
    s_mov_b32 s15, 0x20000
    s_add_u32 s44, s6, 75497472
    s_addc_u32 s45, s7, 0
    s_mov_b32 s20, s44
    s_and_b32 s21, s45, 0xffff
    s_mov_b32 s22, 18874368
    s_mov_b32 s23, 0x20000
    s_mov_b32 s16, s16
    s_and_b32 s17, s17, 0xffff
    s_mov_b32 s18, 4718592
    s_mov_b32 s19, 0x20000
    s_and_b32 s43, s32, 3
    s_lshl_b32 s41, s53, 4
    s_add_u32 s41, s41, s43
    s_mul_i32 s41, s41, 36864
    s_mul_i32 s66, s51, 288
    s_add_u32 s41, s41, s66
    s_mul_i32 s42, s43, 9216
    s_mov_b32 s46, s34
    s_lshl_b32 s66, s46, 3
    s_lshl_b32 s67, s43, 1
    s_add_u32 s67, s67, s66
    s_lshl_b32 s67, s67, 17
    s_lshl_b32 s68, s53, 14
    s_add_u32 s56, s67, s68
    s_add_u32 s66, s66, s53
    s_mul_i32 s48, s66, 36864
    s_mul_i32 s67, s51, 288
    s_add_u32 s48, s48, s67
    s_add_u32 s48, s48, 1152
    s_lshl_b32 s66, s46, 2
    s_add_u32 s66, s66, s51
    s_lshl_b32 s66, s66, 3
    s_mul_i32 s64, s66, 36864
    s_mul_i32 s67, s53, 4608
    s_add_u32 s64, s64, s67
    s_lshl_b32 s62, s66, 4
    s_lshr_b32 s67, s53, 1
    s_lshl_b32 s67, s67, 2
    s_add_u32 s62, s62, s67
    s_add_u32 s62, s62, 40960
    s_add_u32 s66, s66, s53
    s_mul_i32 s58, s66, 36864
    s_add_u32 s58, s58, s42
    s_lshl_b32 s60, s66, 2
    s_add_u32 s60, s60, s43
    s_lshl_b32 s60, s60, 2
    s_add_u32 s60, s60, 40960
    s_sub_u32 s46, 15, s34
    s_lshl_b32 s66, s46, 3
    s_lshl_b32 s67, s43, 1
    s_add_u32 s67, s67, s66
    s_lshl_b32 s67, s67, 17
    s_lshl_b32 s68, s53, 14
    s_add_u32 s57, s67, s68
    s_add_u32 s66, s66, s53
    s_mul_i32 s49, s66, 36864
    s_mul_i32 s67, s51, 288
    s_add_u32 s49, s49, s67
    s_add_u32 s49, s49, 1152
    s_lshl_b32 s66, s46, 2
    s_add_u32 s66, s66, s51
    s_lshl_b32 s66, s66, 3
    s_mul_i32 s65, s66, 36864
    s_mul_i32 s67, s53, 4608
    s_add_u32 s65, s65, s67
    s_lshl_b32 s63, s66, 4
    s_lshr_b32 s67, s53, 1
    s_lshl_b32 s67, s67, 2
    s_add_u32 s63, s63, s67
    s_add_u32 s63, s63, 40960
    s_add_u32 s66, s66, s53
    s_mul_i32 s59, s66, 36864
    s_add_u32 s59, s59, s42
    s_lshl_b32 s61, s66, 2
    s_add_u32 s61, s61, s43
    s_lshl_b32 s61, s61, 2
    s_add_u32 s61, s61, 40960
    v_add_u32 v28, 0, v1
    v_mul_u32_u24 v38, 3641, v28
    v_lshrrev_b32 v38, 16, v38
    v_lshlrev_b32 v28, 4, v28
    v_mul_u32_u24 v38, 864, v38
    v_add_u32 v28, v28, v38
    v_add_u32 v29, 64, v1
    v_mul_u32_u24 v38, 3641, v29
    v_lshrrev_b32 v38, 16, v38
    v_lshlrev_b32 v29, 4, v29
    v_mul_u32_u24 v38, 864, v38
    v_add_u32 v29, v29, v38
    v_subrev_u32 v29, 1024, v29
    v_add_u32 v30, 128, v1
    v_mul_u32_u24 v38, 3641, v30
    v_lshrrev_b32 v38, 16, v38
    v_lshlrev_b32 v30, 4, v30
    v_mul_u32_u24 v38, 864, v38
    v_add_u32 v30, v30, v38
    v_subrev_u32 v30, 2048, v30
    v_add_u32 v31, 192, v1
    v_mul_u32_u24 v38, 3641, v31
    v_lshrrev_b32 v38, 16, v38
    v_lshlrev_b32 v31, 4, v31
    v_mul_u32_u24 v38, 864, v38
    v_add_u32 v31, v31, v38
    v_subrev_u32 v31, 3072, v31
    v_add_u32 v32, 256, v1
    v_mul_u32_u24 v38, 3641, v32
    v_lshrrev_b32 v38, 16, v38
    v_lshlrev_b32 v32, 4, v32
    v_mul_u32_u24 v38, 864, v38
    v_add_u32 v32, v32, v38
    v_add_u32 v33, 320, v1
    v_mul_u32_u24 v38, 3641, v33
    v_lshrrev_b32 v38, 16, v38
    v_lshlrev_b32 v33, 4, v33
    v_mul_u32_u24 v38, 864, v38
    v_add_u32 v33, v33, v38
    v_subrev_u32 v33, 1024, v33
    v_add_u32 v34, 384, v1
    v_mul_u32_u24 v38, 3641, v34
    v_lshrrev_b32 v38, 16, v38
    v_lshlrev_b32 v34, 4, v34
    v_mul_u32_u24 v38, 864, v38
    v_add_u32 v34, v34, v38
    v_subrev_u32 v34, 2048, v34
    v_add_u32 v35, 448, v1
    v_mul_u32_u24 v38, 3641, v35
    v_lshrrev_b32 v38, 16, v38
    v_lshlrev_b32 v35, 4, v35
    v_mul_u32_u24 v38, 864, v38
    v_add_u32 v35, v35, v38
    v_subrev_u32 v35, 3072, v35
    v_add_u32 v36, 512, v1
    v_mul_u32_u24 v38, 3641, v36
    v_lshrrev_b32 v38, 16, v38
    v_lshlrev_b32 v36, 4, v36
    v_mul_u32_u24 v38, 864, v38
    v_add_u32 v36, v36, v38
    s_barrier
    ds_read_b128 v[56:59], v19
    ds_read_b128 v[72:75], v26 offset:0
    ds_read_b128 v[76:79], v26 offset:1024
    ds_read_b128 v[80:83], v26 offset:2048
    ds_read_b128 v[84:87], v26 offset:3072
    ds_read_b128 v[88:91], v26 offset:4096
    ds_read_b128 v[92:95], v26 offset:5120
    ds_read_b128 v[96:99], v26 offset:6144
    ds_read_b128 v[100:103], v26 offset:7168
    s_waitcnt lgkmcnt(8)
    v_max_f32 v46, v42, v58
    v_sub_f32 v47, v42, v46
    v_sub_f32 v48, v58, v46
    v_exp_f32 v47, v47
    v_exp_f32 v48, v48
    s_nop 0
    v_mul_f32 v46, v47, v40
    v_fmac_f32 v46, v48, v56
    v_rcp_f32 v46, v46
    s_nop 0
    v_mul_f32 v47, v47, v46
    v_mul_f32 v48, v48, v46
    v_max_f32 v50, v43, v59
    v_sub_f32 v51, v43, v50
    v_sub_f32 v52, v59, v50
    v_exp_f32 v51, v51
    v_exp_f32 v52, v52
    s_nop 0
    v_mul_f32 v50, v51, v41
    v_fmac_f32 v50, v52, v57
    v_rcp_f32 v50, v50
    s_nop 0
    v_mul_f32 v51, v51, v50
    v_mul_f32 v52, v52, v50
    v_mul_f32 v192, v192, v47
    v_mul_f32 v193, v193, v47
    v_mul_f32 v194, v194, v47
    v_mul_f32 v195, v195, v47
    v_mul_f32 v200, v200, v47
    v_mul_f32 v201, v201, v47
    v_mul_f32 v202, v202, v47
    v_mul_f32 v203, v203, v47
    s_waitcnt lgkmcnt(5)
    v_fmac_f32 v192, v72, v48
    v_fmac_f32 v193, v73, v48
    v_fmac_f32 v194, v74, v48
    v_fmac_f32 v195, v75, v48
    v_fmac_f32 v200, v80, v48
    v_fmac_f32 v201, v81, v48
    v_fmac_f32 v202, v82, v48
    v_fmac_f32 v203, v83, v48
    v_cvt_pk_bf16_f32 v128, v192, v193
    v_cvt_pk_bf16_f32 v129, v194, v195
    v_cvt_pk_bf16_f32 v130, v200, v201
    v_cvt_pk_bf16_f32 v131, v202, v203
    buffer_store_dwordx4 v[128:131], v2, s[28:31], s37 offen offset:0 sc1
    v_mul_f32 v196, v196, v51
    v_mul_f32 v197, v197, v51
    v_mul_f32 v198, v198, v51
    v_mul_f32 v199, v199, v51
    v_mul_f32 v204, v204, v51
    v_mul_f32 v205, v205, v51
    v_mul_f32 v206, v206, v51
    v_mul_f32 v207, v207, v51
    s_waitcnt lgkmcnt(4)
    v_fmac_f32 v196, v76, v52
    v_fmac_f32 v197, v77, v52
    v_fmac_f32 v198, v78, v52
    v_fmac_f32 v199, v79, v52
    v_fmac_f32 v204, v84, v52
    v_fmac_f32 v205, v85, v52
    v_fmac_f32 v206, v86, v52
    v_fmac_f32 v207, v87, v52
    v_cvt_pk_bf16_f32 v132, v196, v197
    v_cvt_pk_bf16_f32 v133, v198, v199
    v_cvt_pk_bf16_f32 v134, v204, v205
    v_cvt_pk_bf16_f32 v135, v206, v207
    buffer_store_dwordx4 v[132:135], v2, s[28:31], s38 offen offset:0 sc1
    v_mul_f32 v208, v208, v47
    v_mul_f32 v209, v209, v47
    v_mul_f32 v210, v210, v47
    v_mul_f32 v211, v211, v47
    v_mul_f32 v216, v216, v47
    v_mul_f32 v217, v217, v47
    v_mul_f32 v218, v218, v47
    v_mul_f32 v219, v219, v47
    s_waitcnt lgkmcnt(1)
    v_fmac_f32 v208, v88, v48
    v_fmac_f32 v209, v89, v48
    v_fmac_f32 v210, v90, v48
    v_fmac_f32 v211, v91, v48
    v_fmac_f32 v216, v96, v48
    v_fmac_f32 v217, v97, v48
    v_fmac_f32 v218, v98, v48
    v_fmac_f32 v219, v99, v48
    v_cvt_pk_bf16_f32 v136, v208, v209
    v_cvt_pk_bf16_f32 v137, v210, v211
    v_cvt_pk_bf16_f32 v138, v216, v217
    v_cvt_pk_bf16_f32 v139, v218, v219
    buffer_store_dwordx4 v[136:139], v2, s[28:31], s37 offen offset:1024 sc1
    v_mul_f32 v212, v212, v51
    v_mul_f32 v213, v213, v51
    v_mul_f32 v214, v214, v51
    v_mul_f32 v215, v215, v51
    v_mul_f32 v220, v220, v51
    v_mul_f32 v221, v221, v51
    v_mul_f32 v222, v222, v51
    v_mul_f32 v223, v223, v51
    s_waitcnt lgkmcnt(0)
    v_fmac_f32 v212, v92, v52
    v_fmac_f32 v213, v93, v52
    v_fmac_f32 v214, v94, v52
    v_fmac_f32 v215, v95, v52
    v_fmac_f32 v220, v100, v52
    v_fmac_f32 v221, v101, v52
    v_fmac_f32 v222, v102, v52
    v_fmac_f32 v223, v103, v52
    v_cvt_pk_bf16_f32 v140, v212, v213
    v_cvt_pk_bf16_f32 v141, v214, v215
    v_cvt_pk_bf16_f32 v142, v220, v221
    v_cvt_pk_bf16_f32 v143, v222, v223
    buffer_store_dwordx4 v[140:143], v2, s[28:31], s38 offen offset:1024 sc1
    s_branch ka_kernel_convw
ka_kernel_g1_50:
    ds_write_b128 v25, v[192:195] offset:0
    ds_write_b128 v25, v[196:199] offset:1024
    ds_write_b128 v25, v[200:203] offset:2048
    ds_write_b128 v25, v[204:207] offset:3072
    ds_write_b128 v25, v[208:211] offset:4096
    ds_write_b128 v25, v[212:215] offset:5120
    ds_write_b128 v25, v[216:219] offset:6144
    ds_write_b128 v25, v[220:223] offset:7168
    s_waitcnt lgkmcnt(0)
    s_and_b32 s66, s2, 7
    s_mul_i32 s50, s66, 18
    s_lshr_b32 s67, s2, 3
    s_sub_u32 s67, s67, 7
    s_add_u32 s50, s50, s67
    s_cmp_lt_u32 s67, 18
    s_cselect_b32 s50, s50, -1
    s_and_b32 s51, s33, 3
    s_add_u32 s44, s6, 33554432
    s_addc_u32 s45, s7, 0
    s_mov_b32 s8, s44
    s_and_b32 s9, s45, 0xffff
    s_mov_b32 s10, 16777216
    s_mov_b32 s11, 0x20000
    s_mov_b32 s12, s4
    s_and_b32 s13, s5, 0xffff
    s_mov_b32 s14, 4718592
    s_mov_b32 s15, 0x20000
    s_add_u32 s44, s6, 75497472
    s_addc_u32 s45, s7, 0
    s_mov_b32 s20, s44
    s_and_b32 s21, s45, 0xffff
    s_mov_b32 s22, 18874368
    s_mov_b32 s23, 0x20000
    s_mov_b32 s16, s16
    s_and_b32 s17, s17, 0xffff
    s_mov_b32 s18, 4718592
    s_mov_b32 s19, 0x20000
    s_and_b32 s43, s32, 3
    s_lshl_b32 s41, s53, 4
    s_add_u32 s41, s41, s43
    s_mul_i32 s41, s41, 36864
    s_mul_i32 s66, s51, 288
    s_add_u32 s41, s41, s66
    s_mul_i32 s42, s43, 9216
    s_mov_b32 s46, s34
    s_lshl_b32 s66, s46, 3
    s_lshl_b32 s67, s43, 1
    s_add_u32 s67, s67, s66
    s_lshl_b32 s67, s67, 17
    s_lshl_b32 s68, s53, 14
    s_add_u32 s56, s67, s68
    s_add_u32 s66, s66, s53
    s_mul_i32 s48, s66, 36864
    s_mul_i32 s67, s51, 288
    s_add_u32 s48, s48, s67
    s_add_u32 s48, s48, 1152
    s_lshl_b32 s66, s46, 2
    s_add_u32 s66, s66, s51
    s_lshl_b32 s66, s66, 3
    s_mul_i32 s64, s66, 36864
    s_mul_i32 s67, s53, 4608
    s_add_u32 s64, s64, s67
    s_lshl_b32 s62, s66, 4
    s_lshr_b32 s67, s53, 1
    s_lshl_b32 s67, s67, 2
    s_add_u32 s62, s62, s67
    s_add_u32 s62, s62, 40960
    s_add_u32 s66, s66, s53
    s_mul_i32 s58, s66, 36864
    s_add_u32 s58, s58, s42
    s_lshl_b32 s60, s66, 2
    s_add_u32 s60, s60, s43
    s_lshl_b32 s60, s60, 2
    s_add_u32 s60, s60, 40960
    s_sub_u32 s46, 15, s34
    s_lshl_b32 s66, s46, 3
    s_lshl_b32 s67, s43, 1
    s_add_u32 s67, s67, s66
    s_lshl_b32 s67, s67, 17
    s_lshl_b32 s68, s53, 14
    s_add_u32 s57, s67, s68
    s_add_u32 s66, s66, s53
    s_mul_i32 s49, s66, 36864
    s_mul_i32 s67, s51, 288
    s_add_u32 s49, s49, s67
    s_add_u32 s49, s49, 1152
    s_lshl_b32 s66, s46, 2
    s_add_u32 s66, s66, s51
    s_lshl_b32 s66, s66, 3
    s_mul_i32 s65, s66, 36864
    s_mul_i32 s67, s53, 4608
    s_add_u32 s65, s65, s67
    s_lshl_b32 s63, s66, 4
    s_lshr_b32 s67, s53, 1
    s_lshl_b32 s67, s67, 2
    s_add_u32 s63, s63, s67
    s_add_u32 s63, s63, 40960
    s_add_u32 s66, s66, s53
    s_mul_i32 s59, s66, 36864
    s_add_u32 s59, s59, s42
    s_lshl_b32 s61, s66, 2
    s_add_u32 s61, s61, s43
    s_lshl_b32 s61, s61, 2
    s_add_u32 s61, s61, 40960
    v_add_u32 v17, 131072, v2
    v_lshrrev_b32 v38, 2, v1
    v_mul_u32_u24 v38, 288, v38
    v_and_b32 v39, 3, v1
    v_lshl_add_u32 v11, v39, 3, v38
    v_add_u32 v12, 55296, v11
    v_add_u32 v13, 110592, v11
    v_and_b32 v9, 15, v1
    v_mul_u32_u24 v9, 2304, v9
    v_lshrrev_b32 v10, 4, v1
    v_lshl_add_u32 v9, v10, 3, v9
    v_lshlrev_b32 v10, 3, v1
    v_and_b32 v14, 7, v1
    v_lshlrev_b32 v14, 4, v14
    s_barrier
    ds_read_b128 v[56:59], v19
    ds_read_b128 v[72:75], v26 offset:0
    ds_read_b128 v[76:79], v26 offset:1024
    ds_read_b128 v[80:83], v26 offset:2048
    ds_read_b128 v[84:87], v26 offset:3072
    ds_read_b128 v[88:91], v26 offset:4096
    ds_read_b128 v[92:95], v26 offset:5120
    ds_read_b128 v[96:99], v26 offset:6144
    ds_read_b128 v[100:103], v26 offset:7168
    s_waitcnt lgkmcnt(8)
    v_max_f32 v46, v42, v58
    v_sub_f32 v47, v42, v46
    v_sub_f32 v48, v58, v46
    v_exp_f32 v47, v47
    v_exp_f32 v48, v48
    s_nop 0
    v_mul_f32 v46, v47, v40
    v_fmac_f32 v46, v48, v56
    v_rcp_f32 v46, v46
    s_nop 0
    v_mul_f32 v47, v47, v46
    v_mul_f32 v48, v48, v46
    v_max_f32 v50, v43, v59
    v_sub_f32 v51, v43, v50
    v_sub_f32 v52, v59, v50
    v_exp_f32 v51, v51
    v_exp_f32 v52, v52
    s_nop 0
    v_mul_f32 v50, v51, v41
    v_fmac_f32 v50, v52, v57
    v_rcp_f32 v50, v50
    s_nop 0
    v_mul_f32 v51, v51, v50
    v_mul_f32 v52, v52, v50
    v_mul_f32 v224, v224, v47
    v_mul_f32 v225, v225, v47
    v_mul_f32 v226, v226, v47
    v_mul_f32 v227, v227, v47
    v_mul_f32 v232, v232, v47
    v_mul_f32 v233, v233, v47
    v_mul_f32 v234, v234, v47
    v_mul_f32 v235, v235, v47
    s_waitcnt lgkmcnt(5)
    v_fmac_f32 v224, v72, v48
    v_fmac_f32 v225, v73, v48
    v_fmac_f32 v226, v74, v48
    v_fmac_f32 v227, v75, v48
    v_fmac_f32 v232, v80, v48
    v_fmac_f32 v233, v81, v48
    v_fmac_f32 v234, v82, v48
    v_fmac_f32 v235, v83, v48
    v_cvt_pk_bf16_f32 v128, v224, v225
    v_cvt_pk_bf16_f32 v129, v226, v227
    v_cvt_pk_bf16_f32 v130, v232, v233
    v_cvt_pk_bf16_f32 v131, v234, v235
    buffer_store_dwordx4 v[128:131], v2, s[28:31], s37 offen offset:0 sc1
    v_mul_f32 v228, v228, v51
    v_mul_f32 v229, v229, v51
    v_mul_f32 v230, v230, v51
    v_mul_f32 v231, v231, v51
    v_mul_f32 v236, v236, v51
    v_mul_f32 v237, v237, v51
    v_mul_f32 v238, v238, v51
    v_mul_f32 v239, v239, v51
    s_waitcnt lgkmcnt(4)
    v_fmac_f32 v228, v76, v52
    v_fmac_f32 v229, v77, v52
    v_fmac_f32 v230, v78, v52
    v_fmac_f32 v231, v79, v52
    v_fmac_f32 v236, v84, v52
    v_fmac_f32 v237, v85, v52
    v_fmac_f32 v238, v86, v52
    v_fmac_f32 v239, v87, v52
    v_cvt_pk_bf16_f32 v132, v228, v229
    v_cvt_pk_bf16_f32 v133, v230, v231
    v_cvt_pk_bf16_f32 v134, v236, v237
    v_cvt_pk_bf16_f32 v135, v238, v239
    buffer_store_dwordx4 v[132:135], v2, s[28:31], s38 offen offset:0 sc1
    v_mul_f32 v240, v240, v47
    v_mul_f32 v241, v241, v47
    v_mul_f32 v242, v242, v47
    v_mul_f32 v243, v243, v47
    v_mul_f32 v248, v248, v47
    v_mul_f32 v249, v249, v47
    v_mul_f32 v250, v250, v47
    v_mul_f32 v251, v251, v47
    s_waitcnt lgkmcnt(1)
    v_fmac_f32 v240, v88, v48
    v_fmac_f32 v241, v89, v48
    v_fmac_f32 v242, v90, v48
    v_fmac_f32 v243, v91, v48
    v_fmac_f32 v248, v96, v48
    v_fmac_f32 v249, v97, v48
    v_fmac_f32 v250, v98, v48
    v_fmac_f32 v251, v99, v48
    v_cvt_pk_bf16_f32 v136, v240, v241
    v_cvt_pk_bf16_f32 v137, v242, v243
    v_cvt_pk_bf16_f32 v138, v248, v249
    v_cvt_pk_bf16_f32 v139, v250, v251
    buffer_store_dwordx4 v[136:139], v2, s[28:31], s37 offen offset:1024 sc1
    v_mul_f32 v244, v244, v51
    v_mul_f32 v245, v245, v51
    v_mul_f32 v246, v246, v51
    v_mul_f32 v247, v247, v51
    v_mul_f32 v252, v252, v51
    v_mul_f32 v253, v253, v51
    v_mul_f32 v254, v254, v51
    v_mul_f32 v255, v255, v51
    s_waitcnt lgkmcnt(0)
    v_fmac_f32 v244, v92, v52
    v_fmac_f32 v245, v93, v52
    v_fmac_f32 v246, v94, v52
    v_fmac_f32 v247, v95, v52
    v_fmac_f32 v252, v100, v52
    v_fmac_f32 v253, v101, v52
    v_fmac_f32 v254, v102, v52
    v_fmac_f32 v255, v103, v52
    v_cvt_pk_bf16_f32 v140, v244, v245
    v_cvt_pk_bf16_f32 v141, v246, v247
    v_cvt_pk_bf16_f32 v142, v252, v253
    v_cvt_pk_bf16_f32 v143, v254, v255
    buffer_store_dwordx4 v[140:143], v2, s[28:31], s38 offen offset:1024 sc1
    v_mov_b32 v16, v65
    s_waitcnt vmcnt(4)
    v_cmp_ne_u32 vcc, s69, v64
    s_mov_b32 s66, vcc_lo
    s_cbranch_vccnz ka_kernel_late
    s_add_u32 s38, s56, 8192
    buffer_load_dwordx4 v[48:51], v2, s[8:11], s38 offen offset:0 sc1
    buffer_load_dwordx4 v[52:55], v17, s[8:11], s38 offen offset:0 sc1
    s_add_u32 s38, s56, 8192
    buffer_load_dwordx4 v[56:59], v2, s[8:11], s38 offen offset:1024 sc1
    buffer_load_dwordx4 v[60:63], v17, s[8:11], s38 offen offset:1024 sc1
    s_add_u32 s38, s56, 8192
    buffer_load_dwordx4 v[64:67], v2, s[8:11], s38 offen offset:2048 sc1
    buffer_load_dwordx4 v[68:71], v17, s[8:11], s38 offen offset:2048 sc1
    s_add_u32 s38, s56, 8192
    buffer_load_dwordx4 v[72:75], v2, s[8:11], s38 offen offset:3072 sc1
    buffer_load_dwordx4 v[76:79], v17, s[8:11], s38 offen offset:3072 sc1
    s_add_u32 s38, s56, 12288
    buffer_load_dwordx4 v[80:83], v2, s[8:11], s38 offen offset:0 sc1
    buffer_load_dwordx4 v[84:87], v17, s[8:11], s38 offen offset:0 sc1
    s_add_u32 s38, s56, 12288
    buffer_load_dwordx4 v[88:91], v2, s[8:11], s38 offen offset:1024 sc1
    buffer_load_dwordx4 v[92:95], v17, s[8:11], s38 offen offset:1024 sc1
    s_add_u32 s38, s56, 12288
    buffer_load_dwordx4 v[96:99], v2, s[8:11], s38 offen offset:2048 sc1
    buffer_load_dwordx4 v[100:103], v17, s[8:11], s38 offen offset:2048 sc1
    s_add_u32 s38, s56, 12288
    buffer_load_dwordx4 v[104:107], v2, s[8:11], s38 offen offset:3072 sc1
    buffer_load_dwordx4 v[108:111], v17, s[8:11], s38 offen offset:3072 sc1
    s_waitcnt vmcnt(16)
    s_branch ka_kernel_late2
ka_kernel_late:
    s_waitcnt vmcnt(0)
ka_kernel_late2:
    s_barrier
    s_cmp_lg_u32 s32, 7
    s_cbranch_scc1 ka_kernel_nsg
    v_mov_b32 v19, s69
    v_mov_b32 v20, 0
    s_lshl_b32 s39, s33, 2
    s_and_b32 s39, s39, 15
    s_add_u32 s37, s71, s39
    s_add_u32 s38, s70, s39
    s_mov_b64 exec, 1
    buffer_store_dword v19, v20, s[72:75], s37 offen sc1
    buffer_store_dword v19, v20, s[72:75], s38 offen sc1
    s_mov_b64 exec, -1
ka_kernel_nsg:
    s_cmp_eq_u32 s66, 0
    s_cbranch_scc1 ka_kernel_rdy
    s_mov_b32 s37, 0
ka_kernel_sp_52:
    buffer_load_dword v15, v16, s[72:75], s70 offen sc1
    s_waitcnt vmcnt(0)
ka_kernel_sc_53:
    v_cmp_ne_u32 vcc, s69, v15
    s_add_u32 s37, s37, 1
    s_cbranch_vccz ka_kernel_ok_54
    s_cmp_lt_u32 s37, 0x40000
    s_cbranch_scc1 ka_kernel_sp_52
ka_kernel_ok_54:
    s_add_u32 s38, s56, 8192
    buffer_load_dwordx4 v[48:51], v2, s[8:11], s38 offen offset:0 sc1
    buffer_load_dwordx4 v[52:55], v17, s[8:11], s38 offen offset:0 sc1
    s_add_u32 s38, s56, 8192
    buffer_load_dwordx4 v[56:59], v2, s[8:11], s38 offen offset:1024 sc1
    buffer_load_dwordx4 v[60:63], v17, s[8:11], s38 offen offset:1024 sc1
    s_add_u32 s38, s56, 8192
    buffer_load_dwordx4 v[64:67], v2, s[8:11], s38 offen offset:2048 sc1
    buffer_load_dwordx4 v[68:71], v17, s[8:11], s38 offen offset:2048 sc1
    s_add_u32 s38, s56, 8192
    buffer_load_dwordx4 v[72:75], v2, s[8:11], s38 offen offset:3072 sc1
    buffer_load_dwordx4 v[76:79], v17, s[8:11], s38 offen offset:3072 sc1
    s_add_u32 s38, s56, 12288
    buffer_load_dwordx4 v[80:83], v2, s[8:11], s38 offen offset:0 sc1
    buffer_load_dwordx4 v[84:87], v17, s[8:11], s38 offen offset:0 sc1
    s_add_u32 s38, s56, 12288
    buffer_load_dwordx4 v[88:91], v2, s[8:11], s38 offen offset:1024 sc1
    buffer_load_dwordx4 v[92:95], v17, s[8:11], s38 offen offset:1024 sc1
    s_add_u32 s38, s56, 12288
    buffer_load_dwordx4 v[96:99], v2, s[8:11], s38 offen offset:2048 sc1
    buffer_load_dwordx4 v[100:103], v17, s[8:11], s38 offen offset:2048 sc1
    s_add_u32 s38, s56, 12288
    buffer_load_dwordx4 v[104:107], v2, s[8:11], s38 offen offset:3072 sc1
    buffer_load_dwordx4 v[108:111], v17, s[8:11], s38 offen offset:3072 sc1
ka_kernel_rdy:
    s_barrier
    ds_read_b64_tr_b16 v[24:25], v12 offset:18432
    ds_read_b64_tr_b16 v[26:27], v12 offset:23040
    ds_read_b64_tr_b16 v[28:29], v12 offset:18464
    ds_read_b64_tr_b16 v[30:31], v12 offset:23072
    ds_read_b64_tr_b16 v[32:33], v12 offset:18496
    ds_read_b64_tr_b16 v[34:35], v12 offset:23104
    ds_read_b64_tr_b16 v[36:37], v12 offset:18528
    ds_read_b64_tr_b16 v[38:39], v12 offset:23136
    ds_read_b64_tr_b16 v[40:41], v12 offset:18560
    ds_read_b64_tr_b16 v[42:43], v12 offset:23168
    s_waitcnt vmcnt(14)
    s_waitcnt lgkmcnt(8)
    v_mfma_f32_16x16x32_bf16 v[112:115], v[24:27], v[48:51], 0
    ds_read_b64_tr_b16 v[44:45], v12 offset:18592
    v_mfma_f32_16x16x32_bf16 v[148:151], v[24:27], v[52:55], 0
    ds_read_b64_tr_b16 v[46:47], v12 offset:23200
    s_waitcnt lgkmcnt(8)
    v_mfma_f32_16x16x32_bf16 v[116:119], v[28:31], v[48:51], 0
    ds_read_b64_tr_b16 v[24:25], v12 offset:18624
    v_mfma_f32_16x16x32_bf16 v[152:155], v[28:31], v[52:55], 0
    ds_read_b64_tr_b16 v[26:27], v12 offset:23232
    s_waitcnt lgkmcnt(8)
    v_mfma_f32_16x16x32_bf16 v[120:123], v[32:35], v[48:51], 0
    ds_read_b64_tr_b16 v[28:29], v12 offset:18656
    v_mfma_f32_16x16x32_bf16 v[156:159], v[32:35], v[52:55], 0
    ds_read_b64_tr_b16 v[30:31], v12 offset:23264
    s_waitcnt lgkmcnt(8)
    v_mfma_f32_16x16x32_bf16 v[124:127], v[36:39], v[48:51], 0
    ds_read_b64_tr_b16 v[32:33], v12 offset:18688
    v_mfma_f32_16x16x32_bf16 v[160:163], v[36:39], v[52:55], 0
    ds_read_b64_tr_b16 v[34:35], v12 offset:23296
    s_waitcnt lgkmcnt(8)
    v_mfma_f32_16x16x32_bf16 v[128:131], v[40:43], v[48:51], 0
    ds_read_b64_tr_b16 v[36:37], v12 offset:27648
    v_mfma_f32_16x16x32_bf16 v[164:167], v[40:43], v[52:55], 0
    ds_read_b64_tr_b16 v[38:39], v12 offset:32256
    s_waitcnt lgkmcnt(8)
    v_mfma_f32_16x16x32_bf16 v[132:135], v[44:47], v[48:51], 0
    ds_read_b64_tr_b16 v[40:41], v12 offset:27680
    v_mfma_f32_16x16x32_bf16 v[168:171], v[44:47], v[52:55], 0
    ds_read_b64_tr_b16 v[42:43], v12 offset:32288
    s_waitcnt lgkmcnt(8)
    v_mfma_f32_16x16x32_bf16 v[136:139], v[24:27], v[48:51], 0
    ds_read_b64_tr_b16 v[44:45], v12 offset:27712
    v_mfma_f32_16x16x32_bf16 v[172:175], v[24:27], v[52:55], 0
    ds_read_b64_tr_b16 v[46:47], v12 offset:32320
    s_waitcnt lgkmcnt(8)
    v_mfma_f32_16x16x32_bf16 v[140:143], v[28:31], v[48:51], 0
    ds_read_b64_tr_b16 v[24:25], v12 offset:27744
    v_mfma_f32_16x16x32_bf16 v[176:179], v[28:31], v[52:55], 0
    ds_read_b64_tr_b16 v[26:27], v12 offset:32352
    s_waitcnt lgkmcnt(8)
    v_mfma_f32_16x16x32_bf16 v[144:147], v[32:35], v[48:51], 0
    ds_read_b64_tr_b16 v[28:29], v12 offset:27776
    v_mfma_f32_16x16x32_bf16 v[180:183], v[32:35], v[52:55], 0
    ds_read_b64_tr_b16 v[30:31], v12 offset:32384
    s_add_u32 s38, s56, 0
    buffer_load_dwordx4 v[48:51], v2, s[8:11], s38 offen offset:0 sc1
    buffer_load_dwordx4 v[52:55], v17, s[8:11], s38 offen offset:0 sc1
    s_waitcnt vmcnt(14)
    s_waitcnt lgkmcnt(8)
    v_mfma_f32_16x16x32_bf16 v[112:115], v[36:39], v[56:59], v[112:115]
    ds_read_b64_tr_b16 v[32:33], v12 offset:27808
    v_mfma_f32_16x16x32_bf16 v[148:151], v[36:39], v[60:63], v[148:151]
    ds_read_b64_tr_b16 v[34:35], v12 offset:32416
    s_waitcnt lgkmcnt(8)
    v_mfma_f32_16x16x32_bf16 v[116:119], v[40:43], v[56:59], v[116:119]
    ds_read_b64_tr_b16 v[36:37], v12 offset:27840
    v_mfma_f32_16x16x32_bf16 v[152:155], v[40:43], v[60:63], v[152:155]
    ds_read_b64_tr_b16 v[38:39], v12 offset:32448
    s_waitcnt lgkmcnt(8)
    v_mfma_f32_16x16x32_bf16 v[120:123], v[44:47], v[56:59], v[120:123]
    ds_read_b64_tr_b16 v[40:41], v12 offset:27872
    v_mfma_f32_16x16x32_bf16 v[156:159], v[44:47], v[60:63], v[156:159]
    ds_read_b64_tr_b16 v[42:43], v12 offset:32480
    s_waitcnt lgkmcnt(8)
    v_mfma_f32_16x16x32_bf16 v[124:127], v[24:27], v[56:59], v[124:127]
    ds_read_b64_tr_b16 v[44:45], v12 offset:27904
    v_mfma_f32_16x16x32_bf16 v[160:163], v[24:27], v[60:63], v[160:163]
    ds_read_b64_tr_b16 v[46:47], v12 offset:32512
    s_waitcnt lgkmcnt(8)
    v_mfma_f32_16x16x32_bf16 v[128:131], v[28:31], v[56:59], v[128:131]
    ds_read_b64_tr_b16 v[24:25], v12 offset:36864
    v_mfma_f32_16x16x32_bf16 v[164:167], v[28:31], v[60:63], v[164:167]
    ds_read_b64_tr_b16 v[26:27], v12 offset:41472
    s_waitcnt lgkmcnt(8)
    v_mfma_f32_16x16x32_bf16 v[132:135], v[32:35], v[56:59], v[132:135]
    ds_read_b64_tr_b16 v[28:29], v12 offset:36896
    v_mfma_f32_16x16x32_bf16 v[168:171], v[32:35], v[60:63], v[168:171]
    ds_read_b64_tr_b16 v[30:31], v12 offset:41504
    s_waitcnt lgkmcnt(8)
    v_mfma_f32_16x16x32_bf16 v[136:139], v[36:39], v[56:59], v[136:139]
    ds_read_b64_tr_b16 v[32:33], v12 offset:36928
    v_mfma_f32_16x16x32_bf16 v[172:175], v[36:39], v[60:63], v[172:175]
    ds_read_b64_tr_b16 v[34:35], v12 offset:41536
    s_waitcnt lgkmcnt(8)
    v_mfma_f32_16x16x32_bf16 v[140:143], v[40:43], v[56:59], v[140:143]
    ds_read_b64_tr_b16 v[36:37], v12 offset:36960
    v_mfma_f32_16x16x32_bf16 v[176:179], v[40:43], v[60:63], v[176:179]
    ds_read_b64_tr_b16 v[38:39], v12 offset:41568
    s_waitcnt lgkmcnt(8)
    v_mfma_f32_16x16x32_bf16 v[144:147], v[44:47], v[56:59], v[144:147]
    ds_read_b64_tr_b16 v[40:41], v12 offset:36992
    v_mfma_f32_16x16x32_bf16 v[180:183], v[44:47], v[60:63], v[180:183]
    ds_read_b64_tr_b16 v[42:43], v12 offset:41600
    s_add_u32 s38, s56, 0
    buffer_load_dwordx4 v[56:59], v2, s[8:11], s38 offen offset:1024 sc1
    buffer_load_dwordx4 v[60:63], v17, s[8:11], s38 offen offset:1024 sc1
    s_waitcnt vmcnt(14)
    s_waitcnt lgkmcnt(8)
    v_mfma_f32_16x16x32_bf16 v[112:115], v[24:27], v[64:67], v[112:115]
    ds_read_b64_tr_b16 v[44:45], v12 offset:37024
    v_mfma_f32_16x16x32_bf16 v[148:151], v[24:27], v[68:71], v[148:151]
    ds_read_b64_tr_b16 v[46:47], v12 offset:41632
    s_waitcnt lgkmcnt(8)
    v_mfma_f32_16x16x32_bf16 v[116:119], v[28:31], v[64:67], v[116:119]
    ds_read_b64_tr_b16 v[24:25], v12 offset:37056
    v_mfma_f32_16x16x32_bf16 v[152:155], v[28:31], v[68:71], v[152:155]
    ds_read_b64_tr_b16 v[26:27], v12 offset:41664
    s_waitcnt lgkmcnt(8)
    v_mfma_f32_16x16x32_bf16 v[120:123], v[32:35], v[64:67], v[120:123]
    ds_read_b64_tr_b16 v[28:29], v12 offset:37088
    v_mfma_f32_16x16x32_bf16 v[156:159], v[32:35], v[68:71], v[156:159]
    ds_read_b64_tr_b16 v[30:31], v12 offset:41696
    s_waitcnt lgkmcnt(8)
    v_mfma_f32_16x16x32_bf16 v[124:127], v[36:39], v[64:67], v[124:127]
    ds_read_b64_tr_b16 v[32:33], v12 offset:37120
    v_mfma_f32_16x16x32_bf16 v[160:163], v[36:39], v[68:71], v[160:163]
    ds_read_b64_tr_b16 v[34:35], v12 offset:41728
    s_waitcnt lgkmcnt(8)
    v_mfma_f32_16x16x32_bf16 v[128:131], v[40:43], v[64:67], v[128:131]
    ds_read_b64_tr_b16 v[36:37], v12 offset:46080
    v_mfma_f32_16x16x32_bf16 v[164:167], v[40:43], v[68:71], v[164:167]
    ds_read_b64_tr_b16 v[38:39], v12 offset:50688
    s_waitcnt lgkmcnt(8)
    v_mfma_f32_16x16x32_bf16 v[132:135], v[44:47], v[64:67], v[132:135]
    ds_read_b64_tr_b16 v[40:41], v12 offset:46112
    v_mfma_f32_16x16x32_bf16 v[168:171], v[44:47], v[68:71], v[168:171]
    ds_read_b64_tr_b16 v[42:43], v12 offset:50720
    s_waitcnt lgkmcnt(8)
    v_mfma_f32_16x16x32_bf16 v[136:139], v[24:27], v[64:67], v[136:139]
    ds_read_b64_tr_b16 v[44:45], v12 offset:46144
    v_mfma_f32_16x16x32_bf16 v[172:175], v[24:27], v[68:71], v[172:175]
    ds_read_b64_tr_b16 v[46:47], v12 offset:50752
    s_waitcnt lgkmcnt(8)
    v_mfma_f32_16x16x32_bf16 v[140:143], v[28:31], v[64:67], v[140:143]
    ds_read_b64_tr_b16 v[24:25], v12 offset:46176
    v_mfma_f32_16x16x32_bf16 v[176:179], v[28:31], v[68:71], v[176:179]
    ds_read_b64_tr_b16 v[26:27], v12 offset:50784
    s_waitcnt lgkmcnt(8)
    v_mfma_f32_16x16x32_bf16 v[144:147], v[32:35], v[64:67], v[144:147]
    ds_read_b64_tr_b16 v[28:29], v12 offset:46208
    v_mfma_f32_16x16x32_bf16 v[180:183], v[32:35], v[68:71], v[180:183]
    ds_read_b64_tr_b16 v[30:31], v12 offset:50816
    s_add_u32 s38, s56, 0
    buffer_load_dwordx4 v[64:67], v2, s[8:11], s38 offen offset:2048 sc1
    buffer_load_dwordx4 v[68:71], v17, s[8:11], s38 offen offset:2048 sc1
    s_waitcnt vmcnt(14)
    s_waitcnt lgkmcnt(8)
    v_mfma_f32_16x16x32_bf16 v[112:115], v[36:39], v[72:75], v[112:115]
    ds_read_b64_tr_b16 v[32:33], v12 offset:46240
    v_mfma_f32_16x16x32_bf16 v[148:151], v[36:39], v[76:79], v[148:151]
    ds_read_b64_tr_b16 v[34:35], v12 offset:50848
    s_waitcnt lgkmcnt(8)
    v_mfma_f32_16x16x32_bf16 v[116:119], v[40:43], v[72:75], v[116:119]
    ds_read_b64_tr_b16 v[36:37], v12 offset:46272
    v_mfma_f32_16x16x32_bf16 v[152:155], v[40:43], v[76:79], v[152:155]
    ds_read_b64_tr_b16 v[38:39], v12 offset:50880
    s_waitcnt lgkmcnt(8)
    v_mfma_f32_16x16x32_bf16 v[120:123], v[44:47], v[72:75], v[120:123]
    ds_read_b64_tr_b16 v[40:41], v12 offset:46304
    v_mfma_f32_16x16x32_bf16 v[156:159], v[44:47], v[76:79], v[156:159]
    ds_read_b64_tr_b16 v[42:43], v12 offset:50912
    s_waitcnt lgkmcnt(8)
    v_mfma_f32_16x16x32_bf16 v[124:127], v[24:27], v[72:75], v[124:127]
    ds_read_b64_tr_b16 v[44:45], v12 offset:46336
    v_mfma_f32_16x16x32_bf16 v[160:163], v[24:27], v[76:79], v[160:163]
    ds_read_b64_tr_b16 v[46:47], v12 offset:50944
    s_waitcnt lgkmcnt(8)
    v_mfma_f32_16x16x32_bf16 v[128:131], v[28:31], v[72:75], v[128:131]
    ds_read_b64_tr_b16 v[24:25], v13 offset:0
    v_mfma_f32_16x16x32_bf16 v[164:167], v[28:31], v[76:79], v[164:167]
    ds_read_b64_tr_b16 v[26:27], v13 offset:4608
    s_waitcnt lgkmcnt(8)
    v_mfma_f32_16x16x32_bf16 v[132:135], v[32:35], v[72:75], v[132:135]
    ds_read_b64_tr_b16 v[28:29], v13 offset:32
    v_mfma_f32_16x16x32_bf16 v[168:171], v[32:35], v[76:79], v[168:171]
    ds_read_b64_tr_b16 v[30:31], v13 offset:4640
    s_waitcnt lgkmcnt(8)
    v_mfma_f32_16x16x32_bf16 v[136:139], v[36:39], v[72:75], v[136:139]
    ds_read_b64_tr_b16 v[32:33], v13 offset:64
    v_mfma_f32_16x16x32_bf16 v[172:175], v[36:39], v[76:79], v[172:175]
    ds_read_b64_tr_b16 v[34:35], v13 offset:4672
    s_waitcnt lgkmcnt(8)
    v_mfma_f32_16x16x32_bf16 v[140:143], v[40:43], v[72:75], v[140:143]
    ds_read_b64_tr_b16 v[36:37], v13 offset:96
    v_mfma_f32_16x16x32_bf16 v[176:179], v[40:43], v[76:79], v[176:179]
    ds_read_b64_tr_b16 v[38:39], v13 offset:4704
    s_waitcnt lgkmcnt(8)
    v_mfma_f32_16x16x32_bf16 v[144:147], v[44:47], v[72:75], v[144:147]
    ds_read_b64_tr_b16 v[40:41], v13 offset:128
    v_mfma_f32_16x16x32_bf16 v[180:183], v[44:47], v[76:79], v[180:183]
    ds_read_b64_tr_b16 v[42:43], v13 offset:4736
    s_add_u32 s38, s56, 0
    buffer_load_dwordx4 v[72:75], v2, s[8:11], s38 offen offset:3072 sc1
    buffer_load_dwordx4 v[76:79], v17, s[8:11], s38 offen offset:3072 sc1
    buffer_load_dword v15, v16, s[72:75], s71 offen sc1
    s_waitcnt vmcnt(15)
    s_waitcnt lgkmcnt(8)
    v_mfma_f32_16x16x32_bf16 v[112:115], v[24:27], v[80:83], v[112:115]
    ds_read_b64_tr_b16 v[44:45], v13 offset:160
    v_mfma_f32_16x16x32_bf16 v[148:151], v[24:27], v[84:87], v[148:151]
    ds_read_b64_tr_b16 v[46:47], v13 offset:4768
    s_waitcnt lgkmcnt(8)
    v_mfma_f32_16x16x32_bf16 v[116:119], v[28:31], v[80:83], v[116:119]
    ds_read_b64_tr_b16 v[24:25], v13 offset:192
    v_mfma_f32_16x16x32_bf16 v[152:155], v[28:31], v[84:87], v[152:155]
    ds_read_b64_tr_b16 v[26:27], v13 offset:4800
    s_waitcnt lgkmcnt(8)
    v_mfma_f32_16x16x32_bf16 v[120:123], v[32:35], v[80:83], v[120:123]
    ds_read_b64_tr_b16 v[28:29], v13 offset:224
    v_mfma_f32_16x16x32_bf16 v[156:159], v[32:35], v[84:87], v[156:159]
    ds_read_b64_tr_b16 v[30:31], v13 offset:4832
    s_waitcnt lgkmcnt(8)
    v_mfma_f32_16x16x32_bf16 v[124:127], v[36:39], v[80:83], v[124:127]
    ds_read_b64_tr_b16 v[32:33], v13 offset:256
    v_mfma_f32_16x16x32_bf16 v[160:163], v[36:39], v[84:87], v[160:163]
    ds_read_b64_tr_b16 v[34:35], v13 offset:4864
    s_waitcnt lgkmcnt(8)
    v_mfma_f32_16x16x32_bf16 v[128:131], v[40:43], v[80:83], v[128:131]
    ds_read_b64_tr_b16 v[36:37], v13 offset:9216
    v_mfma_f32_16x16x32_bf16 v[164:167], v[40:43], v[84:87], v[164:167]
    ds_read_b64_tr_b16 v[38:39], v13 offset:13824
    s_waitcnt lgkmcnt(8)
    v_mfma_f32_16x16x32_bf16 v[132:135], v[44:47], v[80:83], v[132:135]
    ds_read_b64_tr_b16 v[40:41], v13 offset:9248
    v_mfma_f32_16x16x32_bf16 v[168:171], v[44:47], v[84:87], v[168:171]
    ds_read_b64_tr_b16 v[42:43], v13 offset:13856
    s_waitcnt lgkmcnt(8)
    v_mfma_f32_16x16x32_bf16 v[136:139], v[24:27], v[80:83], v[136:139]
    ds_read_b64_tr_b16 v[44:45], v13 offset:9280
    v_mfma_f32_16x16x32_bf16 v[172:175], v[24:27], v[84:87], v[172:175]
    ds_read_b64_tr_b16 v[46:47], v13 offset:13888
    s_waitcnt lgkmcnt(8)
    v_mfma_f32_16x16x32_bf16 v[140:143], v[28:31], v[80:83], v[140:143]
    ds_read_b64_tr_b16 v[24:25], v13 offset:9312
    v_mfma_f32_16x16x32_bf16 v[176:179], v[28:31], v[84:87], v[176:179]
    ds_read_b64_tr_b16 v[26:27], v13 offset:13920
    s_waitcnt lgkmcnt(8)
    v_mfma_f32_16x16x32_bf16 v[144:147], v[32:35], v[80:83], v[144:147]
    ds_read_b64_tr_b16 v[28:29], v13 offset:9344
    v_mfma_f32_16x16x32_bf16 v[180:183], v[32:35], v[84:87], v[180:183]
    ds_read_b64_tr_b16 v[30:31], v13 offset:13952
    s_add_u32 s38, s56, 4096
    buffer_load_dwordx4 v[80:83], v2, s[8:11], s38 offen offset:0 sc1
    buffer_load_dwordx4 v[84:87], v17, s[8:11], s38 offen offset:0 sc1
    s_waitcnt vmcnt(15)
    s_waitcnt lgkmcnt(8)
    v_mfma_f32_16x16x32_bf16 v[112:115], v[36:39], v[88:91], v[112:115]
    ds_read_b64_tr_b16 v[32:33], v13 offset:9376
    v_mfma_f32_16x16x32_bf16 v[148:151], v[36:39], v[92:95], v[148:151]
    ds_read_b64_tr_b16 v[34:35], v13 offset:13984
    s_waitcnt lgkmcnt(8)
    v_mfma_f32_16x16x32_bf16 v[116:119], v[40:43], v[88:91], v[116:119]
    ds_read_b64_tr_b16 v[36:37], v13 offset:9408
    v_mfma_f32_16x16x32_bf16 v[152:155], v[40:43], v[92:95], v[152:155]
    ds_read_b64_tr_b16 v[38:39], v13 offset:14016
    s_waitcnt lgkmcnt(8)
    v_mfma_f32_16x16x32_bf16 v[120:123], v[44:47], v[88:91], v[120:123]
    ds_read_b64_tr_b16 v[40:41], v13 offset:9440
    v_mfma_f32_16x16x32_bf16 v[156:159], v[44:47], v[92:95], v[156:159]
    ds_read_b64_tr_b16 v[42:43], v13 offset:14048
    s_waitcnt lgkmcnt(8)
    v_mfma_f32_16x16x32_bf16 v[124:127], v[24:27], v[88:91], v[124:127]
    ds_read_b64_tr_b16 v[44:45], v13 offset:9472
    v_mfma_f32_16x16x32_bf16 v[160:163], v[24:27], v[92:95], v[160:163]
    ds_read_b64_tr_b16 v[46:47], v13 offset:14080
    s_waitcnt lgkmcnt(8)
    v_mfma_f32_16x16x32_bf16 v[128:131], v[28:31], v[88:91], v[128:131]
    ds_read_b64_tr_b16 v[24:25], v13 offset:18432
    v_mfma_f32_16x16x32_bf16 v[164:167], v[28:31], v[92:95], v[164:167]
    ds_read_b64_tr_b16 v[26:27], v13 offset:23040
    s_waitcnt lgkmcnt(8)
    v_mfma_f32_16x16x32_bf16 v[132:135], v[32:35], v[88:91], v[132:135]
    ds_read_b64_tr_b16 v[28:29], v13 offset:18464
    v_mfma_f32_16x16x32_bf16 v[168:171], v[32:35], v[92:95], v[168:171]
    ds_read_b64_tr_b16 v[30:31], v13 offset:23072
    s_waitcnt lgkmcnt(8)
    v_mfma_f32_16x16x32_bf16 v[136:139], v[36:39], v[88:91], v[136:139]
    ds_read_b64_tr_b16 v[32:33], v13 offset:18496
    v_mfma_f32_16x16x32_bf16 v[172:175], v[36:39], v[92:95], v[172:175]
    ds_read_b64_tr_b16 v[34:35], v13 offset:23104
    s_waitcnt lgkmcnt(8)
    v_mfma_f32_16x16x32_bf16 v[140:143], v[40:43], v[88:91], v[140:143]
    ds_read_b64_tr_b16 v[36:37], v13 offset:18528
    v_mfma_f32_16x16x32_bf16 v[176:179], v[40:43], v[92:95], v[176:179]
    ds_read_b64_tr_b16 v[38:39], v13 offset:23136
    s_waitcnt lgkmcnt(8)
    v_mfma_f32_16x16x32_bf16 v[144:147], v[44:47], v[88:91], v[144:147]
    ds_read_b64_tr_b16 v[40:41], v13 offset:18560
    v_mfma_f32_16x16x32_bf16 v[180:183], v[44:47], v[92:95], v[180:183]
    ds_read_b64_tr_b16 v[42:43], v13 offset:23168
    s_add_u32 s38, s56, 4096
    buffer_load_dwordx4 v[88:91], v2, s[8:11], s38 offen offset:1024 sc1
    buffer_load_dwordx4 v[92:95], v17, s[8:11], s38 offen offset:1024 sc1
    s_waitcnt vmcnt(15)
    s_waitcnt lgkmcnt(8)
    v_mfma_f32_16x16x32_bf16 v[112:115], v[24:27], v[96:99], v[112:115]
    ds_read_b64_tr_b16 v[44:45], v13 offset:18592
    v_mfma_f32_16x16x32_bf16 v[148:151], v[24:27], v[100:103], v[148:151]
    ds_read_b64_tr_b16 v[46:47], v13 offset:23200
    s_waitcnt lgkmcnt(8)
    v_mfma_f32_16x16x32_bf16 v[116:119], v[28:31], v[96:99], v[116:119]
    ds_read_b64_tr_b16 v[24:25], v13 offset:18624
    v_mfma_f32_16x16x32_bf16 v[152:155], v[28:31], v[100:103], v[152:155]
    ds_read_b64_tr_b16 v[26:27], v13 offset:23232
    s_waitcnt lgkmcnt(8)
    v_mfma_f32_16x16x32_bf16 v[120:123], v[32:35], v[96:99], v[120:123]
    ds_read_b64_tr_b16 v[28:29], v13 offset:18656
    v_mfma_f32_16x16x32_bf16 v[156:159], v[32:35], v[100:103], v[156:159]
    ds_read_b64_tr_b16 v[30:31], v13 offset:23264
    s_waitcnt lgkmcnt(8)
    v_mfma_f32_16x16x32_bf16 v[124:127], v[36:39], v[96:99], v[124:127]
    ds_read_b64_tr_b16 v[32:33], v13 offset:18688
    v_mfma_f32_16x16x32_bf16 v[160:163], v[36:39], v[100:103], v[160:163]
    ds_read_b64_tr_b16 v[34:35], v13 offset:23296
    s_waitcnt lgkmcnt(8)
    v_mfma_f32_16x16x32_bf16 v[128:131], v[40:43], v[96:99], v[128:131]
    ds_read_b64_tr_b16 v[36:37], v13 offset:27648
    v_mfma_f32_16x16x32_bf16 v[164:167], v[40:43], v[100:103], v[164:167]
    ds_read_b64_tr_b16 v[38:39], v13 offset:32256
    s_waitcnt lgkmcnt(8)
    v_mfma_f32_16x16x32_bf16 v[132:135], v[44:47], v[96:99], v[132:135]
    ds_read_b64_tr_b16 v[40:41], v13 offset:27680
    v_mfma_f32_16x16x32_bf16 v[168:171], v[44:47], v[100:103], v[168:171]
    ds_read_b64_tr_b16 v[42:43], v13 offset:32288
    s_waitcnt lgkmcnt(8)
    v_mfma_f32_16x16x32_bf16 v[136:139], v[24:27], v[96:99], v[136:139]
    ds_read_b64_tr_b16 v[44:45], v13 offset:27712
    v_mfma_f32_16x16x32_bf16 v[172:175], v[24:27], v[100:103], v[172:175]
    ds_read_b64_tr_b16 v[46:47], v13 offset:32320
    s_waitcnt lgkmcnt(8)
    v_mfma_f32_16x16x32_bf16 v[140:143], v[28:31], v[96:99], v[140:143]
    ds_read_b64_tr_b16 v[24:25], v13 offset:27744
    v_mfma_f32_16x16x32_bf16 v[176:179], v[28:31], v[100:103], v[176:179]
    ds_read_b64_tr_b16 v[26:27], v13 offset:32352
    s_waitcnt lgkmcnt(8)
    v_mfma_f32_16x16x32_bf16 v[144:147], v[32:35], v[96:99], v[144:147]
    ds_read_b64_tr_b16 v[28:29], v13 offset:27776
    v_mfma_f32_16x16x32_bf16 v[180:183], v[32:35], v[100:103], v[180:183]
    ds_read_b64_tr_b16 v[30:31], v13 offset:32384
    s_add_u32 s38, s56, 4096
    buffer_load_dwordx4 v[96:99], v2, s[8:11], s38 offen offset:2048 sc1
    buffer_load_dwordx4 v[100:103], v17, s[8:11], s38 offen offset:2048 sc1
    s_waitcnt vmcnt(15)
    s_waitcnt lgkmcnt(8)
    v_mfma_f32_16x16x32_bf16 v[112:115], v[36:39], v[104:107], v[112:115]
    ds_read_b64_tr_b16 v[32:33], v13 offset:27808
    v_mfma_f32_16x16x32_bf16 v[148:151], v[36:39], v[108:111], v[148:151]
    ds_read_b64_tr_b16 v[34:35], v13 offset:32416
    s_waitcnt lgkmcnt(8)
    v_mfma_f32_16x16x32_bf16 v[116:119], v[40:43], v[104:107], v[116:119]
    ds_read_b64_tr_b16 v[36:37], v13 offset:27840
    v_mfma_f32_16x16x32_bf16 v[152:155], v[40:43], v[108:111], v[152:155]
    ds_read_b64_tr_b16 v[38:39], v13 offset:32448
    s_waitcnt lgkmcnt(8)
    v_mfma_f32_16x16x32_bf16 v[120:123], v[44:47], v[104:107], v[120:123]
    ds_read_b64_tr_b16 v[40:41], v13 offset:27872
    v_mfma_f32_16x16x32_bf16 v[156:159], v[44:47], v[108:111], v[156:159]
    ds_read_b64_tr_b16 v[42:43], v13 offset:32480
    s_waitcnt lgkmcnt(8)
    v_mfma_f32_16x16x32_bf16 v[124:127], v[24:27], v[104:107], v[124:127]
    ds_read_b64_tr_b16 v[44:45], v13 offset:27904
    v_mfma_f32_16x16x32_bf16 v[160:163], v[24:27], v[108:111], v[160:163]
    ds_read_b64_tr_b16 v[46:47], v13 offset:32512
    s_waitcnt lgkmcnt(8)
    v_mfma_f32_16x16x32_bf16 v[128:131], v[28:31], v[104:107], v[128:131]
    v_mfma_f32_16x16x32_bf16 v[164:167], v[28:31], v[108:111], v[164:167]
    s_waitcnt lgkmcnt(6)
    v_mfma_f32_16x16x32_bf16 v[132:135], v[32:35], v[104:107], v[132:135]
    v_mfma_f32_16x16x32_bf16 v[168:171], v[32:35], v[108:111], v[168:171]
    s_waitcnt lgkmcnt(4)
    v_mfma_f32_16x16x32_bf16 v[136:139], v[36:39], v[104:107], v[136:139]
    v_mfma_f32_16x16x32_bf16 v[172:175], v[36:39], v[108:111], v[172:175]
    s_waitcnt lgkmcnt(2)
    v_mfma_f32_16x16x32_bf16 v[140:143], v[40:43], v[104:107], v[140:143]
    v_mfma_f32_16x16x32_bf16 v[176:179], v[40:43], v[108:111], v[176:179]
    s_waitcnt lgkmcnt(0)
    v_mfma_f32_16x16x32_bf16 v[144:147], v[44:47], v[104:107], v[144:147]
    v_mfma_f32_16x16x32_bf16 v[180:183], v[44:47], v[108:111], v[180:183]
    s_add_u32 s38, s56, 4096
    buffer_load_dwordx4 v[104:107], v2, s[8:11], s38 offen offset:3072 sc1
    buffer_load_dwordx4 v[108:111], v17, s[8:11], s38 offen offset:3072 sc1
    s_barrier
    s_waitcnt vmcnt(8)
    s_mov_b32 s37, 0
    s_branch ka_kernel_sc_56
ka_kernel_sp_55:
    buffer_load_dword v15, v16, s[72:75], s71 offen sc1
    s_waitcnt vmcnt(0)
ka_kernel_sc_56:
    v_cmp_ne_u32 vcc, s69, v15
    s_add_u32 s37, s37, 1
    s_cbranch_vccz ka_kernel_ok_57
    s_cmp_lt_u32 s37, 0x40000
    s_cbranch_scc1 ka_kernel_sp_55
ka_kernel_ok_57:
    ds_read_b64_tr_b16 v[24:25], v11 offset:0
    ds_read_b64_tr_b16 v[26:27], v11 offset:4608
    ds_read_b64_tr_b16 v[28:29], v11 offset:32
    ds_read_b64_tr_b16 v[30:31], v11 offset:4640
    ds_read_b64_tr_b16 v[32:33], v11 offset:64
    ds_read_b64_tr_b16 v[34:35], v11 offset:4672
    ds_read_b64_tr_b16 v[36:37], v11 offset:96
    ds_read_b64_tr_b16 v[38:39], v11 offset:4704
    ds_read_b64_tr_b16 v[40:41], v11 offset:128
    ds_read_b64_tr_b16 v[42:43], v11 offset:4736
    s_waitcnt vmcnt(15)
    s_waitcnt lgkmcnt(8)
    v_mfma_f32_16x16x32_bf16 v[112:115], v[24:27], v[48:51], v[112:115]
    ds_read_b64_tr_b16 v[44:45], v11 offset:160
    v_mfma_f32_16x16x32_bf16 v[148:151], v[24:27], v[52:55], v[148:151]
    ds_read_b64_tr_b16 v[46:47], v11 offset:4768
    s_waitcnt lgkmcnt(8)
    v_mfma_f32_16x16x32_bf16 v[116:119], v[28:31], v[48:51], v[116:119]
    ds_read_b64_tr_b16 v[24:25], v11 offset:192
    v_mfma_f32_16x16x32_bf16 v[152:155], v[28:31], v[52:55], v[152:155]
    ds_read_b64_tr_b16 v[26:27], v11 offset:4800
    s_waitcnt lgkmcnt(8)
    v_mfma_f32_16x16x32_bf16 v[120:123], v[32:35], v[48:51], v[120:123]
    ds_read_b64_tr_b16 v[28:29], v11 offset:224
    v_mfma_f32_16x16x32_bf16 v[156:159], v[32:35], v[52:55], v[156:159]
    ds_read_b64_tr_b16 v[30:31], v11 offset:4832
    s_waitcnt lgkmcnt(8)
    v_mfma_f32_16x16x32_bf16 v[124:127], v[36:39], v[48:51], v[124:127]
    ds_read_b64_tr_b16 v[32:33], v11 offset:256
    v_mfma_f32_16x16x32_bf16 v[160:163], v[36:39], v[52:55], v[160:163]
    ds_read_b64_tr_b16 v[34:35], v11 offset:4864
    s_waitcnt lgkmcnt(8)
    v_mfma_f32_16x16x32_bf16 v[128:131], v[40:43], v[48:51], v[128:131]
    ds_read_b64_tr_b16 v[36:37], v11 offset:9216
    v_mfma_f32_16x16x32_bf16 v[164:167], v[40:43], v[52:55], v[164:167]
    ds_read_b64_tr_b16 v[38:39], v11 offset:13824
    s_waitcnt lgkmcnt(8)
    v_mfma_f32_16x16x32_bf16 v[132:135], v[44:47], v[48:51], v[132:135]
    ds_read_b64_tr_b16 v[40:41], v11 offset:9248
    v_mfma_f32_16x16x32_bf16 v[168:171], v[44:47], v[52:55], v[168:171]
    ds_read_b64_tr_b16 v[42:43], v11 offset:13856
    s_waitcnt lgkmcnt(8)
    v_mfma_f32_16x16x32_bf16 v[136:139], v[24:27], v[48:51], v[136:139]
    ds_read_b64_tr_b16 v[44:45], v11 offset:9280
    v_mfma_f32_16x16x32_bf16 v[172:175], v[24:27], v[52:55], v[172:175]
    ds_read_b64_tr_b16 v[46:47], v11 offset:13888
    s_waitcnt lgkmcnt(8)
    v_mfma_f32_16x16x32_bf16 v[140:143], v[28:31], v[48:51], v[140:143]
    ds_read_b64_tr_b16 v[24:25], v11 offset:9312
    v_mfma_f32_16x16x32_bf16 v[176:179], v[28:31], v[52:55], v[176:179]
    ds_read_b64_tr_b16 v[26:27], v11 offset:13920
    s_waitcnt lgkmcnt(8)
    v_mfma_f32_16x16x32_bf16 v[144:147], v[32:35], v[48:51], v[144:147]
    ds_read_b64_tr_b16 v[28:29], v11 offset:9344
    v_mfma_f32_16x16x32_bf16 v[180:183], v[32:35], v[52:55], v[180:183]
    ds_read_b64_tr_b16 v[30:31], v11 offset:13952
    s_add_u32 s38, s57, 8192
    buffer_load_dwordx4 v[48:51], v2, s[8:11], s38 offen offset:0 sc1
    buffer_load_dwordx4 v[52:55], v17, s[8:11], s38 offen offset:0 sc1
    s_waitcnt vmcnt(15)
    s_waitcnt lgkmcnt(8)
    v_mfma_f32_16x16x32_bf16 v[112:115], v[36:39], v[56:59], v[112:115]
    ds_read_b64_tr_b16 v[32:33], v11 offset:9376
    v_mfma_f32_16x16x32_bf16 v[148:151], v[36:39], v[60:63], v[148:151]
    ds_read_b64_tr_b16 v[34:35], v11 offset:13984
    s_waitcnt lgkmcnt(8)
    v_mfma_f32_16x16x32_bf16 v[116:119], v[40:43], v[56:59], v[116:119]
    ds_read_b64_tr_b16 v[36:37], v11 offset:9408
    v_mfma_f32_16x16x32_bf16 v[152:155], v[40:43], v[60:63], v[152:155]
    ds_read_b64_tr_b16 v[38:39], v11 offset:14016
    s_waitcnt lgkmcnt(8)
    v_mfma_f32_16x16x32_bf16 v[120:123], v[44:47], v[56:59], v[120:123]
    ds_read_b64_tr_b16 v[40:41], v11 offset:9440
    v_mfma_f32_16x16x32_bf16 v[156:159], v[44:47], v[60:63], v[156:159]
    ds_read_b64_tr_b16 v[42:43], v11 offset:14048
    s_waitcnt lgkmcnt(8)
    v_mfma_f32_16x16x32_bf16 v[124:127], v[24:27], v[56:59], v[124:127]
    ds_read_b64_tr_b16 v[44:45], v11 offset:9472
    v_mfma_f32_16x16x32_bf16 v[160:163], v[24:27], v[60:63], v[160:163]
    ds_read_b64_tr_b16 v[46:47], v11 offset:14080
    s_waitcnt lgkmcnt(8)
    v_mfma_f32_16x16x32_bf16 v[128:131], v[28:31], v[56:59], v[128:131]
    ds_read_b64_tr_b16 v[24:25], v11 offset:18432
    v_mfma_f32_16x16x32_bf16 v[164:167], v[28:31], v[60:63], v[164:167]
    ds_read_b64_tr_b16 v[26:27], v11 offset:23040
    s_waitcnt lgkmcnt(8)
    v_mfma_f32_16x16x32_bf16 v[132:135], v[32:35], v[56:59], v[132:135]
    ds_read_b64_tr_b16 v[28:29], v11 offset:18464
    v_mfma_f32_16x16x32_bf16 v[168:171], v[32:35], v[60:63], v[168:171]
    ds_read_b64_tr_b16 v[30:31], v11 offset:23072
    s_waitcnt lgkmcnt(8)
    v_mfma_f32_16x16x32_bf16 v[136:139], v[36:39], v[56:59], v[136:139]
    ds_read_b64_tr_b16 v[32:33], v11 offset:18496
    v_mfma_f32_16x16x32_bf16 v[172:175], v[36:39], v[60:63], v[172:175]
    ds_read_b64_tr_b16 v[34:35], v11 offset:23104
    s_waitcnt lgkmcnt(8)
    v_mfma_f32_16x16x32_bf16 v[140:143], v[40:43], v[56:59], v[140:143]
    ds_read_b64_tr_b16 v[36:37], v11 offset:18528
    v_mfma_f32_16x16x32_bf16 v[176:179], v[40:43], v[60:63], v[176:179]
    ds_read_b64_tr_b16 v[38:39], v11 offset:23136
    s_waitcnt lgkmcnt(8)
    v_mfma_f32_16x16x32_bf16 v[144:147], v[44:47], v[56:59], v[144:147]
    ds_read_b64_tr_b16 v[40:41], v11 offset:18560
    v_mfma_f32_16x16x32_bf16 v[180:183], v[44:47], v[60:63], v[180:183]
    ds_read_b64_tr_b16 v[42:43], v11 offset:23168
    s_add_u32 s38, s57, 8192
    buffer_load_dwordx4 v[56:59], v2, s[8:11], s38 offen offset:1024 sc1
    buffer_load_dwordx4 v[60:63], v17, s[8:11], s38 offen offset:1024 sc1
    s_waitcnt vmcnt(15)
    s_waitcnt lgkmcnt(8)
    v_mfma_f32_16x16x32_bf16 v[112:115], v[24:27], v[64:67], v[112:115]
    ds_read_b64_tr_b16 v[44:45], v11 offset:18592
    v_mfma_f32_16x16x32_bf16 v[148:151], v[24:27], v[68:71], v[148:151]
    ds_read_b64_tr_b16 v[46:47], v11 offset:23200
    s_waitcnt lgkmcnt(8)
    v_mfma_f32_16x16x32_bf16 v[116:119], v[28:31], v[64:67], v[116:119]
    ds_read_b64_tr_b16 v[24:25], v11 offset:18624
    v_mfma_f32_16x16x32_bf16 v[152:155], v[28:31], v[68:71], v[152:155]
    ds_read_b64_tr_b16 v[26:27], v11 offset:23232
    s_waitcnt lgkmcnt(8)
    v_mfma_f32_16x16x32_bf16 v[120:123], v[32:35], v[64:67], v[120:123]
    ds_read_b64_tr_b16 v[28:29], v11 offset:18656
    v_mfma_f32_16x16x32_bf16 v[156:159], v[32:35], v[68:71], v[156:159]
    ds_read_b64_tr_b16 v[30:31], v11 offset:23264
    s_waitcnt lgkmcnt(8)
    v_mfma_f32_16x16x32_bf16 v[124:127], v[36:39], v[64:67], v[124:127]
    ds_read_b64_tr_b16 v[32:33], v11 offset:18688
    v_mfma_f32_16x16x32_bf16 v[160:163], v[36:39], v[68:71], v[160:163]
    ds_read_b64_tr_b16 v[34:35], v11 offset:23296
    s_waitcnt lgkmcnt(8)
    v_mfma_f32_16x16x32_bf16 v[128:131], v[40:43], v[64:67], v[128:131]
    ds_read_b64_tr_b16 v[36:37], v11 offset:27648
    v_mfma_f32_16x16x32_bf16 v[164:167], v[40:43], v[68:71], v[164:167]
    ds_read_b64_tr_b16 v[38:39], v11 offset:32256
    s_waitcnt lgkmcnt(8)
    v_mfma_f32_16x16x32_bf16 v[132:135], v[44:47], v[64:67], v[132:135]
    ds_read_b64_tr_b16 v[40:41], v11 offset:27680
    v_mfma_f32_16x16x32_bf16 v[168:171], v[44:47], v[68:71], v[168:171]
    ds_read_b64_tr_b16 v[42:43], v11 offset:32288
    s_waitcnt lgkmcnt(8)
    v_mfma_f32_16x16x32_bf16 v[136:139], v[24:27], v[64:67], v[136:139]
    ds_read_b64_tr_b16 v[44:45], v11 offset:27712
    v_mfma_f32_16x16x32_bf16 v[172:175], v[24:27], v[68:71], v[172:175]
    ds_read_b64_tr_b16 v[46:47], v11 offset:32320
    s_waitcnt lgkmcnt(8)
    v_mfma_f32_16x16x32_bf16 v[140:143], v[28:31], v[64:67], v[140:143]
    ds_read_b64_tr_b16 v[24:25], v11 offset:27744
    v_mfma_f32_16x16x32_bf16 v[176:179], v[28:31], v[68:71], v[176:179]
    ds_read_b64_tr_b16 v[26:27], v11 offset:32352
    s_waitcnt lgkmcnt(8)
    v_mfma_f32_16x16x32_bf16 v[144:147], v[32:35], v[64:67], v[144:147]
    ds_read_b64_tr_b16 v[28:29], v11 offset:27776
    v_mfma_f32_16x16x32_bf16 v[180:183], v[32:35], v[68:71], v[180:183]
    ds_read_b64_tr_b16 v[30:31], v11 offset:32384
    s_add_u32 s38, s57, 8192
    buffer_load_dwordx4 v[64:67], v2, s[8:11], s38 offen offset:2048 sc1
    buffer_load_dwordx4 v[68:71], v17, s[8:11], s38 offen offset:2048 sc1
    s_waitcnt vmcnt(15)
    s_waitcnt lgkmcnt(8)
    v_mfma_f32_16x16x32_bf16 v[112:115], v[36:39], v[72:75], v[112:115]
    ds_read_b64_tr_b16 v[32:33], v11 offset:27808
    v_mfma_f32_16x16x32_bf16 v[148:151], v[36:39], v[76:79], v[148:151]
    ds_read_b64_tr_b16 v[34:35], v11 offset:32416
    s_waitcnt lgkmcnt(8)
    v_mfma_f32_16x16x32_bf16 v[116:119], v[40:43], v[72:75], v[116:119]
    ds_read_b64_tr_b16 v[36:37], v11 offset:27840
    v_mfma_f32_16x16x32_bf16 v[152:155], v[40:43], v[76:79], v[152:155]
    ds_read_b64_tr_b16 v[38:39], v11 offset:32448
    s_waitcnt lgkmcnt(8)
    v_mfma_f32_16x16x32_bf16 v[120:123], v[44:47], v[72:75], v[120:123]
    ds_read_b64_tr_b16 v[40:41], v11 offset:27872
    v_mfma_f32_16x16x32_bf16 v[156:159], v[44:47], v[76:79], v[156:159]
    ds_read_b64_tr_b16 v[42:43], v11 offset:32480
    s_waitcnt lgkmcnt(8)
    v_mfma_f32_16x16x32_bf16 v[124:127], v[24:27], v[72:75], v[124:127]
    ds_read_b64_tr_b16 v[44:45], v11 offset:27904
    v_mfma_f32_16x16x32_bf16 v[160:163], v[24:27], v[76:79], v[160:163]
    ds_read_b64_tr_b16 v[46:47], v11 offset:32512
    s_waitcnt lgkmcnt(8)
    v_mfma_f32_16x16x32_bf16 v[128:131], v[28:31], v[72:75], v[128:131]
    ds_read_b64_tr_b16 v[24:25], v11 offset:36864
    v_mfma_f32_16x16x32_bf16 v[164:167], v[28:31], v[76:79], v[164:167]
    ds_read_b64_tr_b16 v[26:27], v11 offset:41472
    s_waitcnt lgkmcnt(8)
    v_mfma_f32_16x16x32_bf16 v[132:135], v[32:35], v[72:75], v[132:135]
    ds_read_b64_tr_b16 v[28:29], v11 offset:36896
    v_mfma_f32_16x16x32_bf16 v[168:171], v[32:35], v[76:79], v[168:171]
    ds_read_b64_tr_b16 v[30:31], v11 offset:41504
    s_waitcnt lgkmcnt(8)
    v_mfma_f32_16x16x32_bf16 v[136:139], v[36:39], v[72:75], v[136:139]
    ds_read_b64_tr_b16 v[32:33], v11 offset:36928
    v_mfma_f32_16x16x32_bf16 v[172:175], v[36:39], v[76:79], v[172:175]
    ds_read_b64_tr_b16 v[34:35], v11 offset:41536
    s_waitcnt lgkmcnt(8)
    v_mfma_f32_16x16x32_bf16 v[140:143], v[40:43], v[72:75], v[140:143]
    ds_read_b64_tr_b16 v[36:37], v11 offset:36960
    v_mfma_f32_16x16x32_bf16 v[176:179], v[40:43], v[76:79], v[176:179]
    ds_read_b64_tr_b16 v[38:39], v11 offset:41568
    s_waitcnt lgkmcnt(8)
    v_mfma_f32_16x16x32_bf16 v[144:147], v[44:47], v[72:75], v[144:147]
    ds_read_b64_tr_b16 v[40:41], v11 offset:36992
    v_mfma_f32_16x16x32_bf16 v[180:183], v[44:47], v[76:79], v[180:183]
    ds_read_b64_tr_b16 v[42:43], v11 offset:41600
    s_add_u32 s38, s57, 8192
    buffer_load_dwordx4 v[72:75], v2, s[8:11], s38 offen offset:3072 sc1
    buffer_load_dwordx4 v[76:79], v17, s[8:11], s38 offen offset:3072 sc1
    s_waitcnt vmcnt(14)
    s_waitcnt lgkmcnt(8)
    v_mfma_f32_16x16x32_bf16 v[112:115], v[24:27], v[80:83], v[112:115]
    ds_read_b64_tr_b16 v[44:45], v11 offset:37024
    v_mfma_f32_16x16x32_bf16 v[148:151], v[24:27], v[84:87], v[148:151]
    ds_read_b64_tr_b16 v[46:47], v11 offset:41632
    s_waitcnt lgkmcnt(8)
    v_mfma_f32_16x16x32_bf16 v[116:119], v[28:31], v[80:83], v[116:119]
    ds_read_b64_tr_b16 v[24:25], v11 offset:37056
    v_mfma_f32_16x16x32_bf16 v[152:155], v[28:31], v[84:87], v[152:155]
    ds_read_b64_tr_b16 v[26:27], v11 offset:41664
    s_waitcnt lgkmcnt(8)
    v_mfma_f32_16x16x32_bf16 v[120:123], v[32:35], v[80:83], v[120:123]
    ds_read_b64_tr_b16 v[28:29], v11 offset:37088
    v_mfma_f32_16x16x32_bf16 v[156:159], v[32:35], v[84:87], v[156:159]
    ds_read_b64_tr_b16 v[30:31], v11 offset:41696
    s_waitcnt lgkmcnt(8)
    v_mfma_f32_16x16x32_bf16 v[124:127], v[36:39], v[80:83], v[124:127]
    ds_read_b64_tr_b16 v[32:33], v11 offset:37120
    v_mfma_f32_16x16x32_bf16 v[160:163], v[36:39], v[84:87], v[160:163]
    ds_read_b64_tr_b16 v[34:35], v11 offset:41728
    s_waitcnt lgkmcnt(8)
    v_mfma_f32_16x16x32_bf16 v[128:131], v[40:43], v[80:83], v[128:131]
    ds_read_b64_tr_b16 v[36:37], v11 offset:46080
    v_mfma_f32_16x16x32_bf16 v[164:167], v[40:43], v[84:87], v[164:167]
    ds_read_b64_tr_b16 v[38:39], v11 offset:50688
    s_waitcnt lgkmcnt(8)
    v_mfma_f32_16x16x32_bf16 v[132:135], v[44:47], v[80:83], v[132:135]
    ds_read_b64_tr_b16 v[40:41], v11 offset:46112
    v_mfma_f32_16x16x32_bf16 v[168:171], v[44:47], v[84:87], v[168:171]
    ds_read_b64_tr_b16 v[42:43], v11 offset:50720
    s_waitcnt lgkmcnt(8)
    v_mfma_f32_16x16x32_bf16 v[136:139], v[24:27], v[80:83], v[136:139]
    ds_read_b64_tr_b16 v[44:45], v11 offset:46144
    v_mfma_f32_16x16x32_bf16 v[172:175], v[24:27], v[84:87], v[172:175]
    ds_read_b64_tr_b16 v[46:47], v11 offset:50752
    s_waitcnt lgkmcnt(8)
    v_mfma_f32_16x16x32_bf16 v[140:143], v[28:31], v[80:83], v[140:143]
    ds_read_b64_tr_b16 v[24:25], v11 offset:46176
    v_mfma_f32_16x16x32_bf16 v[176:179], v[28:31], v[84:87], v[176:179]
    ds_read_b64_tr_b16 v[26:27], v11 offset:50784
    s_waitcnt lgkmcnt(8)
    v_mfma_f32_16x16x32_bf16 v[144:147], v[32:35], v[80:83], v[144:147]
    ds_read_b64_tr_b16 v[28:29], v11 offset:46208
    v_mfma_f32_16x16x32_bf16 v[180:183], v[32:35], v[84:87], v[180:183]
    ds_read_b64_tr_b16 v[30:31], v11 offset:50816
    s_add_u32 s38, s57, 12288
    buffer_load_dwordx4 v[80:83], v2, s[8:11], s38 offen offset:0 sc1
    buffer_load_dwordx4 v[84:87], v17, s[8:11], s38 offen offset:0 sc1
    s_waitcnt vmcnt(14)
    s_waitcnt lgkmcnt(8)
    v_mfma_f32_16x16x32_bf16 v[112:115], v[36:39], v[88:91], v[112:115]
    ds_read_b64_tr_b16 v[32:33], v11 offset:46240
    v_mfma_f32_16x16x32_bf16 v[148:151], v[36:39], v[92:95], v[148:151]
    ds_read_b64_tr_b16 v[34:35], v11 offset:50848
    s_waitcnt lgkmcnt(8)
    v_mfma_f32_16x16x32_bf16 v[116:119], v[40:43], v[88:91], v[116:119]
    ds_read_b64_tr_b16 v[36:37], v11 offset:46272
    v_mfma_f32_16x16x32_bf16 v[152:155], v[40:43], v[92:95], v[152:155]
    ds_read_b64_tr_b16 v[38:39], v11 offset:50880
    s_waitcnt lgkmcnt(8)
    v_mfma_f32_16x16x32_bf16 v[120:123], v[44:47], v[88:91], v[120:123]
    ds_read_b64_tr_b16 v[40:41], v11 offset:46304
    v_mfma_f32_16x16x32_bf16 v[156:159], v[44:47], v[92:95], v[156:159]
    ds_read_b64_tr_b16 v[42:43], v11 offset:50912
    s_waitcnt lgkmcnt(8)
    v_mfma_f32_16x16x32_bf16 v[124:127], v[24:27], v[88:91], v[124:127]
    ds_read_b64_tr_b16 v[44:45], v11 offset:46336
    v_mfma_f32_16x16x32_bf16 v[160:163], v[24:27], v[92:95], v[160:163]
    ds_read_b64_tr_b16 v[46:47], v11 offset:50944
    s_waitcnt lgkmcnt(8)
    v_mfma_f32_16x16x32_bf16 v[128:131], v[28:31], v[88:91], v[128:131]
    ds_read_b64_tr_b16 v[24:25], v12 offset:0
    v_mfma_f32_16x16x32_bf16 v[164:167], v[28:31], v[92:95], v[164:167]
    ds_read_b64_tr_b16 v[26:27], v12 offset:4608
    s_waitcnt lgkmcnt(8)
    v_mfma_f32_16x16x32_bf16 v[132:135], v[32:35], v[88:91], v[132:135]
    ds_read_b64_tr_b16 v[28:29], v12 offset:32
    v_mfma_f32_16x16x32_bf16 v[168:171], v[32:35], v[92:95], v[168:171]
    ds_read_b64_tr_b16 v[30:31], v12 offset:4640
    s_waitcnt lgkmcnt(8)
    v_mfma_f32_16x16x32_bf16 v[136:139], v[36:39], v[88:91], v[136:139]
    ds_read_b64_tr_b16 v[32:33], v12 offset:64
    v_mfma_f32_16x16x32_bf16 v[172:175], v[36:39], v[92:95], v[172:175]
    ds_read_b64_tr_b16 v[34:35], v12 offset:4672
    s_waitcnt lgkmcnt(8)
    v_mfma_f32_16x16x32_bf16 v[140:143], v[40:43], v[88:91], v[140:143]
    ds_read_b64_tr_b16 v[36:37], v12 offset:96
    v_mfma_f32_16x16x32_bf16 v[176:179], v[40:43], v[92:95], v[176:179]
    ds_read_b64_tr_b16 v[38:39], v12 offset:4704
    s_waitcnt lgkmcnt(8)
    v_mfma_f32_16x16x32_bf16 v[144:147], v[44:47], v[88:91], v[144:147]
    ds_read_b64_tr_b16 v[40:41], v12 offset:128
    v_mfma_f32_16x16x32_bf16 v[180:183], v[44:47], v[92:95], v[180:183]
    ds_read_b64_tr_b16 v[42:43], v12 offset:4736
    s_add_u32 s38, s57, 12288
    buffer_load_dwordx4 v[88:91], v2, s[8:11], s38 offen offset:1024 sc1
    buffer_load_dwordx4 v[92:95], v17, s[8:11], s38 offen offset:1024 sc1
    s_waitcnt vmcnt(14)
    s_waitcnt lgkmcnt(8)
    v_mfma_f32_16x16x32_bf16 v[112:115], v[24:27], v[96:99], v[112:115]
    ds_read_b64_tr_b16 v[44:45], v12 offset:160
    v_mfma_f32_16x16x32_bf16 v[148:151], v[24:27], v[100:103], v[148:151]
    ds_read_b64_tr_b16 v[46:47], v12 offset:4768
    s_waitcnt lgkmcnt(8)
    v_mfma_f32_16x16x32_bf16 v[116:119], v[28:31], v[96:99], v[116:119]
    ds_read_b64_tr_b16 v[24:25], v12 offset:192
    v_mfma_f32_16x16x32_bf16 v[152:155], v[28:31], v[100:103], v[152:155]
    ds_read_b64_tr_b16 v[26:27], v12 offset:4800
    s_waitcnt lgkmcnt(8)
    v_mfma_f32_16x16x32_bf16 v[120:123], v[32:35], v[96:99], v[120:123]
    ds_read_b64_tr_b16 v[28:29], v12 offset:224
    v_mfma_f32_16x16x32_bf16 v[156:159], v[32:35], v[100:103], v[156:159]
    ds_read_b64_tr_b16 v[30:31], v12 offset:4832
    s_waitcnt lgkmcnt(8)
    v_mfma_f32_16x16x32_bf16 v[124:127], v[36:39], v[96:99], v[124:127]
    ds_read_b64_tr_b16 v[32:33], v12 offset:256
    v_mfma_f32_16x16x32_bf16 v[160:163], v[36:39], v[100:103], v[160:163]
    ds_read_b64_tr_b16 v[34:35], v12 offset:4864
    s_waitcnt lgkmcnt(8)
    v_mfma_f32_16x16x32_bf16 v[128:131], v[40:43], v[96:99], v[128:131]
    ds_read_b64_tr_b16 v[36:37], v12 offset:9216
    v_mfma_f32_16x16x32_bf16 v[164:167], v[40:43], v[100:103], v[164:167]
    ds_read_b64_tr_b16 v[38:39], v12 offset:13824
    s_waitcnt lgkmcnt(8)
    v_mfma_f32_16x16x32_bf16 v[132:135], v[44:47], v[96:99], v[132:135]
    ds_read_b64_tr_b16 v[40:41], v12 offset:9248
    v_mfma_f32_16x16x32_bf16 v[168:171], v[44:47], v[100:103], v[168:171]
    ds_read_b64_tr_b16 v[42:43], v12 offset:13856
    s_waitcnt lgkmcnt(8)
    v_mfma_f32_16x16x32_bf16 v[136:139], v[24:27], v[96:99], v[136:139]
    ds_read_b64_tr_b16 v[44:45], v12 offset:9280
    v_mfma_f32_16x16x32_bf16 v[172:175], v[24:27], v[100:103], v[172:175]
    ds_read_b64_tr_b16 v[46:47], v12 offset:13888
    s_waitcnt lgkmcnt(8)
    v_mfma_f32_16x16x32_bf16 v[140:143], v[28:31], v[96:99], v[140:143]
    ds_read_b64_tr_b16 v[24:25], v12 offset:9312
    v_mfma_f32_16x16x32_bf16 v[176:179], v[28:31], v[100:103], v[176:179]
    ds_read_b64_tr_b16 v[26:27], v12 offset:13920
    s_waitcnt lgkmcnt(8)
    v_mfma_f32_16x16x32_bf16 v[144:147], v[32:35], v[96:99], v[144:147]
    ds_read_b64_tr_b16 v[28:29], v12 offset:9344
    v_mfma_f32_16x16x32_bf16 v[180:183], v[32:35], v[100:103], v[180:183]
    ds_read_b64_tr_b16 v[30:31], v12 offset:13952
    s_add_u32 s38, s57, 12288
    buffer_load_dwordx4 v[96:99], v2, s[8:11], s38 offen offset:2048 sc1
    buffer_load_dwordx4 v[100:103], v17, s[8:11], s38 offen offset:2048 sc1
    s_waitcnt vmcnt(14)
    s_waitcnt lgkmcnt(8)
    v_mfma_f32_16x16x32_bf16 v[112:115], v[36:39], v[104:107], v[112:115]
    ds_read_b64_tr_b16 v[32:33], v12 offset:9376
    v_mfma_f32_16x16x32_bf16 v[148:151], v[36:39], v[108:111], v[148:151]
    ds_read_b64_tr_b16 v[34:35], v12 offset:13984
    s_waitcnt lgkmcnt(8)
    v_mfma_f32_16x16x32_bf16 v[116:119], v[40:43], v[104:107], v[116:119]
    ds_read_b64_tr_b16 v[36:37], v12 offset:9408
    v_mfma_f32_16x16x32_bf16 v[152:155], v[40:43], v[108:111], v[152:155]
    ds_read_b64_tr_b16 v[38:39], v12 offset:14016
    s_waitcnt lgkmcnt(8)
    v_mfma_f32_16x16x32_bf16 v[120:123], v[44:47], v[104:107], v[120:123]
    ds_read_b64_tr_b16 v[40:41], v12 offset:9440
    v_mfma_f32_16x16x32_bf16 v[156:159], v[44:47], v[108:111], v[156:159]
    ds_read_b64_tr_b16 v[42:43], v12 offset:14048
    s_waitcnt lgkmcnt(8)
    v_mfma_f32_16x16x32_bf16 v[124:127], v[24:27], v[104:107], v[124:127]
    ds_read_b64_tr_b16 v[44:45], v12 offset:9472
    v_mfma_f32_16x16x32_bf16 v[160:163], v[24:27], v[108:111], v[160:163]
    ds_read_b64_tr_b16 v[46:47], v12 offset:14080
    s_waitcnt lgkmcnt(8)
    v_mfma_f32_16x16x32_bf16 v[128:131], v[28:31], v[104:107], v[128:131]
    ds_read_b64_tr_b16 v[24:25], v12 offset:18432
    v_mfma_f32_16x16x32_bf16 v[164:167], v[28:31], v[108:111], v[164:167]
    ds_read_b64_tr_b16 v[26:27], v12 offset:23040
    s_waitcnt lgkmcnt(8)
    v_mfma_f32_16x16x32_bf16 v[132:135], v[32:35], v[104:107], v[132:135]
    ds_read_b64_tr_b16 v[28:29], v12 offset:18464
    v_mfma_f32_16x16x32_bf16 v[168:171], v[32:35], v[108:111], v[168:171]
    ds_read_b64_tr_b16 v[30:31], v12 offset:23072
    s_waitcnt lgkmcnt(8)
    v_mfma_f32_16x16x32_bf16 v[136:139], v[36:39], v[104:107], v[136:139]
    ds_read_b64_tr_b16 v[32:33], v12 offset:18496
    v_mfma_f32_16x16x32_bf16 v[172:175], v[36:39], v[108:111], v[172:175]
    ds_read_b64_tr_b16 v[34:35], v12 offset:23104
    s_waitcnt lgkmcnt(8)
    v_mfma_f32_16x16x32_bf16 v[140:143], v[40:43], v[104:107], v[140:143]
    ds_read_b64_tr_b16 v[36:37], v12 offset:18528
    v_mfma_f32_16x16x32_bf16 v[176:179], v[40:43], v[108:111], v[176:179]
    ds_read_b64_tr_b16 v[38:39], v12 offset:23136
    s_waitcnt lgkmcnt(8)
    v_mfma_f32_16x16x32_bf16 v[144:147], v[44:47], v[104:107], v[144:147]
    ds_read_b64_tr_b16 v[40:41], v12 offset:18560
    v_mfma_f32_16x16x32_bf16 v[180:183], v[44:47], v[108:111], v[180:183]
    ds_read_b64_tr_b16 v[42:43], v12 offset:23168
    s_add_u32 s38, s57, 12288
    buffer_load_dwordx4 v[104:107], v2, s[8:11], s38 offen offset:3072 sc1
    buffer_load_dwordx4 v[108:111], v17, s[8:11], s38 offen offset:3072 sc1
    s_waitcnt vmcnt(14)
    s_waitcnt lgkmcnt(8)
    v_mfma_f32_16x16x32_bf16 v[184:187], v[24:27], v[48:51], 0
    ds_read_b64_tr_b16 v[44:45], v12 offset:18592
    v_mfma_f32_16x16x32_bf16 v[220:223], v[24:27], v[52:55], 0
    ds_read_b64_tr_b16 v[46:47], v12 offset:23200
    s_waitcnt lgkmcnt(8)
    v_mfma_f32_16x16x32_bf16 v[188:191], v[28:31], v[48:51], 0
    ds_read_b64_tr_b16 v[24:25], v12 offset:18624
    v_mfma_f32_16x16x32_bf16 v[224:227], v[28:31], v[52:55], 0
    ds_read_b64_tr_b16 v[26:27], v12 offset:23232
    s_waitcnt lgkmcnt(8)
    v_mfma_f32_16x16x32_bf16 v[192:195], v[32:35], v[48:51], 0
    ds_read_b64_tr_b16 v[28:29], v12 offset:18656
    v_mfma_f32_16x16x32_bf16 v[228:231], v[32:35], v[52:55], 0
    ds_read_b64_tr_b16 v[30:31], v12 offset:23264
    s_waitcnt lgkmcnt(8)
    v_mfma_f32_16x16x32_bf16 v[196:199], v[36:39], v[48:51], 0
    ds_read_b64_tr_b16 v[32:33], v12 offset:18688
    v_mfma_f32_16x16x32_bf16 v[232:235], v[36:39], v[52:55], 0
    ds_read_b64_tr_b16 v[34:35], v12 offset:23296
    v_cvt_pk_bf16_f32 v20, v112, v113
    v_cvt_pk_bf16_f32 v21, v114, v115
    v_cvt_pk_bf16_f32 v22, v116, v117
    v_cvt_pk_bf16_f32 v23, v118, v119
    s_add_u32 s39, s58, 0
    buffer_store_dwordx4 v[20:23], v2, s[20:23], s39 offen offset:0 sc1
    s_waitcnt lgkmcnt(8)
    v_mfma_f32_16x16x32_bf16 v[200:203], v[40:43], v[48:51], 0
    ds_read_b64_tr_b16 v[36:37], v12 offset:27648
    v_mfma_f32_16x16x32_bf16 v[236:239], v[40:43], v[52:55], 0
    ds_read_b64_tr_b16 v[38:39], v12 offset:32256
    s_waitcnt lgkmcnt(8)
    v_mfma_f32_16x16x32_bf16 v[204:207], v[44:47], v[48:51], 0
    ds_read_b64_tr_b16 v[40:41], v12 offset:27680
    v_mfma_f32_16x16x32_bf16 v[240:243], v[44:47], v[52:55], 0
    ds_read_b64_tr_b16 v[42:43], v12 offset:32288
    s_waitcnt lgkmcnt(8)
    v_mfma_f32_16x16x32_bf16 v[208:211], v[24:27], v[48:51], 0
    ds_read_b64_tr_b16 v[44:45], v12 offset:27712
    v_mfma_f32_16x16x32_bf16 v[244:247], v[24:27], v[52:55], 0
    ds_read_b64_tr_b16 v[46:47], v12 offset:32320
    v_cvt_pk_bf16_f32 v4, v120, v121
    v_cvt_pk_bf16_f32 v5, v122, v123
    v_cvt_pk_bf16_f32 v6, v124, v125
    v_cvt_pk_bf16_f32 v7, v126, v127
    buffer_store_dwordx4 v[4:7], v2, s[20:23], s39 offen offset:1024 sc1
    s_waitcnt lgkmcnt(8)
    v_mfma_f32_16x16x32_bf16 v[212:215], v[28:31], v[48:51], 0
    ds_read_b64_tr_b16 v[24:25], v12 offset:27744
    v_mfma_f32_16x16x32_bf16 v[248:251], v[28:31], v[52:55], 0
    ds_read_b64_tr_b16 v[26:27], v12 offset:32352
    s_waitcnt lgkmcnt(8)
    v_mfma_f32_16x16x32_bf16 v[216:219], v[32:35], v[48:51], 0
    ds_read_b64_tr_b16 v[28:29], v12 offset:27776
    v_mfma_f32_16x16x32_bf16 v[252:255], v[32:35], v[52:55], 0
    ds_read_b64_tr_b16 v[30:31], v12 offset:32384
    s_add_u32 s38, s57, 0
    buffer_load_dwordx4 v[48:51], v2, s[8:11], s38 offen offset:0 sc1
    buffer_load_dwordx4 v[52:55], v17, s[8:11], s38 offen offset:0 sc1
    s_waitcnt vmcnt(16)
    s_waitcnt lgkmcnt(8)
    v_mfma_f32_16x16x32_bf16 v[184:187], v[36:39], v[56:59], v[184:187]
    ds_read_b64_tr_b16 v[32:33], v12 offset:27808
    v_mfma_f32_16x16x32_bf16 v[220:223], v[36:39], v[60:63], v[220:223]
    ds_read_b64_tr_b16 v[34:35], v12 offset:32416
    v_cvt_pk_bf16_f32 v20, v128, v129
    v_cvt_pk_bf16_f32 v21, v130, v131
    v_cvt_pk_bf16_f32 v22, v132, v133
    v_cvt_pk_bf16_f32 v23, v134, v135
    buffer_store_dwordx4 v[20:23], v2, s[20:23], s39 offen offset:2048 sc1
    s_waitcnt lgkmcnt(8)
    v_mfma_f32_16x16x32_bf16 v[188:191], v[40:43], v[56:59], v[188:191]
    ds_read_b64_tr_b16 v[36:37], v12 offset:27840
    v_mfma_f32_16x16x32_bf16 v[224:227], v[40:43], v[60:63], v[224:227]
    ds_read_b64_tr_b16 v[38:39], v12 offset:32448
    s_waitcnt lgkmcnt(8)
    v_mfma_f32_16x16x32_bf16 v[192:195], v[44:47], v[56:59], v[192:195]
    ds_read_b64_tr_b16 v[40:41], v12 offset:27872
    v_mfma_f32_16x16x32_bf16 v[228:231], v[44:47], v[60:63], v[228:231]
    ds_read_b64_tr_b16 v[42:43], v12 offset:32480
    s_waitcnt lgkmcnt(8)
    v_mfma_f32_16x16x32_bf16 v[196:199], v[24:27], v[56:59], v[196:199]
    ds_read_b64_tr_b16 v[44:45], v12 offset:27904
    v_mfma_f32_16x16x32_bf16 v[232:235], v[24:27], v[60:63], v[232:235]
    ds_read_b64_tr_b16 v[46:47], v12 offset:32512
    v_cvt_pk_bf16_f32 v4, v136, v137
    v_cvt_pk_bf16_f32 v5, v138, v139
    v_cvt_pk_bf16_f32 v6, v140, v141
    v_cvt_pk_bf16_f32 v7, v142, v143
    buffer_store_dwordx4 v[4:7], v2, s[20:23], s39 offen offset:3072 sc1
    s_waitcnt lgkmcnt(8)
    v_mfma_f32_16x16x32_bf16 v[200:203], v[28:31], v[56:59], v[200:203]
    ds_read_b64_tr_b16 v[24:25], v12 offset:36864
    v_mfma_f32_16x16x32_bf16 v[236:239], v[28:31], v[60:63], v[236:239]
    ds_read_b64_tr_b16 v[26:27], v12 offset:41472
    s_waitcnt lgkmcnt(8)
    v_mfma_f32_16x16x32_bf16 v[204:207], v[32:35], v[56:59], v[204:207]
    ds_read_b64_tr_b16 v[28:29], v12 offset:36896
    v_mfma_f32_16x16x32_bf16 v[240:243], v[32:35], v[60:63], v[240:243]
    ds_read_b64_tr_b16 v[30:31], v12 offset:41504
    s_waitcnt lgkmcnt(8)
    v_mfma_f32_16x16x32_bf16 v[208:211], v[36:39], v[56:59], v[208:211]
    ds_read_b64_tr_b16 v[32:33], v12 offset:36928
    v_mfma_f32_16x16x32_bf16 v[244:247], v[36:39], v[60:63], v[244:247]
    ds_read_b64_tr_b16 v[34:35], v12 offset:41536
    v_cvt_pk_bf16_f32 v20, v144, v145
    v_cvt_pk_bf16_f32 v21, v146, v147
    s_add_u32 s39, s58, 4096
    buffer_store_dwordx2 v[20:21], v10, s[20:23], s39 offen offset:0 sc1
    s_waitcnt lgkmcnt(8)
    v_mfma_f32_16x16x32_bf16 v[212:215], v[40:43], v[56:59], v[212:215]
    ds_read_b64_tr_b16 v[36:37], v12 offset:36960
    v_mfma_f32_16x16x32_bf16 v[248:251], v[40:43], v[60:63], v[248:251]
    ds_read_b64_tr_b16 v[38:39], v12 offset:41568
    s_waitcnt lgkmcnt(8)
    v_mfma_f32_16x16x32_bf16 v[216:219], v[44:47], v[56:59], v[216:219]
    ds_read_b64_tr_b16 v[40:41], v12 offset:36992
    v_mfma_f32_16x16x32_bf16 v[252:255], v[44:47], v[60:63], v[252:255]
    ds_read_b64_tr_b16 v[42:43], v12 offset:41600
    s_add_u32 s38, s57, 0
    buffer_load_dwordx4 v[56:59], v2, s[8:11], s38 offen offset:1024 sc1
    buffer_load_dwordx4 v[60:63], v17, s[8:11], s38 offen offset:1024 sc1
    s_waitcnt vmcnt(19)
    s_waitcnt lgkmcnt(8)
    v_mfma_f32_16x16x32_bf16 v[184:187], v[24:27], v[64:67], v[184:187]
    ds_read_b64_tr_b16 v[44:45], v12 offset:37024
    v_mfma_f32_16x16x32_bf16 v[220:223], v[24:27], v[68:71], v[220:223]
    ds_read_b64_tr_b16 v[46:47], v12 offset:41632
    v_cvt_pk_bf16_f32 v4, v148, v149
    v_cvt_pk_bf16_f32 v5, v150, v151
    v_cvt_pk_bf16_f32 v6, v152, v153
    v_cvt_pk_bf16_f32 v7, v154, v155
    s_add_u32 s39, s58, 4608
    buffer_store_dwordx4 v[4:7], v2, s[20:23], s39 offen offset:0 sc1
    s_waitcnt lgkmcnt(8)
    v_mfma_f32_16x16x32_bf16 v[188:191], v[28:31], v[64:67], v[188:191]
    ds_read_b64_tr_b16 v[24:25], v12 offset:37056
    v_mfma_f32_16x16x32_bf16 v[224:227], v[28:31], v[68:71], v[224:227]
    ds_read_b64_tr_b16 v[26:27], v12 offset:41664
    s_waitcnt lgkmcnt(8)
    v_mfma_f32_16x16x32_bf16 v[192:195], v[32:35], v[64:67], v[192:195]
    ds_read_b64_tr_b16 v[28:29], v12 offset:37088
    v_mfma_f32_16x16x32_bf16 v[228:231], v[32:35], v[68:71], v[228:231]
    ds_read_b64_tr_b16 v[30:31], v12 offset:41696
    s_waitcnt lgkmcnt(8)
    v_mfma_f32_16x16x32_bf16 v[196:199], v[36:39], v[64:67], v[196:199]
    ds_read_b64_tr_b16 v[32:33], v12 offset:37120
    v_mfma_f32_16x16x32_bf16 v[232:235], v[36:39], v[68:71], v[232:235]
    ds_read_b64_tr_b16 v[34:35], v12 offset:41728
    v_cvt_pk_bf16_f32 v20, v156, v157
    v_cvt_pk_bf16_f32 v21, v158, v159
    v_cvt_pk_bf16_f32 v22, v160, v161
    v_cvt_pk_bf16_f32 v23, v162, v163
    buffer_store_dwordx4 v[20:23], v2, s[20:23], s39 offen offset:1024 sc1
    s_waitcnt lgkmcnt(8)
    v_mfma_f32_16x16x32_bf16 v[200:203], v[40:43], v[64:67], v[200:203]
    ds_read_b64_tr_b16 v[36:37], v12 offset:46080
    v_mfma_f32_16x16x32_bf16 v[236:239], v[40:43], v[68:71], v[236:239]
    ds_read_b64_tr_b16 v[38:39], v12 offset:50688
    s_waitcnt lgkmcnt(8)
    v_mfma_f32_16x16x32_bf16 v[204:207], v[44:47], v[64:67], v[204:207]
    ds_read_b64_tr_b16 v[40:41], v12 offset:46112
    v_mfma_f32_16x16x32_bf16 v[240:243], v[44:47], v[68:71], v[240:243]
    ds_read_b64_tr_b16 v[42:43], v12 offset:50720
    s_waitcnt lgkmcnt(8)
    v_mfma_f32_16x16x32_bf16 v[208:211], v[24:27], v[64:67], v[208:211]
    ds_read_b64_tr_b16 v[44:45], v12 offset:46144
    v_mfma_f32_16x16x32_bf16 v[244:247], v[24:27], v[68:71], v[244:247]
    ds_read_b64_tr_b16 v[46:47], v12 offset:50752
    v_cvt_pk_bf16_f32 v4, v164, v165
    v_cvt_pk_bf16_f32 v5, v166, v167
    v_cvt_pk_bf16_f32 v6, v168, v169
    v_cvt_pk_bf16_f32 v7, v170, v171
    buffer_store_dwordx4 v[4:7], v2, s[20:23], s39 offen offset:2048 sc1
    s_waitcnt lgkmcnt(8)
    v_mfma_f32_16x16x32_bf16 v[212:215], v[28:31], v[64:67], v[212:215]
    ds_read_b64_tr_b16 v[24:25], v12 offset:46176
    v_mfma_f32_16x16x32_bf16 v[248:251], v[28:31], v[68:71], v[248:251]
    ds_read_b64_tr_b16 v[26:27], v12 offset:50784
    s_waitcnt lgkmcnt(8)
    v_mfma_f32_16x16x32_bf16 v[216:219], v[32:35], v[64:67], v[216:219]
    ds_read_b64_tr_b16 v[28:29], v12 offset:46208
    v_mfma_f32_16x16x32_bf16 v[252:255], v[32:35], v[68:71], v[252:255]
    ds_read_b64_tr_b16 v[30:31], v12 offset:50816
    s_add_u32 s38, s57, 0
    buffer_load_dwordx4 v[64:67], v2, s[8:11], s38 offen offset:2048 sc1
    buffer_load_dwordx4 v[68:71], v17, s[8:11], s38 offen offset:2048 sc1
    s_waitcnt vmcnt(22)
    s_waitcnt lgkmcnt(8)
    v_mfma_f32_16x16x32_bf16 v[184:187], v[36:39], v[72:75], v[184:187]
    ds_read_b64_tr_b16 v[32:33], v12 offset:46240
    v_mfma_f32_16x16x32_bf16 v[220:223], v[36:39], v[76:79], v[220:223]
    ds_read_b64_tr_b16 v[34:35], v12 offset:50848
    v_cvt_pk_bf16_f32 v20, v172, v173
    v_cvt_pk_bf16_f32 v21, v174, v175
    v_cvt_pk_bf16_f32 v22, v176, v177
    v_cvt_pk_bf16_f32 v23, v178, v179
    buffer_store_dwordx4 v[20:23], v2, s[20:23], s39 offen offset:3072 sc1
    s_waitcnt lgkmcnt(8)
    v_mfma_f32_16x16x32_bf16 v[188:191], v[40:43], v[72:75], v[188:191]
    ds_read_b64_tr_b16 v[36:37], v12 offset:46272
    v_mfma_f32_16x16x32_bf16 v[224:227], v[40:43], v[76:79], v[224:227]
    ds_read_b64_tr_b16 v[38:39], v12 offset:50880
    s_waitcnt lgkmcnt(8)
    v_mfma_f32_16x16x32_bf16 v[192:195], v[44:47], v[72:75], v[192:195]
    ds_read_b64_tr_b16 v[40:41], v12 offset:46304
    v_mfma_f32_16x16x32_bf16 v[228:231], v[44:47], v[76:79], v[228:231]
    ds_read_b64_tr_b16 v[42:43], v12 offset:50912
    s_waitcnt lgkmcnt(8)
    v_mfma_f32_16x16x32_bf16 v[196:199], v[24:27], v[72:75], v[196:199]
    ds_read_b64_tr_b16 v[44:45], v12 offset:46336
    v_mfma_f32_16x16x32_bf16 v[232:235], v[24:27], v[76:79], v[232:235]
    ds_read_b64_tr_b16 v[46:47], v12 offset:50944
    v_cvt_pk_bf16_f32 v4, v180, v181
    v_cvt_pk_bf16_f32 v5, v182, v183
    s_add_u32 s39, s58, 8704
    buffer_store_dwordx2 v[4:5], v10, s[20:23], s39 offen offset:0 sc1
    s_waitcnt lgkmcnt(8)
    v_mfma_f32_16x16x32_bf16 v[200:203], v[28:31], v[72:75], v[200:203]
    ds_read_b64_tr_b16 v[24:25], v13 offset:0
    v_mfma_f32_16x16x32_bf16 v[236:239], v[28:31], v[76:79], v[236:239]
    ds_read_b64_tr_b16 v[26:27], v13 offset:4608
    s_waitcnt lgkmcnt(8)
    v_mfma_f32_16x16x32_bf16 v[204:207], v[32:35], v[72:75], v[204:207]
    ds_read_b64_tr_b16 v[28:29], v13 offset:32
    v_mfma_f32_16x16x32_bf16 v[240:243], v[32:35], v[76:79], v[240:243]
    ds_read_b64_tr_b16 v[30:31], v13 offset:4640
    s_waitcnt lgkmcnt(8)
    v_mfma_f32_16x16x32_bf16 v[208:211], v[36:39], v[72:75], v[208:211]
    ds_read_b64_tr_b16 v[32:33], v13 offset:64
    v_mfma_f32_16x16x32_bf16 v[244:247], v[36:39], v[76:79], v[244:247]
    ds_read_b64_tr_b16 v[34:35], v13 offset:4672
    s_waitcnt lgkmcnt(8)
    v_mfma_f32_16x16x32_bf16 v[212:215], v[40:43], v[72:75], v[212:215]
    ds_read_b64_tr_b16 v[36:37], v13 offset:96
    v_mfma_f32_16x16x32_bf16 v[248:251], v[40:43], v[76:79], v[248:251]
    ds_read_b64_tr_b16 v[38:39], v13 offset:4704
    s_waitcnt lgkmcnt(8)
    v_mfma_f32_16x16x32_bf16 v[216:219], v[44:47], v[72:75], v[216:219]
    ds_read_b64_tr_b16 v[40:41], v13 offset:128
    v_mfma_f32_16x16x32_bf16 v[252:255], v[44:47], v[76:79], v[252:255]
    ds_read_b64_tr_b16 v[42:43], v13 offset:4736
    s_add_u32 s38, s57, 0
    buffer_load_dwordx4 v[72:75], v2, s[8:11], s38 offen offset:3072 sc1
    buffer_load_dwordx4 v[76:79], v17, s[8:11], s38 offen offset:3072 sc1
    s_waitcnt vmcnt(24)
    s_waitcnt lgkmcnt(8)
    v_mfma_f32_16x16x32_bf16 v[184:187], v[24:27], v[80:83], v[184:187]
    ds_read_b64_tr_b16 v[44:45], v13 offset:160
    v_mfma_f32_16x16x32_bf16 v[220:223], v[24:27], v[84:87], v[220:223]
    ds_read_b64_tr_b16 v[46:47], v13 offset:4768
    s_waitcnt lgkmcnt(8)
    v_mfma_f32_16x16x32_bf16 v[188:191], v[28:31], v[80:83], v[188:191]
    ds_read_b64_tr_b16 v[24:25], v13 offset:192
    v_mfma_f32_16x16x32_bf16 v[224:227], v[28:31], v[84:87], v[224:227]
    ds_read_b64_tr_b16 v[26:27], v13 offset:4800
    s_waitcnt lgkmcnt(8)
    v_mfma_f32_16x16x32_bf16 v[192:195], v[32:35], v[80:83], v[192:195]
    ds_read_b64_tr_b16 v[28:29], v13 offset:224
    v_mfma_f32_16x16x32_bf16 v[228:231], v[32:35], v[84:87], v[228:231]
    ds_read_b64_tr_b16 v[30:31], v13 offset:4832
    s_waitcnt lgkmcnt(8)
    v_mfma_f32_16x16x32_bf16 v[196:199], v[36:39], v[80:83], v[196:199]
    ds_read_b64_tr_b16 v[32:33], v13 offset:256
    v_mfma_f32_16x16x32_bf16 v[232:235], v[36:39], v[84:87], v[232:235]
    ds_read_b64_tr_b16 v[34:35], v13 offset:4864
    s_waitcnt lgkmcnt(8)
    v_mfma_f32_16x16x32_bf16 v[200:203], v[40:43], v[80:83], v[200:203]
    ds_read_b64_tr_b16 v[36:37], v13 offset:9216
    v_mfma_f32_16x16x32_bf16 v[236:239], v[40:43], v[84:87], v[236:239]
    ds_read_b64_tr_b16 v[38:39], v13 offset:13824
    s_waitcnt lgkmcnt(8)
    v_mfma_f32_16x16x32_bf16 v[204:207], v[44:47], v[80:83], v[204:207]
    ds_read_b64_tr_b16 v[40:41], v13 offset:9248
    v_mfma_f32_16x16x32_bf16 v[240:243], v[44:47], v[84:87], v[240:243]
    ds_read_b64_tr_b16 v[42:43], v13 offset:13856
    s_waitcnt lgkmcnt(8)
    v_mfma_f32_16x16x32_bf16 v[208:211], v[24:27], v[80:83], v[208:211]
    ds_read_b64_tr_b16 v[44:45], v13 offset:9280
    v_mfma_f32_16x16x32_bf16 v[244:247], v[24:27], v[84:87], v[244:247]
    ds_read_b64_tr_b16 v[46:47], v13 offset:13888
    s_waitcnt lgkmcnt(8)
    v_mfma_f32_16x16x32_bf16 v[212:215], v[28:31], v[80:83], v[212:215]
    ds_read_b64_tr_b16 v[24:25], v13 offset:9312
    v_mfma_f32_16x16x32_bf16 v[248:251], v[28:31], v[84:87], v[248:251]
    ds_read_b64_tr_b16 v[26:27], v13 offset:13920
    s_waitcnt lgkmcnt(8)
    v_mfma_f32_16x16x32_bf16 v[216:219], v[32:35], v[80:83], v[216:219]
    ds_read_b64_tr_b16 v[28:29], v13 offset:9344
    v_mfma_f32_16x16x32_bf16 v[252:255], v[32:35], v[84:87], v[252:255]
    ds_read_b64_tr_b16 v[30:31], v13 offset:13952
    s_add_u32 s38, s57, 4096
    buffer_load_dwordx4 v[80:83], v2, s[8:11], s38 offen offset:0 sc1
    buffer_load_dwordx4 v[84:87], v17, s[8:11], s38 offen offset:0 sc1
    s_waitcnt vmcnt(24)
    s_waitcnt lgkmcnt(8)
    v_mfma_f32_16x16x32_bf16 v[184:187], v[36:39], v[88:91], v[184:187]
    ds_read_b64_tr_b16 v[32:33], v13 offset:9376
    v_mfma_f32_16x16x32_bf16 v[220:223], v[36:39], v[92:95], v[220:223]
    ds_read_b64_tr_b16 v[34:35], v13 offset:13984
    s_waitcnt lgkmcnt(8)
    v_mfma_f32_16x16x32_bf16 v[188:191], v[40:43], v[88:91], v[188:191]
    ds_read_b64_tr_b16 v[36:37], v13 offset:9408
    v_mfma_f32_16x16x32_bf16 v[224:227], v[40:43], v[92:95], v[224:227]
    ds_read_b64_tr_b16 v[38:39], v13 offset:14016
    s_waitcnt lgkmcnt(8)
    v_mfma_f32_16x16x32_bf16 v[192:195], v[44:47], v[88:91], v[192:195]
    ds_read_b64_tr_b16 v[40:41], v13 offset:9440
    v_mfma_f32_16x16x32_bf16 v[228:231], v[44:47], v[92:95], v[228:231]
    ds_read_b64_tr_b16 v[42:43], v13 offset:14048
    s_waitcnt lgkmcnt(8)
    v_mfma_f32_16x16x32_bf16 v[196:199], v[24:27], v[88:91], v[196:199]
    ds_read_b64_tr_b16 v[44:45], v13 offset:9472
    v_mfma_f32_16x16x32_bf16 v[232:235], v[24:27], v[92:95], v[232:235]
    ds_read_b64_tr_b16 v[46:47], v13 offset:14080
    s_waitcnt lgkmcnt(8)
    v_mfma_f32_16x16x32_bf16 v[200:203], v[28:31], v[88:91], v[200:203]
    ds_read_b64_tr_b16 v[24:25], v13 offset:18432
    v_mfma_f32_16x16x32_bf16 v[236:239], v[28:31], v[92:95], v[236:239]
    ds_read_b64_tr_b16 v[26:27], v13 offset:23040
    s_waitcnt lgkmcnt(8)
    v_mfma_f32_16x16x32_bf16 v[204:207], v[32:35], v[88:91], v[204:207]
    ds_read_b64_tr_b16 v[28:29], v13 offset:18464
    v_mfma_f32_16x16x32_bf16 v[240:243], v[32:35], v[92:95], v[240:243]
    ds_read_b64_tr_b16 v[30:31], v13 offset:23072
    s_waitcnt lgkmcnt(8)
    v_mfma_f32_16x16x32_bf16 v[208:211], v[36:39], v[88:91], v[208:211]
    ds_read_b64_tr_b16 v[32:33], v13 offset:18496
    v_mfma_f32_16x16x32_bf16 v[244:247], v[36:39], v[92:95], v[244:247]
    ds_read_b64_tr_b16 v[34:35], v13 offset:23104
    s_waitcnt lgkmcnt(8)
    v_mfma_f32_16x16x32_bf16 v[212:215], v[40:43], v[88:91], v[212:215]
    ds_read_b64_tr_b16 v[36:37], v13 offset:18528
    v_mfma_f32_16x16x32_bf16 v[248:251], v[40:43], v[92:95], v[248:251]
    ds_read_b64_tr_b16 v[38:39], v13 offset:23136
    s_waitcnt lgkmcnt(8)
    v_mfma_f32_16x16x32_bf16 v[216:219], v[44:47], v[88:91], v[216:219]
    ds_read_b64_tr_b16 v[40:41], v13 offset:18560
    v_mfma_f32_16x16x32_bf16 v[252:255], v[44:47], v[92:95], v[252:255]
    ds_read_b64_tr_b16 v[42:43], v13 offset:23168
    s_add_u32 s38, s57, 4096
    buffer_load_dwordx4 v[88:91], v2, s[8:11], s38 offen offset:1024 sc1
    buffer_load_dwordx4 v[92:95], v17, s[8:11], s38 offen offset:1024 sc1
    s_barrier
    s_waitcnt vmcnt(24)
    s_waitcnt lgkmcnt(8)
    v_mfma_f32_16x16x32_bf16 v[184:187], v[24:27], v[96:99], v[184:187]
    ds_read_b64_tr_b16 v[44:45], v13 offset:18592
    v_mfma_f32_16x16x32_bf16 v[220:223], v[24:27], v[100:103], v[220:223]
    ds_read_b64_tr_b16 v[46:47], v13 offset:23200
    s_waitcnt lgkmcnt(8)
    v_mfma_f32_16x16x32_bf16 v[188:191], v[28:31], v[96:99], v[188:191]
    ds_read_b64_tr_b16 v[24:25], v13 offset:18624
    v_mfma_f32_16x16x32_bf16 v[224:227], v[28:31], v[100:103], v[224:227]
    ds_read_b64_tr_b16 v[26:27], v13 offset:23232
    s_waitcnt lgkmcnt(8)
    v_mfma_f32_16x16x32_bf16 v[192:195], v[32:35], v[96:99], v[192:195]
    ds_read_b64_tr_b16 v[28:29], v13 offset:18656
    v_mfma_f32_16x16x32_bf16 v[228:231], v[32:35], v[100:103], v[228:231]
    ds_read_b64_tr_b16 v[30:31], v13 offset:23264
    s_waitcnt lgkmcnt(8)
    v_mfma_f32_16x16x32_bf16 v[196:199], v[36:39], v[96:99], v[196:199]
    ds_read_b64_tr_b16 v[32:33], v13 offset:18688
    v_mfma_f32_16x16x32_bf16 v[232:235], v[36:39], v[100:103], v[232:235]
    ds_read_b64_tr_b16 v[34:35], v13 offset:23296
    s_waitcnt lgkmcnt(8)
    v_mfma_f32_16x16x32_bf16 v[200:203], v[40:43], v[96:99], v[200:203]
    ds_read_b64_tr_b16 v[36:37], v13 offset:27648
    v_mfma_f32_16x16x32_bf16 v[236:239], v[40:43], v[100:103], v[236:239]
    ds_read_b64_tr_b16 v[38:39], v13 offset:32256
    s_waitcnt lgkmcnt(8)
    v_mfma_f32_16x16x32_bf16 v[204:207], v[44:47], v[96:99], v[204:207]
    ds_read_b64_tr_b16 v[40:41], v13 offset:27680
    v_mfma_f32_16x16x32_bf16 v[240:243], v[44:47], v[100:103], v[240:243]
    ds_read_b64_tr_b16 v[42:43], v13 offset:32288
    s_waitcnt lgkmcnt(8)
    v_mfma_f32_16x16x32_bf16 v[208:211], v[24:27], v[96:99], v[208:211]
    ds_read_b64_tr_b16 v[44:45], v13 offset:27712
    v_mfma_f32_16x16x32_bf16 v[244:247], v[24:27], v[100:103], v[244:247]
    ds_read_b64_tr_b16 v[46:47], v13 offset:32320
    s_waitcnt lgkmcnt(8)
    v_mfma_f32_16x16x32_bf16 v[212:215], v[28:31], v[96:99], v[212:215]
    ds_read_b64_tr_b16 v[24:25], v13 offset:27744
    v_mfma_f32_16x16x32_bf16 v[248:251], v[28:31], v[100:103], v[248:251]
    ds_read_b64_tr_b16 v[26:27], v13 offset:32352
    s_waitcnt lgkmcnt(8)
    v_mfma_f32_16x16x32_bf16 v[216:219], v[32:35], v[96:99], v[216:219]
    ds_read_b64_tr_b16 v[28:29], v13 offset:27776
    v_mfma_f32_16x16x32_bf16 v[252:255], v[32:35], v[100:103], v[252:255]
    ds_read_b64_tr_b16 v[30:31], v13 offset:32384
    s_add_u32 s38, s57, 4096
    buffer_load_dwordx4 v[96:99], v2, s[8:11], s38 offen offset:2048 sc1
    buffer_load_dwordx4 v[100:103], v17, s[8:11], s38 offen offset:2048 sc1
    s_waitcnt vmcnt(24)
    s_waitcnt lgkmcnt(8)
    v_mfma_f32_16x16x32_bf16 v[184:187], v[36:39], v[104:107], v[184:187]
    ds_read_b64_tr_b16 v[32:33], v13 offset:27808
    v_mfma_f32_16x16x32_bf16 v[220:223], v[36:39], v[108:111], v[220:223]
    ds_read_b64_tr_b16 v[34:35], v13 offset:32416
    s_waitcnt vmcnt(8)
    v_mov_b32 v18, s69
    v_mov_b32 v19, 0
    s_mov_b64 exec, 1
    buffer_store_dword v18, v19, s[72:75], s60 offen sc1
    s_mov_b64 exec, -1
    s_waitcnt lgkmcnt(8)
    v_mfma_f32_16x16x32_bf16 v[188:191], v[40:43], v[104:107], v[188:191]
    ds_read_b64_tr_b16 v[36:37], v13 offset:27840
    v_mfma_f32_16x16x32_bf16 v[224:227], v[40:43], v[108:111], v[224:227]
    ds_read_b64_tr_b16 v[38:39], v13 offset:32448
    s_waitcnt lgkmcnt(8)
    v_mfma_f32_16x16x32_bf16 v[192:195], v[44:47], v[104:107], v[192:195]
    ds_read_b64_tr_b16 v[40:41], v13 offset:27872
    v_mfma_f32_16x16x32_bf16 v[228:231], v[44:47], v[108:111], v[228:231]
    ds_read_b64_tr_b16 v[42:43], v13 offset:32480
    s_waitcnt lgkmcnt(8)
    v_mfma_f32_16x16x32_bf16 v[196:199], v[24:27], v[104:107], v[196:199]
    ds_read_b64_tr_b16 v[44:45], v13 offset:27904
    v_mfma_f32_16x16x32_bf16 v[232:235], v[24:27], v[108:111], v[232:235]
    ds_read_b64_tr_b16 v[46:47], v13 offset:32512
    s_waitcnt lgkmcnt(8)
    v_mfma_f32_16x16x32_bf16 v[200:203], v[28:31], v[104:107], v[200:203]
    ds_read_b64_tr_b16 v[24:25], v11 offset:0
    v_mfma_f32_16x16x32_bf16 v[236:239], v[28:31], v[108:111], v[236:239]
    ds_read_b64_tr_b16 v[26:27], v11 offset:4608
    s_waitcnt lgkmcnt(8)
    v_mfma_f32_16x16x32_bf16 v[204:207], v[32:35], v[104:107], v[204:207]
    ds_read_b64_tr_b16 v[28:29], v11 offset:32
    v_mfma_f32_16x16x32_bf16 v[240:243], v[32:35], v[108:111], v[240:243]
    ds_read_b64_tr_b16 v[30:31], v11 offset:4640
    s_waitcnt lgkmcnt(8)
    v_mfma_f32_16x16x32_bf16 v[208:211], v[36:39], v[104:107], v[208:211]
    ds_read_b64_tr_b16 v[32:33], v11 offset:64
    v_mfma_f32_16x16x32_bf16 v[244:247], v[36:39], v[108:111], v[244:247]
    ds_read_b64_tr_b16 v[34:35], v11 offset:4672
    s_waitcnt lgkmcnt(8)
    v_mfma_f32_16x16x32_bf16 v[212:215], v[40:43], v[104:107], v[212:215]
    ds_read_b64_tr_b16 v[36:37], v11 offset:96
    v_mfma_f32_16x16x32_bf16 v[248:251], v[40:43], v[108:111], v[248:251]
    ds_read_b64_tr_b16 v[38:39], v11 offset:4704
    s_waitcnt lgkmcnt(8)
    v_mfma_f32_16x16x32_bf16 v[216:219], v[44:47], v[104:107], v[216:219]
    ds_read_b64_tr_b16 v[40:41], v11 offset:128
    v_mfma_f32_16x16x32_bf16 v[252:255], v[44:47], v[108:111], v[252:255]
    ds_read_b64_tr_b16 v[42:43], v11 offset:4736
    s_add_u32 s38, s57, 4096
    buffer_load_dwordx4 v[104:107], v2, s[8:11], s38 offen offset:3072 sc1
    buffer_load_dwordx4 v[108:111], v17, s[8:11], s38 offen offset:3072 sc1
    s_waitcnt vmcnt(23)
    s_waitcnt lgkmcnt(8)
    v_mfma_f32_16x16x32_bf16 v[184:187], v[24:27], v[48:51], v[184:187]
    ds_read_b64_tr_b16 v[44:45], v11 offset:160
    v_mfma_f32_16x16x32_bf16 v[220:223], v[24:27], v[52:55], v[220:223]
    ds_read_b64_tr_b16 v[46:47], v11 offset:4768
    s_waitcnt lgkmcnt(8)
    v_mfma_f32_16x16x32_bf16 v[188:191], v[28:31], v[48:51], v[188:191]
    ds_read_b64_tr_b16 v[24:25], v11 offset:192
    v_mfma_f32_16x16x32_bf16 v[224:227], v[28:31], v[52:55], v[224:227]
    ds_read_b64_tr_b16 v[26:27], v11 offset:4800
    s_waitcnt lgkmcnt(8)
    v_mfma_f32_16x16x32_bf16 v[192:195], v[32:35], v[48:51], v[192:195]
    ds_read_b64_tr_b16 v[28:29], v11 offset:224
    v_mfma_f32_16x16x32_bf16 v[228:231], v[32:35], v[52:55], v[228:231]
    ds_read_b64_tr_b16 v[30:31], v11 offset:4832
    s_waitcnt lgkmcnt(8)
    v_mfma_f32_16x16x32_bf16 v[196:199], v[36:39], v[48:51], v[196:199]
    ds_read_b64_tr_b16 v[32:33], v11 offset:256
    v_mfma_f32_16x16x32_bf16 v[232:235], v[36:39], v[52:55], v[232:235]
    ds_read_b64_tr_b16 v[34:35], v11 offset:4864
    s_waitcnt lgkmcnt(8)
    v_mfma_f32_16x16x32_bf16 v[200:203], v[40:43], v[48:51], v[200:203]
    ds_read_b64_tr_b16 v[36:37], v11 offset:9216
    v_mfma_f32_16x16x32_bf16 v[236:239], v[40:43], v[52:55], v[236:239]
    ds_read_b64_tr_b16 v[38:39], v11 offset:13824
    s_waitcnt lgkmcnt(8)
    v_mfma_f32_16x16x32_bf16 v[204:207], v[44:47], v[48:51], v[204:207]
    ds_read_b64_tr_b16 v[40:41], v11 offset:9248
    v_mfma_f32_16x16x32_bf16 v[240:243], v[44:47], v[52:55], v[240:243]
    ds_read_b64_tr_b16 v[42:43], v11 offset:13856
    s_waitcnt lgkmcnt(8)
    v_mfma_f32_16x16x32_bf16 v[208:211], v[24:27], v[48:51], v[208:211]
    ds_read_b64_tr_b16 v[44:45], v11 offset:9280
    v_mfma_f32_16x16x32_bf16 v[244:247], v[24:27], v[52:55], v[244:247]
    ds_read_b64_tr_b16 v[46:47], v11 offset:13888
    s_waitcnt lgkmcnt(8)
    v_mfma_f32_16x16x32_bf16 v[212:215], v[28:31], v[48:51], v[212:215]
    ds_read_b64_tr_b16 v[24:25], v11 offset:9312
    v_mfma_f32_16x16x32_bf16 v[248:251], v[28:31], v[52:55], v[248:251]
    ds_read_b64_tr_b16 v[26:27], v11 offset:13920
    s_waitcnt lgkmcnt(8)
    v_mfma_f32_16x16x32_bf16 v[216:219], v[32:35], v[48:51], v[216:219]
    ds_read_b64_tr_b16 v[28:29], v11 offset:9344
    v_mfma_f32_16x16x32_bf16 v[252:255], v[32:35], v[52:55], v[252:255]
    ds_read_b64_tr_b16 v[30:31], v11 offset:13952
    s_waitcnt vmcnt(18)
    s_waitcnt lgkmcnt(8)
    v_mfma_f32_16x16x32_bf16 v[184:187], v[36:39], v[56:59], v[184:187]
    ds_read_b64_tr_b16 v[32:33], v11 offset:9376
    v_mfma_f32_16x16x32_bf16 v[220:223], v[36:39], v[60:63], v[220:223]
    ds_read_b64_tr_b16 v[34:35], v11 offset:13984
    s_waitcnt lgkmcnt(8)
    v_mfma_f32_16x16x32_bf16 v[188:191], v[40:43], v[56:59], v[188:191]
    ds_read_b64_tr_b16 v[36:37], v11 offset:9408
    v_mfma_f32_16x16x32_bf16 v[224:227], v[40:43], v[60:63], v[224:227]
    ds_read_b64_tr_b16 v[38:39], v11 offset:14016
    s_waitcnt lgkmcnt(8)
    v_mfma_f32_16x16x32_bf16 v[192:195], v[44:47], v[56:59], v[192:195]
    ds_read_b64_tr_b16 v[40:41], v11 offset:9440
    v_mfma_f32_16x16x32_bf16 v[228:231], v[44:47], v[60:63], v[228:231]
    ds_read_b64_tr_b16 v[42:43], v11 offset:14048
    s_waitcnt lgkmcnt(8)
    v_mfma_f32_16x16x32_bf16 v[196:199], v[24:27], v[56:59], v[196:199]
    ds_read_b64_tr_b16 v[44:45], v11 offset:9472
    v_mfma_f32_16x16x32_bf16 v[232:235], v[24:27], v[60:63], v[232:235]
    ds_read_b64_tr_b16 v[46:47], v11 offset:14080
    s_waitcnt lgkmcnt(8)
    v_mfma_f32_16x16x32_bf16 v[200:203], v[28:31], v[56:59], v[200:203]
    ds_read_b64_tr_b16 v[24:25], v11 offset:18432
    v_mfma_f32_16x16x32_bf16 v[236:239], v[28:31], v[60:63], v[236:239]
    ds_read_b64_tr_b16 v[26:27], v11 offset:23040
    s_waitcnt lgkmcnt(8)
    v_mfma_f32_16x16x32_bf16 v[204:207], v[32:35], v[56:59], v[204:207]
    ds_read_b64_tr_b16 v[28:29], v11 offset:18464
    v_mfma_f32_16x16x32_bf16 v[240:243], v[32:35], v[60:63], v[240:243]
    ds_read_b64_tr_b16 v[30:31], v11 offset:23072
    s_waitcnt lgkmcnt(8)
    v_mfma_f32_16x16x32_bf16 v[208:211], v[36:39], v[56:59], v[208:211]
    ds_read_b64_tr_b16 v[32:33], v11 offset:18496
    v_mfma_f32_16x16x32_bf16 v[244:247], v[36:39], v[60:63], v[244:247]
    ds_read_b64_tr_b16 v[34:35], v11 offset:23104
    s_waitcnt lgkmcnt(8)
    v_mfma_f32_16x16x32_bf16 v[212:215], v[40:43], v[56:59], v[212:215]
    ds_read_b64_tr_b16 v[36:37], v11 offset:18528
    v_mfma_f32_16x16x32_bf16 v[248:251], v[40:43], v[60:63], v[248:251]
    ds_read_b64_tr_b16 v[38:39], v11 offset:23136
    s_waitcnt lgkmcnt(8)
    v_mfma_f32_16x16x32_bf16 v[216:219], v[44:47], v[56:59], v[216:219]
    ds_read_b64_tr_b16 v[40:41], v11 offset:18560
    v_mfma_f32_16x16x32_bf16 v[252:255], v[44:47], v[60:63], v[252:255]
    ds_read_b64_tr_b16 v[42:43], v11 offset:23168
    s_waitcnt vmcnt(13)
    s_waitcnt lgkmcnt(8)
    v_mfma_f32_16x16x32_bf16 v[184:187], v[24:27], v[64:67], v[184:187]
    ds_read_b64_tr_b16 v[44:45], v11 offset:18592
    v_mfma_f32_16x16x32_bf16 v[220:223], v[24:27], v[68:71], v[220:223]
    ds_read_b64_tr_b16 v[46:47], v11 offset:23200
    s_waitcnt lgkmcnt(8)
    v_mfma_f32_16x16x32_bf16 v[188:191], v[28:31], v[64:67], v[188:191]
    ds_read_b64_tr_b16 v[24:25], v11 offset:18624
    v_mfma_f32_16x16x32_bf16 v[224:227], v[28:31], v[68:71], v[224:227]
    ds_read_b64_tr_b16 v[26:27], v11 offset:23232
    s_waitcnt lgkmcnt(8)
    v_mfma_f32_16x16x32_bf16 v[192:195], v[32:35], v[64:67], v[192:195]
    ds_read_b64_tr_b16 v[28:29], v11 offset:18656
    v_mfma_f32_16x16x32_bf16 v[228:231], v[32:35], v[68:71], v[228:231]
    ds_read_b64_tr_b16 v[30:31], v11 offset:23264
    s_waitcnt lgkmcnt(8)
    v_mfma_f32_16x16x32_bf16 v[196:199], v[36:39], v[64:67], v[196:199]
    ds_read_b64_tr_b16 v[32:33], v11 offset:18688
    v_mfma_f32_16x16x32_bf16 v[232:235], v[36:39], v[68:71], v[232:235]
    ds_read_b64_tr_b16 v[34:35], v11 offset:23296
    s_waitcnt lgkmcnt(8)
    v_mfma_f32_16x16x32_bf16 v[200:203], v[40:43], v[64:67], v[200:203]
    ds_read_b64_tr_b16 v[36:37], v11 offset:27648
    v_mfma_f32_16x16x32_bf16 v[236:239], v[40:43], v[68:71], v[236:239]
    ds_read_b64_tr_b16 v[38:39], v11 offset:32256
    s_waitcnt lgkmcnt(8)
    v_mfma_f32_16x16x32_bf16 v[204:207], v[44:47], v[64:67], v[204:207]
    ds_read_b64_tr_b16 v[40:41], v11 offset:27680
    v_mfma_f32_16x16x32_bf16 v[240:243], v[44:47], v[68:71], v[240:243]
    ds_read_b64_tr_b16 v[42:43], v11 offset:32288
    s_waitcnt lgkmcnt(8)
    v_mfma_f32_16x16x32_bf16 v[208:211], v[24:27], v[64:67], v[208:211]
    ds_read_b64_tr_b16 v[44:45], v11 offset:27712
    v_mfma_f32_16x16x32_bf16 v[244:247], v[24:27], v[68:71], v[244:247]
    ds_read_b64_tr_b16 v[46:47], v11 offset:32320
    s_waitcnt lgkmcnt(8)
    v_mfma_f32_16x16x32_bf16 v[212:215], v[28:31], v[64:67], v[212:215]
    ds_read_b64_tr_b16 v[24:25], v11 offset:27744
    v_mfma_f32_16x16x32_bf16 v[248:251], v[28:31], v[68:71], v[248:251]
    ds_read_b64_tr_b16 v[26:27], v11 offset:32352
    s_waitcnt lgkmcnt(8)
    v_mfma_f32_16x16x32_bf16 v[216:219], v[32:35], v[64:67], v[216:219]
    ds_read_b64_tr_b16 v[28:29], v11 offset:27776
    v_mfma_f32_16x16x32_bf16 v[252:255], v[32:35], v[68:71], v[252:255]
    ds_read_b64_tr_b16 v[30:31], v11 offset:32384
    s_waitcnt vmcnt(9)
    s_waitcnt lgkmcnt(8)
    v_mfma_f32_16x16x32_bf16 v[184:187], v[36:39], v[72:75], v[184:187]
    ds_read_b64_tr_b16 v[32:33], v11 offset:27808
    v_mfma_f32_16x16x32_bf16 v[220:223], v[36:39], v[76:79], v[220:223]
    ds_read_b64_tr_b16 v[34:35], v11 offset:32416
    s_waitcnt lgkmcnt(8)
    v_mfma_f32_16x16x32_bf16 v[188:191], v[40:43], v[72:75], v[188:191]
    ds_read_b64_tr_b16 v[36:37], v11 offset:27840
    v_mfma_f32_16x16x32_bf16 v[224:227], v[40:43], v[76:79], v[224:227]
    ds_read_b64_tr_b16 v[38:39], v11 offset:32448
    s_waitcnt lgkmcnt(8)
    v_mfma_f32_16x16x32_bf16 v[192:195], v[44:47], v[72:75], v[192:195]
    ds_read_b64_tr_b16 v[40:41], v11 offset:27872
    v_mfma_f32_16x16x32_bf16 v[228:231], v[44:47], v[76:79], v[228:231]
    ds_read_b64_tr_b16 v[42:43], v11 offset:32480
    s_waitcnt lgkmcnt(8)
    v_mfma_f32_16x16x32_bf16 v[196:199], v[24:27], v[72:75], v[196:199]
    ds_read_b64_tr_b16 v[44:45], v11 offset:27904
    v_mfma_f32_16x16x32_bf16 v[232:235], v[24:27], v[76:79], v[232:235]
    ds_read_b64_tr_b16 v[46:47], v11 offset:32512
    s_waitcnt lgkmcnt(8)
    v_mfma_f32_16x16x32_bf16 v[200:203], v[28:31], v[72:75], v[200:203]
    ds_read_b64_tr_b16 v[24:25], v11 offset:36864
    v_mfma_f32_16x16x32_bf16 v[236:239], v[28:31], v[76:79], v[236:239]
    ds_read_b64_tr_b16 v[26:27], v11 offset:41472
    s_waitcnt lgkmcnt(8)
    v_mfma_f32_16x16x32_bf16 v[204:207], v[32:35], v[72:75], v[204:207]
    ds_read_b64_tr_b16 v[28:29], v11 offset:36896
    v_mfma_f32_16x16x32_bf16 v[240:243], v[32:35], v[76:79], v[240:243]
    ds_read_b64_tr_b16 v[30:31], v11 offset:41504
    s_waitcnt lgkmcnt(8)
    v_mfma_f32_16x16x32_bf16 v[208:211], v[36:39], v[72:75], v[208:211]
    ds_read_b64_tr_b16 v[32:33], v11 offset:36928
    v_mfma_f32_16x16x32_bf16 v[244:247], v[36:39], v[76:79], v[244:247]
    ds_read_b64_tr_b16 v[34:35], v11 offset:41536
    s_waitcnt lgkmcnt(8)
    v_mfma_f32_16x16x32_bf16 v[212:215], v[40:43], v[72:75], v[212:215]
    ds_read_b64_tr_b16 v[36:37], v11 offset:36960
    v_mfma_f32_16x16x32_bf16 v[248:251], v[40:43], v[76:79], v[248:251]
    ds_read_b64_tr_b16 v[38:39], v11 offset:41568
    s_waitcnt lgkmcnt(8)
    v_mfma_f32_16x16x32_bf16 v[216:219], v[44:47], v[72:75], v[216:219]
    ds_read_b64_tr_b16 v[40:41], v11 offset:36992
    v_mfma_f32_16x16x32_bf16 v[252:255], v[44:47], v[76:79], v[252:255]
    ds_read_b64_tr_b16 v[42:43], v11 offset:41600
    s_waitcnt vmcnt(7)
    s_waitcnt lgkmcnt(8)
    v_mfma_f32_16x16x32_bf16 v[184:187], v[24:27], v[80:83], v[184:187]
    ds_read_b64_tr_b16 v[44:45], v11 offset:37024
    v_mfma_f32_16x16x32_bf16 v[220:223], v[24:27], v[84:87], v[220:223]
    ds_read_b64_tr_b16 v[46:47], v11 offset:41632
    s_waitcnt lgkmcnt(8)
    v_mfma_f32_16x16x32_bf16 v[188:191], v[28:31], v[80:83], v[188:191]
    ds_read_b64_tr_b16 v[24:25], v11 offset:37056
    v_mfma_f32_16x16x32_bf16 v[224:227], v[28:31], v[84:87], v[224:227]
    ds_read_b64_tr_b16 v[26:27], v11 offset:41664
    s_waitcnt lgkmcnt(8)
    v_mfma_f32_16x16x32_bf16 v[192:195], v[32:35], v[80:83], v[192:195]
    ds_read_b64_tr_b16 v[28:29], v11 offset:37088
    v_mfma_f32_16x16x32_bf16 v[228:231], v[32:35], v[84:87], v[228:231]
    ds_read_b64_tr_b16 v[30:31], v11 offset:41696
    s_waitcnt lgkmcnt(8)
    v_mfma_f32_16x16x32_bf16 v[196:199], v[36:39], v[80:83], v[196:199]
    ds_read_b64_tr_b16 v[32:33], v11 offset:37120
    v_mfma_f32_16x16x32_bf16 v[232:235], v[36:39], v[84:87], v[232:235]
    ds_read_b64_tr_b16 v[34:35], v11 offset:41728
    s_waitcnt lgkmcnt(8)
    v_mfma_f32_16x16x32_bf16 v[200:203], v[40:43], v[80:83], v[200:203]
    ds_read_b64_tr_b16 v[36:37], v11 offset:46080
    v_mfma_f32_16x16x32_bf16 v[236:239], v[40:43], v[84:87], v[236:239]
    ds_read_b64_tr_b16 v[38:39], v11 offset:50688
    s_waitcnt lgkmcnt(8)
    v_mfma_f32_16x16x32_bf16 v[204:207], v[44:47], v[80:83], v[204:207]
    ds_read_b64_tr_b16 v[40:41], v11 offset:46112
    v_mfma_f32_16x16x32_bf16 v[240:243], v[44:47], v[84:87], v[240:243]
    ds_read_b64_tr_b16 v[42:43], v11 offset:50720
    s_waitcnt lgkmcnt(8)
    v_mfma_f32_16x16x32_bf16 v[208:211], v[24:27], v[80:83], v[208:211]
    ds_read_b64_tr_b16 v[44:45], v11 offset:46144
    v_mfma_f32_16x16x32_bf16 v[244:247], v[24:27], v[84:87], v[244:247]
    ds_read_b64_tr_b16 v[46:47], v11 offset:50752
    s_waitcnt lgkmcnt(8)
    v_mfma_f32_16x16x32_bf16 v[212:215], v[28:31], v[80:83], v[212:215]
    ds_read_b64_tr_b16 v[24:25], v11 offset:46176
    v_mfma_f32_16x16x32_bf16 v[248:251], v[28:31], v[84:87], v[248:251]
    ds_read_b64_tr_b16 v[26:27], v11 offset:50784
    s_waitcnt lgkmcnt(8)
    v_mfma_f32_16x16x32_bf16 v[216:219], v[32:35], v[80:83], v[216:219]
    ds_read_b64_tr_b16 v[28:29], v11 offset:46208
    v_mfma_f32_16x16x32_bf16 v[252:255], v[32:35], v[84:87], v[252:255]
    ds_read_b64_tr_b16 v[30:31], v11 offset:50816
    s_waitcnt vmcnt(5)
    s_waitcnt lgkmcnt(8)
    v_mfma_f32_16x16x32_bf16 v[184:187], v[36:39], v[88:91], v[184:187]
    ds_read_b64_tr_b16 v[32:33], v11 offset:46240
    v_mfma_f32_16x16x32_bf16 v[220:223], v[36:39], v[92:95], v[220:223]
    ds_read_b64_tr_b16 v[34:35], v11 offset:50848
    s_waitcnt lgkmcnt(8)
    v_mfma_f32_16x16x32_bf16 v[188:191], v[40:43], v[88:91], v[188:191]
    ds_read_b64_tr_b16 v[36:37], v11 offset:46272
    v_mfma_f32_16x16x32_bf16 v[224:227], v[40:43], v[92:95], v[224:227]
    ds_read_b64_tr_b16 v[38:39], v11 offset:50880
    s_waitcnt lgkmcnt(8)
    v_mfma_f32_16x16x32_bf16 v[192:195], v[44:47], v[88:91], v[192:195]
    ds_read_b64_tr_b16 v[40:41], v11 offset:46304
    v_mfma_f32_16x16x32_bf16 v[228:231], v[44:47], v[92:95], v[228:231]
    ds_read_b64_tr_b16 v[42:43], v11 offset:50912
    s_waitcnt lgkmcnt(8)
    v_mfma_f32_16x16x32_bf16 v[196:199], v[24:27], v[88:91], v[196:199]
    ds_read_b64_tr_b16 v[44:45], v11 offset:46336
    v_mfma_f32_16x16x32_bf16 v[232:235], v[24:27], v[92:95], v[232:235]
    ds_read_b64_tr_b16 v[46:47], v11 offset:50944
    s_waitcnt lgkmcnt(8)
    v_mfma_f32_16x16x32_bf16 v[200:203], v[28:31], v[88:91], v[200:203]
    ds_read_b64_tr_b16 v[24:25], v12 offset:0
    v_mfma_f32_16x16x32_bf16 v[236:239], v[28:31], v[92:95], v[236:239]
    ds_read_b64_tr_b16 v[26:27], v12 offset:4608
    s_waitcnt lgkmcnt(8)
    v_mfma_f32_16x16x32_bf16 v[204:207], v[32:35], v[88:91], v[204:207]
    ds_read_b64_tr_b16 v[28:29], v12 offset:32
    v_mfma_f32_16x16x32_bf16 v[240:243], v[32:35], v[92:95], v[240:243]
    ds_read_b64_tr_b16 v[30:31], v12 offset:4640
    s_waitcnt lgkmcnt(8)
    v_mfma_f32_16x16x32_bf16 v[208:211], v[36:39], v[88:91], v[208:211]
    ds_read_b64_tr_b16 v[32:33], v12 offset:64
    v_mfma_f32_16x16x32_bf16 v[244:247], v[36:39], v[92:95], v[244:247]
    ds_read_b64_tr_b16 v[34:35], v12 offset:4672
    s_waitcnt lgkmcnt(8)
    v_mfma_f32_16x16x32_bf16 v[212:215], v[40:43], v[88:91], v[212:215]
    ds_read_b64_tr_b16 v[36:37], v12 offset:96
    v_mfma_f32_16x16x32_bf16 v[248:251], v[40:43], v[92:95], v[248:251]
    ds_read_b64_tr_b16 v[38:39], v12 offset:4704
    s_waitcnt lgkmcnt(8)
    v_mfma_f32_16x16x32_bf16 v[216:219], v[44:47], v[88:91], v[216:219]
    ds_read_b64_tr_b16 v[40:41], v12 offset:128
    v_mfma_f32_16x16x32_bf16 v[252:255], v[44:47], v[92:95], v[252:255]
    ds_read_b64_tr_b16 v[42:43], v12 offset:4736
    s_waitcnt vmcnt(3)
    s_waitcnt lgkmcnt(8)
    v_mfma_f32_16x16x32_bf16 v[184:187], v[24:27], v[96:99], v[184:187]
    ds_read_b64_tr_b16 v[44:45], v12 offset:160
    v_mfma_f32_16x16x32_bf16 v[220:223], v[24:27], v[100:103], v[220:223]
    ds_read_b64_tr_b16 v[46:47], v12 offset:4768
    buffer_load_dword v15, v14, s[72:75], s62 offen sc1
    s_waitcnt lgkmcnt(8)
    v_mfma_f32_16x16x32_bf16 v[188:191], v[28:31], v[96:99], v[188:191]
    ds_read_b64_tr_b16 v[24:25], v12 offset:192
    v_mfma_f32_16x16x32_bf16 v[224:227], v[28:31], v[100:103], v[224:227]
    ds_read_b64_tr_b16 v[26:27], v12 offset:4800
    s_waitcnt lgkmcnt(8)
    v_mfma_f32_16x16x32_bf16 v[192:195], v[32:35], v[96:99], v[192:195]
    ds_read_b64_tr_b16 v[28:29], v12 offset:224
    v_mfma_f32_16x16x32_bf16 v[228:231], v[32:35], v[100:103], v[228:231]
    ds_read_b64_tr_b16 v[30:31], v12 offset:4832
    s_waitcnt lgkmcnt(8)
    v_mfma_f32_16x16x32_bf16 v[196:199], v[36:39], v[96:99], v[196:199]
    ds_read_b64_tr_b16 v[32:33], v12 offset:256
    v_mfma_f32_16x16x32_bf16 v[232:235], v[36:39], v[100:103], v[232:235]
    ds_read_b64_tr_b16 v[34:35], v12 offset:4864
    s_waitcnt lgkmcnt(8)
    v_mfma_f32_16x16x32_bf16 v[200:203], v[40:43], v[96:99], v[200:203]
    ds_read_b64_tr_b16 v[36:37], v12 offset:9216
    v_mfma_f32_16x16x32_bf16 v[236:239], v[40:43], v[100:103], v[236:239]
    ds_read_b64_tr_b16 v[38:39], v12 offset:13824
    s_waitcnt lgkmcnt(8)
    v_mfma_f32_16x16x32_bf16 v[204:207], v[44:47], v[96:99], v[204:207]
    ds_read_b64_tr_b16 v[40:41], v12 offset:9248
    v_mfma_f32_16x16x32_bf16 v[240:243], v[44:47], v[100:103], v[240:243]
    ds_read_b64_tr_b16 v[42:43], v12 offset:13856
    s_waitcnt lgkmcnt(8)
    v_mfma_f32_16x16x32_bf16 v[208:211], v[24:27], v[96:99], v[208:211]
    ds_read_b64_tr_b16 v[44:45], v12 offset:9280
    v_mfma_f32_16x16x32_bf16 v[244:247], v[24:27], v[100:103], v[244:247]
    ds_read_b64_tr_b16 v[46:47], v12 offset:13888
    s_waitcnt lgkmcnt(8)
    v_mfma_f32_16x16x32_bf16 v[212:215], v[28:31], v[96:99], v[212:215]
    ds_read_b64_tr_b16 v[24:25], v12 offset:9312
    v_mfma_f32_16x16x32_bf16 v[248:251], v[28:31], v[100:103], v[248:251]
    ds_read_b64_tr_b16 v[26:27], v12 offset:13920
    s_waitcnt lgkmcnt(8)
    v_mfma_f32_16x16x32_bf16 v[216:219], v[32:35], v[96:99], v[216:219]
    ds_read_b64_tr_b16 v[28:29], v12 offset:9344
    v_mfma_f32_16x16x32_bf16 v[252:255], v[32:35], v[100:103], v[252:255]
    ds_read_b64_tr_b16 v[30:31], v12 offset:13952
    s_waitcnt vmcnt(1)
    s_waitcnt lgkmcnt(8)
    v_mfma_f32_16x16x32_bf16 v[184:187], v[36:39], v[104:107], v[184:187]
    ds_read_b64_tr_b16 v[32:33], v12 offset:9376
    v_mfma_f32_16x16x32_bf16 v[220:223], v[36:39], v[108:111], v[220:223]
    ds_read_b64_tr_b16 v[34:35], v12 offset:13984
    s_waitcnt lgkmcnt(8)
    v_mfma_f32_16x16x32_bf16 v[188:191], v[40:43], v[104:107], v[188:191]
    ds_read_b64_tr_b16 v[36:37], v12 offset:9408
    v_mfma_f32_16x16x32_bf16 v[224:227], v[40:43], v[108:111], v[224:227]
    ds_read_b64_tr_b16 v[38:39], v12 offset:14016
    s_waitcnt lgkmcnt(8)
    v_mfma_f32_16x16x32_bf16 v[192:195], v[44:47], v[104:107], v[192:195]
    ds_read_b64_tr_b16 v[40:41], v12 offset:9440
    v_mfma_f32_16x16x32_bf16 v[228:231], v[44:47], v[108:111], v[228:231]
    ds_read_b64_tr_b16 v[42:43], v12 offset:14048
    s_waitcnt lgkmcnt(8)
    v_mfma_f32_16x16x32_bf16 v[196:199], v[24:27], v[104:107], v[196:199]
    ds_read_b64_tr_b16 v[44:45], v12 offset:9472
    v_mfma_f32_16x16x32_bf16 v[232:235], v[24:27], v[108:111], v[232:235]
    ds_read_b64_tr_b16 v[46:47], v12 offset:14080
    s_waitcnt lgkmcnt(8)
    v_mfma_f32_16x16x32_bf16 v[200:203], v[28:31], v[104:107], v[200:203]
    v_mfma_f32_16x16x32_bf16 v[236:239], v[28:31], v[108:111], v[236:239]
    s_waitcnt lgkmcnt(6)
    v_mfma_f32_16x16x32_bf16 v[204:207], v[32:35], v[104:107], v[204:207]
    v_mfma_f32_16x16x32_bf16 v[240:243], v[32:35], v[108:111], v[240:243]
    s_waitcnt lgkmcnt(4)
    v_mfma_f32_16x16x32_bf16 v[208:211], v[36:39], v[104:107], v[208:211]
    v_mfma_f32_16x16x32_bf16 v[244:247], v[36:39], v[108:111], v[244:247]
    s_waitcnt lgkmcnt(2)
    v_mfma_f32_16x16x32_bf16 v[212:215], v[40:43], v[104:107], v[212:215]
    v_mfma_f32_16x16x32_bf16 v[248:251], v[40:43], v[108:111], v[248:251]
    s_waitcnt lgkmcnt(0)
    v_mfma_f32_16x16x32_bf16 v[216:219], v[44:47], v[104:107], v[216:219]
    v_mfma_f32_16x16x32_bf16 v[252:255], v[44:47], v[108:111], v[252:255]
    s_mov_b32 s44, 0x00003f80
    s_mov_b32 s45, 0x3f800000
    v_cvt_pk_bf16_f32 v20, v184, v185
    v_cvt_pk_bf16_f32 v21, v186, v187
    v_cvt_pk_bf16_f32 v22, v188, v189
    v_cvt_pk_bf16_f32 v23, v190, v191
    s_add_u32 s39, s59, 0
    buffer_store_dwordx4 v[20:23], v2, s[20:23], s39 offen offset:0 sc1
    v_cvt_pk_bf16_f32 v4, v192, v193
    v_cvt_pk_bf16_f32 v5, v194, v195
    v_cvt_pk_bf16_f32 v6, v196, v197
    v_cvt_pk_bf16_f32 v7, v198, v199
    buffer_store_dwordx4 v[4:7], v2, s[20:23], s39 offen offset:1024 sc1
    v_cvt_pk_bf16_f32 v20, v200, v201
    v_cvt_pk_bf16_f32 v21, v202, v203
    v_cvt_pk_bf16_f32 v22, v204, v205
    v_cvt_pk_bf16_f32 v23, v206, v207
    buffer_store_dwordx4 v[20:23], v2, s[20:23], s39 offen offset:2048 sc1
    v_cvt_pk_bf16_f32 v4, v208, v209
    v_cvt_pk_bf16_f32 v5, v210, v211
    v_cvt_pk_bf16_f32 v6, v212, v213
    v_cvt_pk_bf16_f32 v7, v214, v215
    buffer_store_dwordx4 v[4:7], v2, s[20:23], s39 offen offset:3072 sc1
    v_cvt_pk_bf16_f32 v20, v216, v217
    v_cvt_pk_bf16_f32 v21, v218, v219
    s_add_u32 s39, s59, 4096
    buffer_store_dwordx2 v[20:21], v10, s[20:23], s39 offen offset:0 sc1
    v_cvt_pk_bf16_f32 v4, v220, v221
    v_cvt_pk_bf16_f32 v5, v222, v223
    v_cvt_pk_bf16_f32 v6, v224, v225
    v_cvt_pk_bf16_f32 v7, v226, v227
    s_add_u32 s39, s59, 4608
    buffer_store_dwordx4 v[4:7], v2, s[20:23], s39 offen offset:0 sc1
    v_cvt_pk_bf16_f32 v20, v228, v229
    v_cvt_pk_bf16_f32 v21, v230, v231
    v_cvt_pk_bf16_f32 v22, v232, v233
    v_cvt_pk_bf16_f32 v23, v234, v235
    buffer_store_dwordx4 v[20:23], v2, s[20:23], s39 offen offset:1024 sc1
    v_cvt_pk_bf16_f32 v4, v236, v237
    v_cvt_pk_bf16_f32 v5, v238, v239
    v_cvt_pk_bf16_f32 v6, v240, v241
    v_cvt_pk_bf16_f32 v7, v242, v243
    buffer_store_dwordx4 v[4:7], v2, s[20:23], s39 offen offset:2048 sc1
    v_cvt_pk_bf16_f32 v20, v244, v245
    v_cvt_pk_bf16_f32 v21, v246, v247
    v_cvt_pk_bf16_f32 v22, v248, v249
    v_cvt_pk_bf16_f32 v23, v250, v251
    buffer_store_dwordx4 v[20:23], v2, s[20:23], s39 offen offset:3072 sc1
    v_cvt_pk_bf16_f32 v4, v252, v253
    v_cvt_pk_bf16_f32 v5, v254, v255
    s_add_u32 s39, s59, 8704
    buffer_store_dwordx2 v[4:5], v10, s[20:23], s39 offen offset:0 sc1
    s_waitcnt vmcnt(10)
    v_cmp_ne_u32 vcc, s69, v15
    s_cbranch_vccnz ka_kernel_ea_58
    s_lshl_b32 s38, s43, 10
    s_add_u32 s38, s38, s64
    s_add_u32 s39, s64, 4096
    s_cmp_eq_u32 s43, 0
    s_cselect_b32 s39, s39, 2146435072
    buffer_load_dwordx4 v[64:67], v2, s[20:23], s38 offen sc1
    s_add_u32 s38, s38, 36864
    buffer_load_dwordx4 v[68:71], v2, s[20:23], s38 offen sc1
    s_add_u32 s38, s38, 36864
    buffer_load_dwordx4 v[72:75], v2, s[20:23], s38 offen sc1
    s_add_u32 s38, s38, 36864
    buffer_load_dwordx4 v[76:79], v2, s[20:23], s38 offen sc1
    s_add_u32 s38, s38, 36864
    buffer_load_dwordx4 v[80:83], v2, s[20:23], s38 offen sc1
    s_add_u32 s38, s38, 36864
    buffer_load_dwordx4 v[84:87], v2, s[20:23], s38 offen sc1
    s_add_u32 s38, s38, 36864
    buffer_load_dwordx4 v[88:91], v2, s[20:23], s38 offen sc1
    s_add_u32 s38, s38, 36864
    buffer_load_dwordx4 v[92:95], v2, s[20:23], s38 offen sc1
    s_add_u32 s38, s38, 36864
    buffer_load_dwordx2 v[96:97], v10, s[20:23], s39 offen sc1
    s_add_u32 s39, s39, 36864
    buffer_load_dwordx2 v[98:99], v10, s[20:23], s39 offen sc1
    s_add_u32 s39, s39, 36864
    buffer_load_dwordx2 v[100:101], v10, s[20:23], s39 offen sc1
    s_add_u32 s39, s39, 36864
    buffer_load_dwordx2 v[102:103], v10, s[20:23], s39 offen sc1
    s_add_u32 s39, s39, 36864
    buffer_load_dwordx2 v[104:105], v10, s[20:23], s39 offen sc1
    s_add_u32 s39, s39, 36864
    buffer_load_dwordx2 v[106:107], v10, s[20:23], s39 offen sc1
    s_add_u32 s39, s39, 36864
    buffer_load_dwordx2 v[108:109], v10, s[20:23], s39 offen sc1
    s_add_u32 s39, s39, 36864
    buffer_load_dwordx2 v[110:111], v10, s[20:23], s39 offen sc1
    s_add_u32 s39, s39, 36864
    s_waitcnt vmcnt(16)
    v_mov_b32 v18, s69
    v_mov_b32 v19, 0
    s_mov_b64 exec, 1
    buffer_store_dword v18, v19, s[72:75], s61 offen sc1
    s_mov_b64 exec, -1
    s_lshl_b32 s38, s43, 6
    s_add_u32 s38, s38, s48
    s_add_u32 s39, s48, 256
    s_cmp_eq_u32 s43, 0
    s_cselect_b32 s39, s39, 2146435072
    s_waitcnt vmcnt(16)
    v_lshlrev_b32 v40, 16, v64
    v_and_b32 v41, 0xffff0000, v64
    v_lshlrev_b32 v42, 16, v65
    v_and_b32 v43, 0xffff0000, v65
    v_lshlrev_b32 v44, 16, v66
    v_and_b32 v45, 0xffff0000, v66
    v_lshlrev_b32 v46, 16, v67
    v_and_b32 v47, 0xffff0000, v67
    s_waitcnt vmcnt(15)
    v_dot2_f32_bf16 v40, v68, s44, v40
    v_dot2_f32_bf16 v41, v68, s45, v41
    v_dot2_f32_bf16 v42, v69, s44, v42
    v_dot2_f32_bf16 v43, v69, s45, v43
    v_dot2_f32_bf16 v44, v70, s44, v44
    v_dot2_f32_bf16 v45, v70, s45, v45
    v_dot2_f32_bf16 v46, v71, s44, v46
    v_dot2_f32_bf16 v47, v71, s45, v47
    s_waitcnt vmcnt(14)
    v_dot2_f32_bf16 v40, v72, s44, v40
    v_dot2_f32_bf16 v41, v72, s45, v41
    v_dot2_f32_bf16 v42, v73, s44, v42
    v_dot2_f32_bf16 v43, v73, s45, v43
    v_dot2_f32_bf16 v44, v74, s44, v44
    v_dot2_f32_bf16 v45, v74, s45, v45
    v_dot2_f32_bf16 v46, v75, s44, v46
    v_dot2_f32_bf16 v47, v75, s45, v47
    s_waitcnt vmcnt(13)
    v_dot2_f32_bf16 v40, v76, s44, v40
    v_dot2_f32_bf16 v41, v76, s45, v41
    v_dot2_f32_bf16 v42, v77, s44, v42
    v_dot2_f32_bf16 v43, v77, s45, v43
    v_dot2_f32_bf16 v44, v78, s44, v44
    v_dot2_f32_bf16 v45, v78, s45, v45
    v_dot2_f32_bf16 v46, v79, s44, v46
    v_dot2_f32_bf16 v47, v79, s45, v47
    s_waitcnt vmcnt(12)
    v_dot2_f32_bf16 v40, v80, s44, v40
    v_dot2_f32_bf16 v41, v80, s45, v41
    v_dot2_f32_bf16 v42, v81, s44, v42
    v_dot2_f32_bf16 v43, v81, s45, v43
    v_dot2_f32_bf16 v44, v82, s44, v44
    v_dot2_f32_bf16 v45, v82, s45, v45
    v_dot2_f32_bf16 v46, v83, s44, v46
    v_dot2_f32_bf16 v47, v83, s45, v47
    s_waitcnt vmcnt(11)
    v_dot2_f32_bf16 v40, v84, s44, v40
    v_dot2_f32_bf16 v41, v84, s45, v41
    v_dot2_f32_bf16 v42, v85, s44, v42
    v_dot2_f32_bf16 v43, v85, s45, v43
    v_dot2_f32_bf16 v44, v86, s44, v44
    v_dot2_f32_bf16 v45, v86, s45, v45
    v_dot2_f32_bf16 v46, v87, s44, v46
    v_dot2_f32_bf16 v47, v87, s45, v47
    s_waitcnt vmcnt(10)
    v_dot2_f32_bf16 v40, v88, s44, v40
    v_dot2_f32_bf16 v41, v88, s45, v41
    v_dot2_f32_bf16 v42, v89, s44, v42
    v_dot2_f32_bf16 v43, v89, s45, v43
    v_dot2_f32_bf16 v44, v90, s44, v44
    v_dot2_f32_bf16 v45, v90, s45, v45
    v_dot2_f32_bf16 v46, v91, s44, v46
    v_dot2_f32_bf16 v47, v91, s45, v47
    s_waitcnt vmcnt(9)
    v_dot2_f32_bf16 v40, v92, s44, v40
    v_dot2_f32_bf16 v41, v92, s45, v41
    v_dot2_f32_bf16 v42, v93, s44, v42
    v_dot2_f32_bf16 v43, v93, s45, v43
    v_dot2_f32_bf16 v44, v94, s44, v44
    v_dot2_f32_bf16 v45, v94, s45, v45
    v_dot2_f32_bf16 v46, v95, s44, v46
    v_dot2_f32_bf16 v47, v95, s45, v47
    s_nop 2
    v_cvt_pk_bf16_f32 v56, v40, v41
    v_cvt_pk_bf16_f32 v57, v42, v43
    v_cvt_pk_bf16_f32 v58, v44, v45
    v_cvt_pk_bf16_f32 v59, v46, v47
    buffer_store_dwordx2 v[56:57], v9, s[16:19], s38 offen
    buffer_store_dwordx2 v[58:59], v9, s[16:19], s38 offen offset:32
    s_waitcnt vmcnt(10)
    v_lshlrev_b32 v52, 16, v96
    v_and_b32 v53, 0xffff0000, v96
    v_lshlrev_b32 v54, 16, v97
    v_and_b32 v55, 0xffff0000, v97
    s_waitcnt vmcnt(9)
    v_dot2_f32_bf16 v52, v98, s44, v52
    v_dot2_f32_bf16 v53, v98, s45, v53
    v_dot2_f32_bf16 v54, v99, s44, v54
    v_dot2_f32_bf16 v55, v99, s45, v55
    s_waitcnt vmcnt(8)
    v_dot2_f32_bf16 v52, v100, s44, v52
    v_dot2_f32_bf16 v53, v100, s45, v53
    v_dot2_f32_bf16 v54, v101, s44, v54
    v_dot2_f32_bf16 v55, v101, s45, v55
    s_waitcnt vmcnt(7)
    v_dot2_f32_bf16 v52, v102, s44, v52
    v_dot2_f32_bf16 v53, v102, s45, v53
    v_dot2_f32_bf16 v54, v103, s44, v54
    v_dot2_f32_bf16 v55, v103, s45, v55
    s_waitcnt vmcnt(6)
    v_dot2_f32_bf16 v52, v104, s44, v52
    v_dot2_f32_bf16 v53, v104, s45, v53
    v_dot2_f32_bf16 v54, v105, s44, v54
    v_dot2_f32_bf16 v55, v105, s45, v55
    s_waitcnt vmcnt(5)
    v_dot2_f32_bf16 v52, v106, s44, v52
    v_dot2_f32_bf16 v53, v106, s45, v53
    v_dot2_f32_bf16 v54, v107, s44, v54
    v_dot2_f32_bf16 v55, v107, s45, v55
    s_waitcnt vmcnt(4)
    v_dot2_f32_bf16 v52, v108, s44, v52
    v_dot2_f32_bf16 v53, v108, s45, v53
    v_dot2_f32_bf16 v54, v109, s44, v54
    v_dot2_f32_bf16 v55, v109, s45, v55
    s_waitcnt vmcnt(3)
    v_dot2_f32_bf16 v52, v110, s44, v52
    v_dot2_f32_bf16 v53, v110, s45, v53
    v_dot2_f32_bf16 v54, v111, s44, v54
    v_dot2_f32_bf16 v55, v111, s45, v55
    s_nop 2
    v_cvt_pk_bf16_f32 v60, v52, v53
    v_cvt_pk_bf16_f32 v61, v54, v55
    buffer_store_dwordx2 v[60:61], v9, s[16:19], s39 offen
    s_branch ka_kernel_eb_59
ka_kernel_ea_58:
    s_waitcnt vmcnt(0)
    v_mov_b32 v18, s69
    v_mov_b32 v19, 0
    s_mov_b64 exec, 1
    buffer_store_dword v18, v19, s[72:75], s61 offen sc1
    s_mov_b64 exec, -1
    s_mov_b32 s37, 0
ka_kernel_sp_60:
    buffer_load_dword v15, v14, s[72:75], s62 offen sc1
    s_waitcnt vmcnt(0)
ka_kernel_sc_61:
    v_cmp_ne_u32 vcc, s69, v15
    s_add_u32 s37, s37, 1
    s_cbranch_vccz ka_kernel_ok_62
    s_cmp_lt_u32 s37, 0x40000
    s_cbranch_scc1 ka_kernel_sp_60
ka_kernel_ok_62:
    s_lshl_b32 s38, s43, 10
    s_add_u32 s38, s38, s64
    s_add_u32 s39, s64, 4096
    s_cmp_eq_u32 s43, 0
    s_cselect_b32 s39, s39, 2146435072
    buffer_load_dwordx4 v[64:67], v2, s[20:23], s38 offen sc1
    s_add_u32 s38, s38, 36864
    buffer_load_dwordx4 v[68:71], v2, s[20:23], s38 offen sc1
    s_add_u32 s38, s38, 36864
    buffer_load_dwordx4 v[72:75], v2, s[20:23], s38 offen sc1
    s_add_u32 s38, s38, 36864
    buffer_load_dwordx4 v[76:79], v2, s[20:23], s38 offen sc1
    s_add_u32 s38, s38, 36864
    buffer_load_dwordx4 v[80:83], v2, s[20:23], s38 offen sc1
    s_add_u32 s38, s38, 36864
    buffer_load_dwordx4 v[84:87], v2, s[20:23], s38 offen sc1
    s_add_u32 s38, s38, 36864
    buffer_load_dwordx4 v[88:91], v2, s[20:23], s38 offen sc1
    s_add_u32 s38, s38, 36864
    buffer_load_dwordx4 v[92:95], v2, s[20:23], s38 offen sc1
    s_add_u32 s38, s38, 36864
    buffer_load_dwordx2 v[96:97], v10, s[20:23], s39 offen sc1
    s_add_u32 s39, s39, 36864
    buffer_load_dwordx2 v[98:99], v10, s[20:23], s39 offen sc1
    s_add_u32 s39, s39, 36864
    buffer_load_dwordx2 v[100:101], v10, s[20:23], s39 offen sc1
    s_add_u32 s39, s39, 36864
    buffer_load_dwordx2 v[102:103], v10, s[20:23], s39 offen sc1
    s_add_u32 s39, s39, 36864
    buffer_load_dwordx2 v[104:105], v10, s[20:23], s39 offen sc1
    s_add_u32 s39, s39, 36864
    buffer_load_dwordx2 v[106:107], v10, s[20:23], s39 offen sc1
    s_add_u32 s39, s39, 36864
    buffer_load_dwordx2 v[108:109], v10, s[20:23], s39 offen sc1
    s_add_u32 s39, s39, 36864
    buffer_load_dwordx2 v[110:111], v10, s[20:23], s39 offen sc1
    s_add_u32 s39, s39, 36864
    s_lshl_b32 s38, s43, 6
    s_add_u32 s38, s38, s48
    s_add_u32 s39, s48, 256
    s_cmp_eq_u32 s43, 0
    s_cselect_b32 s39, s39, 2146435072
    s_waitcnt vmcnt(15)
    v_lshlrev_b32 v40, 16, v64
    v_and_b32 v41, 0xffff0000, v64
    v_lshlrev_b32 v42, 16, v65
    v_and_b32 v43, 0xffff0000, v65
    v_lshlrev_b32 v44, 16, v66
    v_and_b32 v45, 0xffff0000, v66
    v_lshlrev_b32 v46, 16, v67
    v_and_b32 v47, 0xffff0000, v67
    s_waitcnt vmcnt(14)
    v_dot2_f32_bf16 v40, v68, s44, v40
    v_dot2_f32_bf16 v41, v68, s45, v41
    v_dot2_f32_bf16 v42, v69, s44, v42
    v_dot2_f32_bf16 v43, v69, s45, v43
    v_dot2_f32_bf16 v44, v70, s44, v44
    v_dot2_f32_bf16 v45, v70, s45, v45
    v_dot2_f32_bf16 v46, v71, s44, v46
    v_dot2_f32_bf16 v47, v71, s45, v47
    s_waitcnt vmcnt(13)
    v_dot2_f32_bf16 v40, v72, s44, v40
    v_dot2_f32_bf16 v41, v72, s45, v41
    v_dot2_f32_bf16 v42, v73, s44, v42
    v_dot2_f32_bf16 v43, v73, s45, v43
    v_dot2_f32_bf16 v44, v74, s44, v44
    v_dot2_f32_bf16 v45, v74, s45, v45
    v_dot2_f32_bf16 v46, v75, s44, v46
    v_dot2_f32_bf16 v47, v75, s45, v47
    s_waitcnt vmcnt(12)
    v_dot2_f32_bf16 v40, v76, s44, v40
    v_dot2_f32_bf16 v41, v76, s45, v41
    v_dot2_f32_bf16 v42, v77, s44, v42
    v_dot2_f32_bf16 v43, v77, s45, v43
    v_dot2_f32_bf16 v44, v78, s44, v44
    v_dot2_f32_bf16 v45, v78, s45, v45
    v_dot2_f32_bf16 v46, v79, s44, v46
    v_dot2_f32_bf16 v47, v79, s45, v47
    s_waitcnt vmcnt(11)
    v_dot2_f32_bf16 v40, v80, s44, v40
    v_dot2_f32_bf16 v41, v80, s45, v41
    v_dot2_f32_bf16 v42, v81, s44, v42
    v_dot2_f32_bf16 v43, v81, s45, v43
    v_dot2_f32_bf16 v44, v82, s44, v44
    v_dot2_f32_bf16 v45, v82, s45, v45
    v_dot2_f32_bf16 v46, v83, s44, v46
    v_dot2_f32_bf16 v47, v83, s45, v47
    s_waitcnt vmcnt(10)
    v_dot2_f32_bf16 v40, v84, s44, v40
    v_dot2_f32_bf16 v41, v84, s45, v41
    v_dot2_f32_bf16 v42, v85, s44, v42
    v_dot2_f32_bf16 v43, v85, s45, v43
    v_dot2_f32_bf16 v44, v86, s44, v44
    v_dot2_f32_bf16 v45, v86, s45, v45
    v_dot2_f32_bf16 v46, v87, s44, v46
    v_dot2_f32_bf16 v47, v87, s45, v47
    s_waitcnt vmcnt(9)
    v_dot2_f32_bf16 v40, v88, s44, v40
    v_dot2_f32_bf16 v41, v88, s45, v41
    v_dot2_f32_bf16 v42, v89, s44, v42
    v_dot2_f32_bf16 v43, v89, s45, v43
    v_dot2_f32_bf16 v44, v90, s44, v44
    v_dot2_f32_bf16 v45, v90, s45, v45
    v_dot2_f32_bf16 v46, v91, s44, v46
    v_dot2_f32_bf16 v47, v91, s45, v47
    s_waitcnt vmcnt(8)
    v_dot2_f32_bf16 v40, v92, s44, v40
    v_dot2_f32_bf16 v41, v92, s45, v41
    v_dot2_f32_bf16 v42, v93, s44, v42
    v_dot2_f32_bf16 v43, v93, s45, v43
    v_dot2_f32_bf16 v44, v94, s44, v44
    v_dot2_f32_bf16 v45, v94, s45, v45
    v_dot2_f32_bf16 v46, v95, s44, v46
    v_dot2_f32_bf16 v47, v95, s45, v47
    s_nop 2
    v_cvt_pk_bf16_f32 v56, v40, v41
    v_cvt_pk_bf16_f32 v57, v42, v43
    v_cvt_pk_bf16_f32 v58, v44, v45
    v_cvt_pk_bf16_f32 v59, v46, v47
    buffer_store_dwordx2 v[56:57], v9, s[16:19], s38 offen
    buffer_store_dwordx2 v[58:59], v9, s[16:19], s38 offen offset:32
    s_waitcnt vmcnt(9)
    v_lshlrev_b32 v52, 16, v96
    v_and_b32 v53, 0xffff0000, v96
    v_lshlrev_b32 v54, 16, v97
    v_and_b32 v55, 0xffff0000, v97
    s_waitcnt vmcnt(8)
    v_dot2_f32_bf16 v52, v98, s44, v52
    v_dot2_f32_bf16 v53, v98, s45, v53
    v_dot2_f32_bf16 v54, v99, s44, v54
    v_dot2_f32_bf16 v55, v99, s45, v55
    s_waitcnt vmcnt(7)
    v_dot2_f32_bf16 v52, v100, s44, v52
    v_dot2_f32_bf16 v53, v100, s45, v53
    v_dot2_f32_bf16 v54, v101, s44, v54
    v_dot2_f32_bf16 v55, v101, s45, v55
    s_waitcnt vmcnt(6)
    v_dot2_f32_bf16 v52, v102, s44, v52
    v_dot2_f32_bf16 v53, v102, s45, v53
    v_dot2_f32_bf16 v54, v103, s44, v54
    v_dot2_f32_bf16 v55, v103, s45, v55
    s_waitcnt vmcnt(5)
    v_dot2_f32_bf16 v52, v104, s44, v52
    v_dot2_f32_bf16 v53, v104, s45, v53
    v_dot2_f32_bf16 v54, v105, s44, v54
    v_dot2_f32_bf16 v55, v105, s45, v55
    s_waitcnt vmcnt(4)
    v_dot2_f32_bf16 v52, v106, s44, v52
    v_dot2_f32_bf16 v53, v106, s45, v53
    v_dot2_f32_bf16 v54, v107, s44, v54
    v_dot2_f32_bf16 v55, v107, s45, v55
    s_waitcnt vmcnt(3)
    v_dot2_f32_bf16 v52, v108, s44, v52
    v_dot2_f32_bf16 v53, v108, s45, v53
    v_dot2_f32_bf16 v54, v109, s44, v54
    v_dot2_f32_bf16 v55, v109, s45, v55
    s_waitcnt vmcnt(2)
    v_dot2_f32_bf16 v52, v110, s44, v52
    v_dot2_f32_bf16 v53, v110, s45, v53
    v_dot2_f32_bf16 v54, v111, s44, v54
    v_dot2_f32_bf16 v55, v111, s45, v55
    s_nop 2
    v_cvt_pk_bf16_f32 v60, v52, v53
    v_cvt_pk_bf16_f32 v61, v54, v55
    buffer_store_dwordx2 v[60:61], v9, s[16:19], s39 offen
ka_kernel_eb_59:
    s_mov_b32 s37, 0
ka_kernel_sp_63:
    buffer_load_dword v15, v14, s[72:75], s63 offen sc1
    s_waitcnt vmcnt(0)
ka_kernel_sc_64:
    v_cmp_ne_u32 vcc, s69, v15
    s_add_u32 s37, s37, 1
    s_cbranch_vccz ka_kernel_ok_65
    s_cmp_lt_u32 s37, 0x40000
    s_cbranch_scc1 ka_kernel_sp_63
ka_kernel_ok_65:
    s_lshl_b32 s38, s43, 10
    s_add_u32 s38, s38, s65
    s_add_u32 s39, s65, 4096
    s_cmp_eq_u32 s43, 1
    s_cselect_b32 s39, s39, 2146435072
    buffer_load_dwordx4 v[64:67], v2, s[20:23], s38 offen sc1
    s_add_u32 s38, s38, 36864
    buffer_load_dwordx4 v[68:71], v2, s[20:23], s38 offen sc1
    s_add_u32 s38, s38, 36864
    buffer_load_dwordx4 v[72:75], v2, s[20:23], s38 offen sc1
    s_add_u32 s38, s38, 36864
    buffer_load_dwordx4 v[76:79], v2, s[20:23], s38 offen sc1
    s_add_u32 s38, s38, 36864
    buffer_load_dwordx4 v[80:83], v2, s[20:23], s38 offen sc1
    s_add_u32 s38, s38, 36864
    buffer_load_dwordx4 v[84:87], v2, s[20:23], s38 offen sc1
    s_add_u32 s38, s38, 36864
    buffer_load_dwordx4 v[88:91], v2, s[20:23], s38 offen sc1
    s_add_u32 s38, s38, 36864
    buffer_load_dwordx4 v[92:95], v2, s[20:23], s38 offen sc1
    s_add_u32 s38, s38, 36864
    buffer_load_dwordx2 v[96:97], v10, s[20:23], s39 offen sc1
    s_add_u32 s39, s39, 36864
    buffer_load_dwordx2 v[98:99], v10, s[20:23], s39 offen sc1
    s_add_u32 s39, s39, 36864
    buffer_load_dwordx2 v[100:101], v10, s[20:23], s39 offen sc1
    s_add_u32 s39, s39, 36864
    buffer_load_dwordx2 v[102:103], v10, s[20:23], s39 offen sc1
    s_add_u32 s39, s39, 36864
    buffer_load_dwordx2 v[104:105], v10, s[20:23], s39 offen sc1
    s_add_u32 s39, s39, 36864
    buffer_load_dwordx2 v[106:107], v10, s[20:23], s39 offen sc1
    s_add_u32 s39, s39, 36864
    buffer_load_dwordx2 v[108:109], v10, s[20:23], s39 offen sc1
    s_add_u32 s39, s39, 36864
    buffer_load_dwordx2 v[110:111], v10, s[20:23], s39 offen sc1
    s_add_u32 s39, s39, 36864
    s_lshl_b32 s38, s43, 6
    s_add_u32 s38, s38, s49
    s_add_u32 s39, s49, 256
    s_cmp_eq_u32 s43, 1
    s_cselect_b32 s39, s39, 2146435072
    s_waitcnt vmcnt(15)
    v_lshlrev_b32 v40, 16, v64
    v_and_b32 v41, 0xffff0000, v64
    v_lshlrev_b32 v42, 16, v65
    v_and_b32 v43, 0xffff0000, v65
    v_lshlrev_b32 v44, 16, v66
    v_and_b32 v45, 0xffff0000, v66
    v_lshlrev_b32 v46, 16, v67
    v_and_b32 v47, 0xffff0000, v67
    s_waitcnt vmcnt(14)
    v_dot2_f32_bf16 v40, v68, s44, v40
    v_dot2_f32_bf16 v41, v68, s45, v41
    v_dot2_f32_bf16 v42, v69, s44, v42
    v_dot2_f32_bf16 v43, v69, s45, v43
    v_dot2_f32_bf16 v44, v70, s44, v44
    v_dot2_f32_bf16 v45, v70, s45, v45
    v_dot2_f32_bf16 v46, v71, s44, v46
    v_dot2_f32_bf16 v47, v71, s45, v47
    s_waitcnt vmcnt(13)
    v_dot2_f32_bf16 v40, v72, s44, v40
    v_dot2_f32_bf16 v41, v72, s45, v41
    v_dot2_f32_bf16 v42, v73, s44, v42
    v_dot2_f32_bf16 v43, v73, s45, v43
    v_dot2_f32_bf16 v44, v74, s44, v44
    v_dot2_f32_bf16 v45, v74, s45, v45
    v_dot2_f32_bf16 v46, v75, s44, v46
    v_dot2_f32_bf16 v47, v75, s45, v47
    s_waitcnt vmcnt(12)
    v_dot2_f32_bf16 v40, v76, s44, v40
    v_dot2_f32_bf16 v41, v76, s45, v41
    v_dot2_f32_bf16 v42, v77, s44, v42
    v_dot2_f32_bf16 v43, v77, s45, v43
    v_dot2_f32_bf16 v44, v78, s44, v44
    v_dot2_f32_bf16 v45, v78, s45, v45
    v_dot2_f32_bf16 v46, v79, s44, v46
    v_dot2_f32_bf16 v47, v79, s45, v47
    s_waitcnt vmcnt(11)
    v_dot2_f32_bf16 v40, v80, s44, v40
    v_dot2_f32_bf16 v41, v80, s45, v41
    v_dot2_f32_bf16 v42, v81, s44, v42
    v_dot2_f32_bf16 v43, v81, s45, v43
    v_dot2_f32_bf16 v44, v82, s44, v44
    v_dot2_f32_bf16 v45, v82, s45, v45
    v_dot2_f32_bf16 v46, v83, s44, v46
    v_dot2_f32_bf16 v47, v83, s45, v47
    s_waitcnt vmcnt(10)
    v_dot2_f32_bf16 v40, v84, s44, v40
    v_dot2_f32_bf16 v41, v84, s45, v41
    v_dot2_f32_bf16 v42, v85, s44, v42
    v_dot2_f32_bf16 v43, v85, s45, v43
    v_dot2_f32_bf16 v44, v86, s44, v44
    v_dot2_f32_bf16 v45, v86, s45, v45
    v_dot2_f32_bf16 v46, v87, s44, v46
    v_dot2_f32_bf16 v47, v87, s45, v47
    s_waitcnt vmcnt(9)
    v_dot2_f32_bf16 v40, v88, s44, v40
    v_dot2_f32_bf16 v41, v88, s45, v41
    v_dot2_f32_bf16 v42, v89, s44, v42
    v_dot2_f32_bf16 v43, v89, s45, v43
    v_dot2_f32_bf16 v44, v90, s44, v44
    v_dot2_f32_bf16 v45, v90, s45, v45
    v_dot2_f32_bf16 v46, v91, s44, v46
    v_dot2_f32_bf16 v47, v91, s45, v47
    s_waitcnt vmcnt(8)
    v_dot2_f32_bf16 v40, v92, s44, v40
    v_dot2_f32_bf16 v41, v92, s45, v41
    v_dot2_f32_bf16 v42, v93, s44, v42
    v_dot2_f32_bf16 v43, v93, s45, v43
    v_dot2_f32_bf16 v44, v94, s44, v44
    v_dot2_f32_bf16 v45, v94, s45, v45
    v_dot2_f32_bf16 v46, v95, s44, v46
    v_dot2_f32_bf16 v47, v95, s45, v47
    s_nop 2
    v_cvt_pk_bf16_f32 v56, v40, v41
    v_cvt_pk_bf16_f32 v57, v42, v43
    v_cvt_pk_bf16_f32 v58, v44, v45
    v_cvt_pk_bf16_f32 v59, v46, v47
    buffer_store_dwordx2 v[56:57], v9, s[16:19], s38 offen
    buffer_store_dwordx2 v[58:59], v9, s[16:19], s38 offen offset:32
    s_waitcnt vmcnt(9)
    v_lshlrev_b32 v52, 16, v96
    v_and_b32 v53, 0xffff0000, v96
    v_lshlrev_b32 v54, 16, v97
    v_and_b32 v55, 0xffff0000, v97
    s_waitcnt vmcnt(8)
    v_dot2_f32_bf16 v52, v98, s44, v52
    v_dot2_f32_bf16 v53, v98, s45, v53
    v_dot2_f32_bf16 v54, v99, s44, v54
    v_dot2_f32_bf16 v55, v99, s45, v55
    s_waitcnt vmcnt(7)
    v_dot2_f32_bf16 v52, v100, s44, v52
    v_dot2_f32_bf16 v53, v100, s45, v53
    v_dot2_f32_bf16 v54, v101, s44, v54
    v_dot2_f32_bf16 v55, v101, s45, v55
    s_waitcnt vmcnt(6)
    v_dot2_f32_bf16 v52, v102, s44, v52
    v_dot2_f32_bf16 v53, v102, s45, v53
    v_dot2_f32_bf16 v54, v103, s44, v54
    v_dot2_f32_bf16 v55, v103, s45, v55
    s_waitcnt vmcnt(5)
    v_dot2_f32_bf16 v52, v104, s44, v52
    v_dot2_f32_bf16 v53, v104, s45, v53
    v_dot2_f32_bf16 v54, v105, s44, v54
    v_dot2_f32_bf16 v55, v105, s45, v55
    s_waitcnt vmcnt(4)
    v_dot2_f32_bf16 v52, v106, s44, v52
    v_dot2_f32_bf16 v53, v106, s45, v53
    v_dot2_f32_bf16 v54, v107, s44, v54
    v_dot2_f32_bf16 v55, v107, s45, v55
    s_waitcnt vmcnt(3)
    v_dot2_f32_bf16 v52, v108, s44, v52
    v_dot2_f32_bf16 v53, v108, s45, v53
    v_dot2_f32_bf16 v54, v109, s44, v54
    v_dot2_f32_bf16 v55, v109, s45, v55
    s_waitcnt vmcnt(2)
    v_dot2_f32_bf16 v52, v110, s44, v52
    v_dot2_f32_bf16 v53, v110, s45, v53
    v_dot2_f32_bf16 v54, v111, s44, v54
    v_dot2_f32_bf16 v55, v111, s45, v55
    s_nop 2
    v_cvt_pk_bf16_f32 v60, v52, v53
    v_cvt_pk_bf16_f32 v61, v54, v55
    buffer_store_dwordx2 v[60:61], v9, s[16:19], s39 offen
    s_branch ka_kernel_fin
ka_kernel_convw:
    s_add_u32 s37, s41, 294912
    s_add_u32 m0, s42, 73728
    s_nop 0
    buffer_load_dwordx4 v28, s[12:15], s37 offen offset:0 lds
    buffer_load_dwordx4 v29, s[12:15], s37 offen offset:1024 lds
    buffer_load_dwordx4 v30, s[12:15], s37 offen offset:2048 lds
    buffer_load_dwordx4 v31, s[12:15], s37 offen offset:3072 lds
    s_add_u32 m0, s42, 77824
    s_nop 0
    buffer_load_dwordx4 v32, s[12:15], s37 offen offset:0 lds
    buffer_load_dwordx4 v33, s[12:15], s37 offen offset:1024 lds
    buffer_load_dwordx4 v34, s[12:15], s37 offen offset:2048 lds
    buffer_load_dwordx4 v35, s[12:15], s37 offen offset:3072 lds
    s_add_u32 m0, s42, 81920
    s_nop 0
    buffer_load_dwordx4 v36, s[12:15], s37 offen offset:0 lds
    s_add_u32 s37, s41, 442368
    s_add_u32 m0, s42, 110592
    s_nop 0
    buffer_load_dwordx4 v28, s[12:15], s37 offen offset:0 lds
    buffer_load_dwordx4 v29, s[12:15], s37 offen offset:1024 lds
    buffer_load_dwordx4 v30, s[12:15], s37 offen offset:2048 lds
    buffer_load_dwordx4 v31, s[12:15], s37 offen offset:3072 lds
    s_add_u32 m0, s42, 114688
    s_nop 0
    buffer_load_dwordx4 v32, s[12:15], s37 offen offset:0 lds
    buffer_load_dwordx4 v33, s[12:15], s37 offen offset:1024 lds
    buffer_load_dwordx4 v34, s[12:15], s37 offen offset:2048 lds
    buffer_load_dwordx4 v35, s[12:15], s37 offen offset:3072 lds
    s_add_u32 m0, s42, 118784
    s_nop 0
    buffer_load_dwordx4 v36, s[12:15], s37 offen offset:0 lds
    s_waitcnt vmcnt(18)
    s_barrier
    s_waitcnt vmcnt(0)
    s_barrier
    s_add_u32 s37, s41, 0
    s_add_u32 m0, s42, 0
    s_nop 0
    buffer_load_dwordx4 v28, s[12:15], s37 offen offset:0 lds
    buffer_load_dwordx4 v29, s[12:15], s37 offen offset:1024 lds
    buffer_load_dwordx4 v30, s[12:15], s37 offen offset:2048 lds
    buffer_load_dwordx4 v31, s[12:15], s37 offen offset:3072 lds
    s_add_u32 m0, s42, 4096
    s_nop 0
    buffer_load_dwordx4 v32, s[12:15], s37 offen offset:0 lds
    buffer_load_dwordx4 v33, s[12:15], s37 offen offset:1024 lds
    buffer_load_dwordx4 v34, s[12:15], s37 offen offset:2048 lds
    buffer_load_dwordx4 v35, s[12:15], s37 offen offset:3072 lds
    s_add_u32 m0, s42, 8192
    s_nop 0
    buffer_load_dwordx4 v36, s[12:15], s37 offen offset:0 lds
    s_add_u32 s37, s41, 147456
    s_add_u32 m0, s42, 36864
    s_nop 0
    buffer_load_dwordx4 v28, s[12:15], s37 offen offset:0 lds
    buffer_load_dwordx4 v29, s[12:15], s37 offen offset:1024 lds
    buffer_load_dwordx4 v30, s[12:15], s37 offen offset:2048 lds
    buffer_load_dwordx4 v31, s[12:15], s37 offen offset:3072 lds
    s_add_u32 m0, s42, 40960
    s_nop 0
    buffer_load_dwordx4 v32, s[12:15], s37 offen offset:0 lds
    buffer_load_dwordx4 v33, s[12:15], s37 offen offset:1024 lds
    buffer_load_dwordx4 v34, s[12:15], s37 offen offset:2048 lds
    buffer_load_dwordx4 v35, s[12:15], s37 offen offset:3072 lds
    s_add_u32 m0, s42, 45056
    s_nop 0
    buffer_load_dwordx4 v36, s[12:15], s37 offen offset:0 lds
    v_mov_b32 v19, 155520
    v_mov_b32 v20, 0
    ds_write_b32 v19, v20
    s_waitcnt vmcnt(0) lgkmcnt(0)
    s_barrier
    s_cmp_eq_u32 s50, -1
    s_cbranch_scc1 ka_kernel_fin
    s_mov_b32 s37, 0
ka_kernel_ssp:
    buffer_load_dwordx4 v[60:63], v2, s[72:75], s52 offen sc1
    s_waitcnt vmcnt(0)
    v_xor_b32 v60, s69, v60
    v_xor_b32 v61, s69, v61
    v_xor_b32 v62, s69, v62
    v_xor_b32 v63, s69, v63
    v_or3_b32 v60, v60, v61, v62
    v_or_b32 v60, v60, v63
    v_cmp_ne_u32 vcc, 0, v60
    s_add_u32 s37, s37, 1
    s_cbranch_vccz ka_kernel_sok
    s_cmp_lt_u32 s37, 0x40000
    s_cbranch_scc1 ka_kernel_ssp
ka_kernel_sok:
    s_barrier
    s_load_dwordx4 s[24:27], s[0:1], 32
    s_load_dwordx2 s[4:5], s[0:1], 96
    s_lshl_b32 s40, s50, 2
    s_add_u32 s40, s40, s32
    s_mul_i32 s43, s32, 12928
    s_add_u32 s43, s43, 73728
    s_lshl_b32 s39, s40, 12
    s_add_u32 s44, s6, 58720256
    s_addc_u32 s45, s7, 0
    s_mov_b32 s8, s44
    s_and_b32 s9, s45, 0xffff
    s_mov_b32 s10, 2359296
    s_mov_b32 s11, 0x20000
    s_add_u32 s44, s6, 62914560
    s_addc_u32 s45, s7, 0
    s_mov_b32 s12, s44
    s_and_b32 s13, s45, 0xffff
    s_mov_b32 s14, 2359296
    s_mov_b32 s15, 0x20000
    s_mov_b32 m0, s43
    s_nop 0
    buffer_load_dwordx4 v2, s[8:11], s39 offen offset:0 sc1 lds
    buffer_load_dwordx4 v2, s[8:11], s39 offen offset:1024 sc1 lds
    buffer_load_dwordx4 v2, s[8:11], s39 offen offset:2048 sc1 lds
    buffer_load_dwordx4 v2, s[8:11], s39 offen offset:3072 sc1 lds
    s_waitcnt lgkmcnt(0)
    s_mov_b32 s16, s24
    s_and_b32 s17, s25, 0xffff
    s_mov_b32 s18, 2359296
    s_mov_b32 s19, 0x20000
    s_mov_b32 s20, s4
    s_and_b32 s21, s5, 0xffff
    s_mov_b32 s22, 4718592
    s_mov_b32 s23, 0x20000
    s_add_u32 m0, s43, 4640
    s_add_u32 s38, s39, 2
    buffer_load_dwordx4 v2, s[16:19], s39 offen offset:0 lds
    buffer_load_dwordx4 v2, s[16:19], s39 offen offset:1024 lds
    buffer_load_dwordx4 v2, s[16:19], s39 offen offset:2048 lds
    buffer_load_dwordx4 v2, s[16:19], s39 offen offset:3072 lds
    s_add_u32 m0, s43, 8800
    s_nop 0
    buffer_load_dwordx4 v2, s[16:19], s38 offen offset:0 lds
    buffer_load_dwordx4 v2, s[16:19], s38 offen offset:1024 lds
    buffer_load_dwordx4 v2, s[16:19], s38 offen offset:2048 lds
    buffer_load_dwordx4 v2, s[16:19], s38 offen offset:3072 lds
    s_add_u32 s24, s24, s39
    s_addc_u32 s25, s25, 0
    s_lshr_b32 s37, s40, 1
    s_lshl_b32 s37, s37, 2
    s_add_u32 s26, s26, s37
    s_addc_u32 s27, s27, 0
    s_load_dword s42, s[24:25], 0
    s_load_dword s41, s[26:27], 0
    v_and_b32 v4, 15, v1
    v_lshrrev_b32 v5, 4, v1
    v_lshl_add_u32 v16, v5, 3, v4
    v_add_u32 v16, 1, v16
    v_and_b32 v17, 1, v16
    v_and_b32 v16, 0xfe, v16
    v_lshlrev_b32 v16, 1, v16
    v_mul_u32_u24 v17, 4160, v17
    s_add_u32 s37, s43, 4608
    v_add3_u32 v8, v16, v17, s37
    v_add_u32 v9, 1024, v8
    v_add_u32 v10, 2048, v8
    v_add_u32 v11, 3072, v8
    v_lshlrev_b32 v17, 5, v4
    v_lshlrev_b32 v18, 4, v5
    v_sub_u32 v19, v18, v17
    s_add_u32 s38, s43, 480
    v_add_u32 v12, s38, v19
    v_lshlrev_b32 v18, 3, v5
    v_add_u32 v15, v17, v18
    s_add_u32 s38, s43, 504
    v_sub_u32 v13, s38, v15
    v_add_u32 v14, s37, v15
    buffer_load_dwordx2 v[224:225], v15, s[12:15], s39 offen offset:0 sc1
    buffer_load_dwordx2 v[226:227], v15, s[12:15], s39 offen offset:512 sc1
    buffer_load_dwordx2 v[228:229], v15, s[12:15], s39 offen offset:1024 sc1
    buffer_load_dwordx2 v[230:231], v15, s[12:15], s39 offen offset:1536 sc1
    buffer_load_dwordx2 v[232:233], v15, s[12:15], s39 offen offset:2048 sc1
    buffer_load_dwordx2 v[234:235], v15, s[12:15], s39 offen offset:2560 sc1
    buffer_load_dwordx2 v[236:237], v15, s[12:15], s39 offen offset:3072 sc1
    buffer_load_dwordx2 v[238:239], v15, s[12:15], s39 offen offset:3584 sc1
    v_mov_b32 v20, 0
    v_mov_b32 v21, 0
    v_mov_b32 v22, 0
    v_mov_b32 v23, 0
    v_and_b32 v16, 31, v1
    v_lshlrev_b32 v16, 4, v16
    v_add_u32 v16, s43, v16
    ds_write_b128 v16, v[20:23] offset:4096
    v_and_b32 v16, 7, v1
    v_cmp_eq_u32 vcc, 7, v16
    v_lshlrev_b32 v16, 2, v16
    v_add_u32 v16, s37, v16
    ds_write_b32 v16, v20
    s_waitcnt lgkmcnt(0)
    s_lshl_b32 s42, s42, 16
    v_mov_b32 v17, s42
    v_cndmask_b32 v17, v20, v17, vcc
    ds_write_b32 v16, v17 offset:4160
    s_lshl_b32 s37, s41, 16
    s_and_b32 s38, s41, 0xffff0000
    s_bitcmp0_b32 s40, 0
    s_cselect_b32 s41, s37, s38
    s_waitcnt vmcnt(8) lgkmcnt(0)
    ds_read2_b32 v[64:65], v8 offset0:0 offset1:1
    ds_read2_b32 v[66:67], v8 offset0:2 offset1:3
    ds_read_b128 v[96:99], v12 offset:3584
    ds_read2_b32 v[68:69], v8 offset0:128 offset1:129
    ds_read2_b32 v[70:71], v8 offset0:130 offset1:131
    ds_read_b128 v[100:103], v12 offset:3072
    ds_read2_b32 v[72:73], v9 offset0:0 offset1:1
    ds_read2_b32 v[74:75], v9 offset0:2 offset1:3
    ds_read_b128 v[104:107], v12 offset:2560
    ds_read2_b32 v[76:77], v9 offset0:128 offset1:129
    ds_read2_b32 v[78:79], v9 offset0:130 offset1:131
    ds_read_b128 v[108:111], v12 offset:2048
    ds_read2_b32 v[80:81], v10 offset0:0 offset1:1
    ds_read2_b32 v[82:83], v10 offset0:2 offset1:3
    ds_read_b128 v[112:115], v12 offset:1536
    ds_read2_b32 v[84:85], v10 offset0:128 offset1:129
    ds_read2_b32 v[86:87], v10 offset0:130 offset1:131
    ds_read_b128 v[116:119], v12 offset:1024
    ds_read2_b32 v[88:89], v11 offset0:0 offset1:1
    ds_read2_b32 v[90:91], v11 offset0:2 offset1:3
    ds_read_b128 v[120:123], v12 offset:512
    ds_read2_b32 v[92:93], v11 offset0:128 offset1:129
    ds_read2_b32 v[94:95], v11 offset0:130 offset1:131
    ds_read_b128 v[124:127], v12 offset:0
    s_waitcnt lgkmcnt(0)
    v_mfma_f32_16x16x32_bf16 v[192:195], v[64:67], v[96:99], 0
    ds_read2_b32 v[128:129], v8 offset0:16 offset1:17
    v_mfma_f32_16x16x32_bf16 v[196:199], v[64:67], v[100:103], 0
    ds_read2_b32 v[130:131], v8 offset0:18 offset1:19
    v_mfma_f32_16x16x32_bf16 v[196:199], v[68:71], v[96:99], v[196:199]
    ds_read_b128 v[160:163], v12 offset:3648
    v_mfma_f32_16x16x32_bf16 v[200:203], v[68:71], v[100:103], 0
    ds_read2_b32 v[132:133], v8 offset0:144 offset1:145
    v_mfma_f32_16x16x32_bf16 v[200:203], v[64:67], v[104:107], v[200:203]
    ds_read2_b32 v[134:135], v8 offset0:146 offset1:147
    v_mfma_f32_16x16x32_bf16 v[200:203], v[72:75], v[96:99], v[200:203]
    ds_read_b128 v[164:167], v12 offset:3136
    v_mfma_f32_16x16x32_bf16 v[204:207], v[68:71], v[104:107], 0
    ds_read2_b32 v[136:137], v9 offset0:16 offset1:17
    v_mfma_f32_16x16x32_bf16 v[204:207], v[72:75], v[100:103], v[204:207]
    ds_read2_b32 v[138:139], v9 offset0:18 offset1:19
    v_mfma_f32_16x16x32_bf16 v[208:211], v[72:75], v[104:107], 0
    ds_read_b128 v[168:171], v12 offset:2624
    v_mfma_f32_16x16x32_bf16 v[204:207], v[64:67], v[108:111], v[204:207]
    ds_read2_b32 v[140:141], v9 offset0:144 offset1:145
    v_mfma_f32_16x16x32_bf16 v[204:207], v[76:79], v[96:99], v[204:207]
    ds_read2_b32 v[142:143], v9 offset0:146 offset1:147
    v_mfma_f32_16x16x32_bf16 v[208:211], v[68:71], v[108:111], v[208:211]
    ds_read_b128 v[172:175], v12 offset:2112
    v_mfma_f32_16x16x32_bf16 v[208:211], v[76:79], v[100:103], v[208:211]
    ds_read2_b32 v[144:145], v10 offset0:16 offset1:17
    v_mfma_f32_16x16x32_bf16 v[212:215], v[72:75], v[108:111], 0
    ds_read2_b32 v[146:147], v10 offset0:18 offset1:19
    v_mfma_f32_16x16x32_bf16 v[212:215], v[76:79], v[104:107], v[212:215]
    ds_read_b128 v[176:179], v12 offset:1600
    v_mfma_f32_16x16x32_bf16 v[216:219], v[76:79], v[108:111], 0
    ds_read2_b32 v[148:149], v10 offset0:144 offset1:145
    v_mfma_f32_16x16x32_bf16 v[208:211], v[64:67], v[112:115], v[208:211]
    ds_read2_b32 v[150:151], v10 offset0:146 offset1:147
    v_mfma_f32_16x16x32_bf16 v[208:211], v[80:83], v[96:99], v[208:211]
    ds_read_b128 v[180:183], v12 offset:1088
    v_mfma_f32_16x16x32_bf16 v[212:215], v[68:71], v[112:115], v[212:215]
    ds_read2_b32 v[152:153], v11 offset0:16 offset1:17
    v_mfma_f32_16x16x32_bf16 v[212:215], v[80:83], v[100:103], v[212:215]
    ds_read2_b32 v[154:155], v11 offset0:18 offset1:19
    v_mfma_f32_16x16x32_bf16 v[216:219], v[72:75], v[112:115], v[216:219]
    ds_read_b128 v[184:187], v12 offset:576
    v_mfma_f32_16x16x32_bf16 v[216:219], v[80:83], v[104:107], v[216:219]
    ds_read2_b32 v[156:157], v11 offset0:144 offset1:145
    v_mfma_f32_16x16x32_bf16 v[220:223], v[76:79], v[112:115], 0
    ds_read2_b32 v[158:159], v11 offset0:146 offset1:147
    v_mfma_f32_16x16x32_bf16 v[220:223], v[80:83], v[108:111], v[220:223]
    ds_read_b128 v[188:191], v12 offset:64
    v_mfma_f32_16x16x32_bf16 v[212:215], v[64:67], v[116:119], v[212:215]
    v_mfma_f32_16x16x32_bf16 v[212:215], v[84:87], v[96:99], v[212:215]
    v_mfma_f32_16x16x32_bf16 v[216:219], v[68:71], v[116:119], v[216:219]
    v_mfma_f32_16x16x32_bf16 v[216:219], v[84:87], v[100:103], v[216:219]
    v_mfma_f32_16x16x32_bf16 v[220:223], v[72:75], v[116:119], v[220:223]
    v_mfma_f32_16x16x32_bf16 v[220:223], v[84:87], v[104:107], v[220:223]
    v_mfma_f32_16x16x32_bf16 v[216:219], v[64:67], v[120:123], v[216:219]
    v_mfma_f32_16x16x32_bf16 v[216:219], v[88:91], v[96:99], v[216:219]
    v_mfma_f32_16x16x32_bf16 v[220:223], v[68:71], v[120:123], v[220:223]
    v_mfma_f32_16x16x32_bf16 v[220:223], v[88:91], v[100:103], v[220:223]
    v_mfma_f32_16x16x32_bf16 v[220:223], v[64:67], v[124:127], v[220:223]
    v_mfma_f32_16x16x32_bf16 v[220:223], v[92:95], v[96:99], v[220:223]
    s_waitcnt lgkmcnt(0)
    v_mfma_f32_16x16x32_bf16 v[192:195], v[128:131], v[160:163], v[192:195]
    ds_read2_b32 v[64:65], v8 offset0:32 offset1:33
    v_mfma_f32_16x16x32_bf16 v[196:199], v[128:131], v[164:167], v[196:199]
    ds_read2_b32 v[66:67], v8 offset0:34 offset1:35
    v_mfma_f32_16x16x32_bf16 v[196:199], v[132:135], v[160:163], v[196:199]
    ds_read_b128 v[96:99], v12 offset:3712
    v_mfma_f32_16x16x32_bf16 v[200:203], v[132:135], v[164:167], v[200:203]
    ds_read2_b32 v[68:69], v8 offset0:160 offset1:161
    v_mfma_f32_16x16x32_bf16 v[200:203], v[128:131], v[168:171], v[200:203]
    ds_read2_b32 v[70:71], v8 offset0:162 offset1:163
    v_mfma_f32_16x16x32_bf16 v[200:203], v[136:139], v[160:163], v[200:203]
    ds_read_b128 v[100:103], v12 offset:3200
    v_mfma_f32_16x16x32_bf16 v[204:207], v[132:135], v[168:171], v[204:207]
    ds_read2_b32 v[72:73], v9 offset0:32 offset1:33
    v_mfma_f32_16x16x32_bf16 v[204:207], v[136:139], v[164:167], v[204:207]
    ds_read2_b32 v[74:75], v9 offset0:34 offset1:35
    v_mfma_f32_16x16x32_bf16 v[208:211], v[136:139], v[168:171], v[208:211]
    ds_read_b128 v[104:107], v12 offset:2688
    v_mfma_f32_16x16x32_bf16 v[204:207], v[128:131], v[172:175], v[204:207]
    ds_read2_b32 v[76:77], v9 offset0:160 offset1:161
    v_mfma_f32_16x16x32_bf16 v[204:207], v[140:143], v[160:163], v[204:207]
    ds_read2_b32 v[78:79], v9 offset0:162 offset1:163
    v_mfma_f32_16x16x32_bf16 v[208:211], v[132:135], v[172:175], v[208:211]
    ds_read_b128 v[108:111], v12 offset:2176
    v_mfma_f32_16x16x32_bf16 v[208:211], v[140:143], v[164:167], v[208:211]
    ds_read2_b32 v[80:81], v10 offset0:32 offset1:33
    v_mfma_f32_16x16x32_bf16 v[212:215], v[136:139], v[172:175], v[212:215]
    ds_read2_b32 v[82:83], v10 offset0:34 offset1:35
    v_mfma_f32_16x16x32_bf16 v[212:215], v[140:143], v[168:171], v[212:215]
    ds_read_b128 v[112:115], v12 offset:1664
    v_mfma_f32_16x16x32_bf16 v[216:219], v[140:143], v[172:175], v[216:219]
    ds_read2_b32 v[84:85], v10 offset0:160 offset1:161
    v_mfma_f32_16x16x32_bf16 v[208:211], v[128:131], v[176:179], v[208:211]
    ds_read2_b32 v[86:87], v10 offset0:162 offset1:163
    v_mfma_f32_16x16x32_bf16 v[208:211], v[144:147], v[160:163], v[208:211]
    ds_read_b128 v[116:119], v12 offset:1152
    v_mfma_f32_16x16x32_bf16 v[212:215], v[132:135], v[176:179], v[212:215]
    ds_read2_b32 v[88:89], v11 offset0:32 offset1:33
    v_mfma_f32_16x16x32_bf16 v[212:215], v[144:147], v[164:167], v[212:215]
    ds_read2_b32 v[90:91], v11 offset0:34 offset1:35
    v_mfma_f32_16x16x32_bf16 v[216:219], v[136:139], v[176:179], v[216:219]
    ds_read_b128 v[120:123], v12 offset:640
    v_mfma_f32_16x16x32_bf16 v[216:219], v[144:147], v[168:171], v[216:219]
    ds_read2_b32 v[92:93], v11 offset0:160 offset1:161
    v_mfma_f32_16x16x32_bf16 v[220:223], v[140:143], v[176:179], v[220:223]
    ds_read2_b32 v[94:95], v11 offset0:162 offset1:163
    v_mfma_f32_16x16x32_bf16 v[220:223], v[144:147], v[172:175], v[220:223]
    ds_read_b128 v[124:127], v12 offset:128
    v_mfma_f32_16x16x32_bf16 v[212:215], v[128:131], v[180:183], v[212:215]
    v_mfma_f32_16x16x32_bf16 v[212:215], v[148:151], v[160:163], v[212:215]
    v_mfma_f32_16x16x32_bf16 v[216:219], v[132:135], v[180:183], v[216:219]
    v_mfma_f32_16x16x32_bf16 v[216:219], v[148:151], v[164:167], v[216:219]
    v_mfma_f32_16x16x32_bf16 v[220:223], v[136:139], v[180:183], v[220:223]
    v_mfma_f32_16x16x32_bf16 v[220:223], v[148:151], v[168:171], v[220:223]
    v_mfma_f32_16x16x32_bf16 v[216:219], v[128:131], v[184:187], v[216:219]
    v_mfma_f32_16x16x32_bf16 v[216:219], v[152:155], v[160:163], v[216:219]
    v_mfma_f32_16x16x32_bf16 v[220:223], v[132:135], v[184:187], v[220:223]
    v_mfma_f32_16x16x32_bf16 v[220:223], v[152:155], v[164:167], v[220:223]
    v_mfma_f32_16x16x32_bf16 v[220:223], v[128:131], v[188:191], v[220:223]
    v_mfma_f32_16x16x32_bf16 v[220:223], v[156:159], v[160:163], v[220:223]
    s_waitcnt lgkmcnt(0)
    v_mfma_f32_16x16x32_bf16 v[192:195], v[64:67], v[96:99], v[192:195]
    ds_read2_b32 v[128:129], v8 offset0:48 offset1:49
    v_mfma_f32_16x16x32_bf16 v[196:199], v[64:67], v[100:103], v[196:199]
    ds_read2_b32 v[130:131], v8 offset0:50 offset1:51
    v_mfma_f32_16x16x32_bf16 v[196:199], v[68:71], v[96:99], v[196:199]
    ds_read_b128 v[160:163], v12 offset:3776
    v_mfma_f32_16x16x32_bf16 v[200:203], v[68:71], v[100:103], v[200:203]
    ds_read2_b32 v[132:133], v8 offset0:176 offset1:177
    v_mfma_f32_16x16x32_bf16 v[200:203], v[64:67], v[104:107], v[200:203]
    ds_read2_b32 v[134:135], v8 offset0:178 offset1:179
    v_mfma_f32_16x16x32_bf16 v[200:203], v[72:75], v[96:99], v[200:203]
    ds_read_b128 v[164:167], v12 offset:3264
    v_mfma_f32_16x16x32_bf16 v[204:207], v[68:71], v[104:107], v[204:207]
    ds_read2_b32 v[136:137], v9 offset0:48 offset1:49
    v_mfma_f32_16x16x32_bf16 v[204:207], v[72:75], v[100:103], v[204:207]
    ds_read2_b32 v[138:139], v9 offset0:50 offset1:51
    v_mfma_f32_16x16x32_bf16 v[208:211], v[72:75], v[104:107], v[208:211]
    ds_read_b128 v[168:171], v12 offset:2752
    v_mfma_f32_16x16x32_bf16 v[204:207], v[64:67], v[108:111], v[204:207]
    ds_read2_b32 v[140:141], v9 offset0:176 offset1:177
    v_mfma_f32_16x16x32_bf16 v[204:207], v[76:79], v[96:99], v[204:207]
    ds_read2_b32 v[142:143], v9 offset0:178 offset1:179
    v_mfma_f32_16x16x32_bf16 v[208:211], v[68:71], v[108:111], v[208:211]
    ds_read_b128 v[172:175], v12 offset:2240
    v_mfma_f32_16x16x32_bf16 v[208:211], v[76:79], v[100:103], v[208:211]
    ds_read2_b32 v[144:145], v10 offset0:48 offset1:49
    v_mfma_f32_16x16x32_bf16 v[212:215], v[72:75], v[108:111], v[212:215]
    ds_read2_b32 v[146:147], v10 offset0:50 offset1:51
    v_mfma_f32_16x16x32_bf16 v[212:215], v[76:79], v[104:107], v[212:215]
    ds_read_b128 v[176:179], v12 offset:1728
    v_mfma_f32_16x16x32_bf16 v[216:219], v[76:79], v[108:111], v[216:219]
    ds_read2_b32 v[148:149], v10 offset0:176 offset1:177
    v_mfma_f32_16x16x32_bf16 v[208:211], v[64:67], v[112:115], v[208:211]
    ds_read2_b32 v[150:151], v10 offset0:178 offset1:179
    v_mfma_f32_16x16x32_bf16 v[208:211], v[80:83], v[96:99], v[208:211]
    ds_read_b128 v[180:183], v12 offset:1216
    v_mfma_f32_16x16x32_bf16 v[212:215], v[68:71], v[112:115], v[212:215]
    ds_read2_b32 v[152:153], v11 offset0:48 offset1:49
    v_mfma_f32_16x16x32_bf16 v[212:215], v[80:83], v[100:103], v[212:215]
    ds_read2_b32 v[154:155], v11 offset0:50 offset1:51
    v_mfma_f32_16x16x32_bf16 v[216:219], v[72:75], v[112:115], v[216:219]
    ds_read_b128 v[184:187], v12 offset:704
    v_mfma_f32_16x16x32_bf16 v[216:219], v[80:83], v[104:107], v[216:219]
    ds_read2_b32 v[156:157], v11 offset0:176 offset1:177
    v_mfma_f32_16x16x32_bf16 v[220:223], v[76:79], v[112:115], v[220:223]
    ds_read2_b32 v[158:159], v11 offset0:178 offset1:179
    v_mfma_f32_16x16x32_bf16 v[220:223], v[80:83], v[108:111], v[220:223]
    ds_read_b128 v[188:191], v12 offset:192
    v_mfma_f32_16x16x32_bf16 v[212:215], v[64:67], v[116:119], v[212:215]
    v_mfma_f32_16x16x32_bf16 v[212:215], v[84:87], v[96:99], v[212:215]
    v_mfma_f32_16x16x32_bf16 v[216:219], v[68:71], v[116:119], v[216:219]
    v_mfma_f32_16x16x32_bf16 v[216:219], v[84:87], v[100:103], v[216:219]
    v_mfma_f32_16x16x32_bf16 v[220:223], v[72:75], v[116:119], v[220:223]
    v_mfma_f32_16x16x32_bf16 v[220:223], v[84:87], v[104:107], v[220:223]
    v_mfma_f32_16x16x32_bf16 v[216:219], v[64:67], v[120:123], v[216:219]
    v_mfma_f32_16x16x32_bf16 v[216:219], v[88:91], v[96:99], v[216:219]
    v_mfma_f32_16x16x32_bf16 v[220:223], v[68:71], v[120:123], v[220:223]
    v_mfma_f32_16x16x32_bf16 v[220:223], v[88:91], v[100:103], v[220:223]
    v_mfma_f32_16x16x32_bf16 v[220:223], v[64:67], v[124:127], v[220:223]
    v_mfma_f32_16x16x32_bf16 v[220:223], v[92:95], v[96:99], v[220:223]
    s_waitcnt lgkmcnt(0)
    v_mfma_f32_16x16x32_bf16 v[192:195], v[128:131], v[160:163], v[192:195]
    ds_read2_b32 v[64:65], v8 offset0:64 offset1:65
    v_mfma_f32_16x16x32_bf16 v[196:199], v[128:131], v[164:167], v[196:199]
    ds_read2_b32 v[66:67], v8 offset0:66 offset1:67
    v_mfma_f32_16x16x32_bf16 v[196:199], v[132:135], v[160:163], v[196:199]
    ds_read_b128 v[96:99], v12 offset:3840
    v_mfma_f32_16x16x32_bf16 v[200:203], v[132:135], v[164:167], v[200:203]
    ds_read2_b32 v[68:69], v8 offset0:192 offset1:193
    v_mfma_f32_16x16x32_bf16 v[200:203], v[128:131], v[168:171], v[200:203]
    ds_read2_b32 v[70:71], v8 offset0:194 offset1:195
    v_mfma_f32_16x16x32_bf16 v[200:203], v[136:139], v[160:163], v[200:203]
    ds_read_b128 v[100:103], v12 offset:3328
    v_mfma_f32_16x16x32_bf16 v[204:207], v[132:135], v[168:171], v[204:207]
    ds_read2_b32 v[72:73], v9 offset0:64 offset1:65
    v_mfma_f32_16x16x32_bf16 v[204:207], v[136:139], v[164:167], v[204:207]
    ds_read2_b32 v[74:75], v9 offset0:66 offset1:67
    v_mfma_f32_16x16x32_bf16 v[208:211], v[136:139], v[168:171], v[208:211]
    ds_read_b128 v[104:107], v12 offset:2816
    v_mfma_f32_16x16x32_bf16 v[204:207], v[128:131], v[172:175], v[204:207]
    ds_read2_b32 v[76:77], v9 offset0:192 offset1:193
    v_mfma_f32_16x16x32_bf16 v[204:207], v[140:143], v[160:163], v[204:207]
    ds_read2_b32 v[78:79], v9 offset0:194 offset1:195
    v_mfma_f32_16x16x32_bf16 v[208:211], v[132:135], v[172:175], v[208:211]
    ds_read_b128 v[108:111], v12 offset:2304
    v_mfma_f32_16x16x32_bf16 v[208:211], v[140:143], v[164:167], v[208:211]
    ds_read2_b32 v[80:81], v10 offset0:64 offset1:65
    v_mfma_f32_16x16x32_bf16 v[212:215], v[136:139], v[172:175], v[212:215]
    ds_read2_b32 v[82:83], v10 offset0:66 offset1:67
    v_mfma_f32_16x16x32_bf16 v[212:215], v[140:143], v[168:171], v[212:215]
    ds_read_b128 v[112:115], v12 offset:1792
    v_mfma_f32_16x16x32_bf16 v[216:219], v[140:143], v[172:175], v[216:219]
    ds_read2_b32 v[84:85], v10 offset0:192 offset1:193
    v_mfma_f32_16x16x32_bf16 v[208:211], v[128:131], v[176:179], v[208:211]
    ds_read2_b32 v[86:87], v10 offset0:194 offset1:195
    v_mfma_f32_16x16x32_bf16 v[208:211], v[144:147], v[160:163], v[208:211]
    ds_read_b128 v[116:119], v12 offset:1280
    v_mfma_f32_16x16x32_bf16 v[212:215], v[132:135], v[176:179], v[212:215]
    ds_read2_b32 v[88:89], v11 offset0:64 offset1:65
    v_mfma_f32_16x16x32_bf16 v[212:215], v[144:147], v[164:167], v[212:215]
    ds_read2_b32 v[90:91], v11 offset0:66 offset1:67
    v_mfma_f32_16x16x32_bf16 v[216:219], v[136:139], v[176:179], v[216:219]
    ds_read_b128 v[120:123], v12 offset:768
    v_mfma_f32_16x16x32_bf16 v[216:219], v[144:147], v[168:171], v[216:219]
    ds_read2_b32 v[92:93], v11 offset0:192 offset1:193
    v_mfma_f32_16x16x32_bf16 v[220:223], v[140:143], v[176:179], v[220:223]
    ds_read2_b32 v[94:95], v11 offset0:194 offset1:195
    v_mfma_f32_16x16x32_bf16 v[220:223], v[144:147], v[172:175], v[220:223]
    ds_read_b128 v[124:127], v12 offset:256
    v_mfma_f32_16x16x32_bf16 v[212:215], v[128:131], v[180:183], v[212:215]
    v_mfma_f32_16x16x32_bf16 v[212:215], v[148:151], v[160:163], v[212:215]
    v_mfma_f32_16x16x32_bf16 v[216:219], v[132:135], v[180:183], v[216:219]
    v_mfma_f32_16x16x32_bf16 v[216:219], v[148:151], v[164:167], v[216:219]
    v_mfma_f32_16x16x32_bf16 v[220:223], v[136:139], v[180:183], v[220:223]
    v_mfma_f32_16x16x32_bf16 v[220:223], v[148:151], v[168:171], v[220:223]
    v_mfma_f32_16x16x32_bf16 v[216:219], v[128:131], v[184:187], v[216:219]
    v_mfma_f32_16x16x32_bf16 v[216:219], v[152:155], v[160:163], v[216:219]
    v_mfma_f32_16x16x32_bf16 v[220:223], v[132:135], v[184:187], v[220:223]
    v_mfma_f32_16x16x32_bf16 v[220:223], v[152:155], v[164:167], v[220:223]
    v_mfma_f32_16x16x32_bf16 v[220:223], v[128:131], v[188:191], v[220:223]
    v_mfma_f32_16x16x32_bf16 v[220:223], v[156:159], v[160:163], v[220:223]
    s_waitcnt lgkmcnt(0)
    v_mfma_f32_16x16x32_bf16 v[192:195], v[64:67], v[96:99], v[192:195]
    ds_read2_b32 v[128:129], v8 offset0:80 offset1:81
    v_mfma_f32_16x16x32_bf16 v[196:199], v[64:67], v[100:103], v[196:199]
    ds_read2_b32 v[130:131], v8 offset0:82 offset1:83
    v_mfma_f32_16x16x32_bf16 v[196:199], v[68:71], v[96:99], v[196:199]
    ds_read_b128 v[160:163], v12 offset:3904
    v_mfma_f32_16x16x32_bf16 v[200:203], v[68:71], v[100:103], v[200:203]
    ds_read2_b32 v[132:133], v8 offset0:208 offset1:209
    v_mfma_f32_16x16x32_bf16 v[200:203], v[64:67], v[104:107], v[200:203]
    ds_read2_b32 v[134:135], v8 offset0:210 offset1:211
    v_mfma_f32_16x16x32_bf16 v[200:203], v[72:75], v[96:99], v[200:203]
    ds_read_b128 v[164:167], v12 offset:3392
    v_mfma_f32_16x16x32_bf16 v[204:207], v[68:71], v[104:107], v[204:207]
    ds_read2_b32 v[136:137], v9 offset0:80 offset1:81
    v_mfma_f32_16x16x32_bf16 v[204:207], v[72:75], v[100:103], v[204:207]
    ds_read2_b32 v[138:139], v9 offset0:82 offset1:83
    v_mfma_f32_16x16x32_bf16 v[208:211], v[72:75], v[104:107], v[208:211]
    ds_read_b128 v[168:171], v12 offset:2880
    v_mfma_f32_16x16x32_bf16 v[204:207], v[64:67], v[108:111], v[204:207]
    ds_read2_b32 v[140:141], v9 offset0:208 offset1:209
    v_mfma_f32_16x16x32_bf16 v[204:207], v[76:79], v[96:99], v[204:207]
    ds_read2_b32 v[142:143], v9 offset0:210 offset1:211
    v_mfma_f32_16x16x32_bf16 v[208:211], v[68:71], v[108:111], v[208:211]
    ds_read_b128 v[172:175], v12 offset:2368
    v_mfma_f32_16x16x32_bf16 v[208:211], v[76:79], v[100:103], v[208:211]
    ds_read2_b32 v[144:145], v10 offset0:80 offset1:81
    v_mfma_f32_16x16x32_bf16 v[212:215], v[72:75], v[108:111], v[212:215]
    ds_read2_b32 v[146:147], v10 offset0:82 offset1:83
    v_mfma_f32_16x16x32_bf16 v[212:215], v[76:79], v[104:107], v[212:215]
    ds_read_b128 v[176:179], v12 offset:1856
    v_mfma_f32_16x16x32_bf16 v[216:219], v[76:79], v[108:111], v[216:219]
    ds_read2_b32 v[148:149], v10 offset0:208 offset1:209
    v_mfma_f32_16x16x32_bf16 v[208:211], v[64:67], v[112:115], v[208:211]
    ds_read2_b32 v[150:151], v10 offset0:210 offset1:211
    v_mfma_f32_16x16x32_bf16 v[208:211], v[80:83], v[96:99], v[208:211]
    ds_read_b128 v[180:183], v12 offset:1344
    v_mfma_f32_16x16x32_bf16 v[212:215], v[68:71], v[112:115], v[212:215]
    ds_read2_b32 v[152:153], v11 offset0:80 offset1:81
    v_mfma_f32_16x16x32_bf16 v[212:215], v[80:83], v[100:103], v[212:215]
    ds_read2_b32 v[154:155], v11 offset0:82 offset1:83
    v_mfma_f32_16x16x32_bf16 v[216:219], v[72:75], v[112:115], v[216:219]
    ds_read_b128 v[184:187], v12 offset:832
    v_mfma_f32_16x16x32_bf16 v[216:219], v[80:83], v[104:107], v[216:219]
    ds_read2_b32 v[156:157], v11 offset0:208 offset1:209
    v_mfma_f32_16x16x32_bf16 v[220:223], v[76:79], v[112:115], v[220:223]
    ds_read2_b32 v[158:159], v11 offset0:210 offset1:211
    v_mfma_f32_16x16x32_bf16 v[220:223], v[80:83], v[108:111], v[220:223]
    ds_read_b128 v[188:191], v12 offset:320
    v_mfma_f32_16x16x32_bf16 v[212:215], v[64:67], v[116:119], v[212:215]
    v_mfma_f32_16x16x32_bf16 v[212:215], v[84:87], v[96:99], v[212:215]
    v_mfma_f32_16x16x32_bf16 v[216:219], v[68:71], v[116:119], v[216:219]
    v_mfma_f32_16x16x32_bf16 v[216:219], v[84:87], v[100:103], v[216:219]
    v_mfma_f32_16x16x32_bf16 v[220:223], v[72:75], v[116:119], v[220:223]
    v_mfma_f32_16x16x32_bf16 v[220:223], v[84:87], v[104:107], v[220:223]
    v_mfma_f32_16x16x32_bf16 v[216:219], v[64:67], v[120:123], v[216:219]
    v_mfma_f32_16x16x32_bf16 v[216:219], v[88:91], v[96:99], v[216:219]
    v_mfma_f32_16x16x32_bf16 v[220:223], v[68:71], v[120:123], v[220:223]
    v_mfma_f32_16x16x32_bf16 v[220:223], v[88:91], v[100:103], v[220:223]
    v_mfma_f32_16x16x32_bf16 v[220:223], v[64:67], v[124:127], v[220:223]
    v_mfma_f32_16x16x32_bf16 v[220:223], v[92:95], v[96:99], v[220:223]
    s_waitcnt lgkmcnt(0)
    v_mfma_f32_16x16x32_bf16 v[192:195], v[128:131], v[160:163], v[192:195]
    ds_read2_b32 v[64:65], v8 offset0:96 offset1:97
    v_mfma_f32_16x16x32_bf16 v[196:199], v[128:131], v[164:167], v[196:199]
    ds_read2_b32 v[66:67], v8 offset0:98 offset1:99
    v_mfma_f32_16x16x32_bf16 v[196:199], v[132:135], v[160:163], v[196:199]
    ds_read_b128 v[96:99], v12 offset:3968
    v_mfma_f32_16x16x32_bf16 v[200:203], v[132:135], v[164:167], v[200:203]
    ds_read2_b32 v[68:69], v8 offset0:224 offset1:225
    v_mfma_f32_16x16x32_bf16 v[200:203], v[128:131], v[168:171], v[200:203]
    ds_read2_b32 v[70:71], v8 offset0:226 offset1:227
    v_mfma_f32_16x16x32_bf16 v[200:203], v[136:139], v[160:163], v[200:203]
    ds_read_b128 v[100:103], v12 offset:3456
    v_mfma_f32_16x16x32_bf16 v[204:207], v[132:135], v[168:171], v[204:207]
    ds_read2_b32 v[72:73], v9 offset0:96 offset1:97
    v_mfma_f32_16x16x32_bf16 v[204:207], v[136:139], v[164:167], v[204:207]
    ds_read2_b32 v[74:75], v9 offset0:98 offset1:99
    v_mfma_f32_16x16x32_bf16 v[208:211], v[136:139], v[168:171], v[208:211]
    ds_read_b128 v[104:107], v12 offset:2944
    v_mfma_f32_16x16x32_bf16 v[204:207], v[128:131], v[172:175], v[204:207]
    ds_read2_b32 v[76:77], v9 offset0:224 offset1:225
    v_mfma_f32_16x16x32_bf16 v[204:207], v[140:143], v[160:163], v[204:207]
    ds_read2_b32 v[78:79], v9 offset0:226 offset1:227
    v_mfma_f32_16x16x32_bf16 v[208:211], v[132:135], v[172:175], v[208:211]
    ds_read_b128 v[108:111], v12 offset:2432
    v_mfma_f32_16x16x32_bf16 v[208:211], v[140:143], v[164:167], v[208:211]
    ds_read2_b32 v[80:81], v10 offset0:96 offset1:97
    v_mfma_f32_16x16x32_bf16 v[212:215], v[136:139], v[172:175], v[212:215]
    ds_read2_b32 v[82:83], v10 offset0:98 offset1:99
    v_mfma_f32_16x16x32_bf16 v[212:215], v[140:143], v[168:171], v[212:215]
    ds_read_b128 v[112:115], v12 offset:1920
    v_mfma_f32_16x16x32_bf16 v[216:219], v[140:143], v[172:175], v[216:219]
    ds_read2_b32 v[84:85], v10 offset0:224 offset1:225
    v_mfma_f32_16x16x32_bf16 v[208:211], v[128:131], v[176:179], v[208:211]
    ds_read2_b32 v[86:87], v10 offset0:226 offset1:227
    v_mfma_f32_16x16x32_bf16 v[208:211], v[144:147], v[160:163], v[208:211]
    ds_read_b128 v[116:119], v12 offset:1408
    v_mfma_f32_16x16x32_bf16 v[212:215], v[132:135], v[176:179], v[212:215]
    ds_read2_b32 v[88:89], v11 offset0:96 offset1:97
    v_mfma_f32_16x16x32_bf16 v[212:215], v[144:147], v[164:167], v[212:215]
    ds_read2_b32 v[90:91], v11 offset0:98 offset1:99
    v_mfma_f32_16x16x32_bf16 v[216:219], v[136:139], v[176:179], v[216:219]
    ds_read_b128 v[120:123], v12 offset:896
    v_mfma_f32_16x16x32_bf16 v[216:219], v[144:147], v[168:171], v[216:219]
    ds_read2_b32 v[92:93], v11 offset0:224 offset1:225
    v_mfma_f32_16x16x32_bf16 v[220:223], v[140:143], v[176:179], v[220:223]
    ds_read2_b32 v[94:95], v11 offset0:226 offset1:227
    v_mfma_f32_16x16x32_bf16 v[220:223], v[144:147], v[172:175], v[220:223]
    ds_read_b128 v[124:127], v12 offset:384
    v_mfma_f32_16x16x32_bf16 v[212:215], v[128:131], v[180:183], v[212:215]
    v_mfma_f32_16x16x32_bf16 v[212:215], v[148:151], v[160:163], v[212:215]
    v_mfma_f32_16x16x32_bf16 v[216:219], v[132:135], v[180:183], v[216:219]
    v_mfma_f32_16x16x32_bf16 v[216:219], v[148:151], v[164:167], v[216:219]
    v_mfma_f32_16x16x32_bf16 v[220:223], v[136:139], v[180:183], v[220:223]
    v_mfma_f32_16x16x32_bf16 v[220:223], v[148:151], v[168:171], v[220:223]
    v_mfma_f32_16x16x32_bf16 v[216:219], v[128:131], v[184:187], v[216:219]
    v_mfma_f32_16x16x32_bf16 v[216:219], v[152:155], v[160:163], v[216:219]
    v_mfma_f32_16x16x32_bf16 v[220:223], v[132:135], v[184:187], v[220:223]
    v_mfma_f32_16x16x32_bf16 v[220:223], v[152:155], v[164:167], v[220:223]
    v_mfma_f32_16x16x32_bf16 v[220:223], v[128:131], v[188:191], v[220:223]
    v_mfma_f32_16x16x32_bf16 v[220:223], v[156:159], v[160:163], v[220:223]
    s_waitcnt lgkmcnt(0)
    v_mfma_f32_16x16x32_bf16 v[192:195], v[64:67], v[96:99], v[192:195]
    ds_read2_b32 v[128:129], v8 offset0:112 offset1:113
    v_mfma_f32_16x16x32_bf16 v[196:199], v[64:67], v[100:103], v[196:199]
    ds_read2_b32 v[130:131], v8 offset0:114 offset1:115
    v_mfma_f32_16x16x32_bf16 v[196:199], v[68:71], v[96:99], v[196:199]
    ds_read_b128 v[160:163], v12 offset:4032
    v_mfma_f32_16x16x32_bf16 v[200:203], v[68:71], v[100:103], v[200:203]
    ds_read2_b32 v[132:133], v8 offset0:240 offset1:241
    v_mfma_f32_16x16x32_bf16 v[200:203], v[64:67], v[104:107], v[200:203]
    ds_read2_b32 v[134:135], v8 offset0:242 offset1:243
    v_mfma_f32_16x16x32_bf16 v[200:203], v[72:75], v[96:99], v[200:203]
    ds_read_b128 v[164:167], v12 offset:3520
    v_mfma_f32_16x16x32_bf16 v[204:207], v[68:71], v[104:107], v[204:207]
    ds_read2_b32 v[136:137], v9 offset0:112 offset1:113
    v_mfma_f32_16x16x32_bf16 v[204:207], v[72:75], v[100:103], v[204:207]
    ds_read2_b32 v[138:139], v9 offset0:114 offset1:115
    v_mfma_f32_16x16x32_bf16 v[208:211], v[72:75], v[104:107], v[208:211]
    ds_read_b128 v[168:171], v12 offset:3008
    v_mfma_f32_16x16x32_bf16 v[204:207], v[64:67], v[108:111], v[204:207]
    ds_read2_b32 v[140:141], v9 offset0:240 offset1:241
    v_mfma_f32_16x16x32_bf16 v[204:207], v[76:79], v[96:99], v[204:207]
    ds_read2_b32 v[142:143], v9 offset0:242 offset1:243
    v_mfma_f32_16x16x32_bf16 v[208:211], v[68:71], v[108:111], v[208:211]
    ds_read_b128 v[172:175], v12 offset:2496
    v_mfma_f32_16x16x32_bf16 v[208:211], v[76:79], v[100:103], v[208:211]
    ds_read2_b32 v[144:145], v10 offset0:112 offset1:113
    v_mfma_f32_16x16x32_bf16 v[212:215], v[72:75], v[108:111], v[212:215]
    ds_read2_b32 v[146:147], v10 offset0:114 offset1:115
    v_mfma_f32_16x16x32_bf16 v[212:215], v[76:79], v[104:107], v[212:215]
    ds_read_b128 v[176:179], v12 offset:1984
    v_mfma_f32_16x16x32_bf16 v[216:219], v[76:79], v[108:111], v[216:219]
    ds_read2_b32 v[148:149], v10 offset0:240 offset1:241
    v_mfma_f32_16x16x32_bf16 v[208:211], v[64:67], v[112:115], v[208:211]
    ds_read2_b32 v[150:151], v10 offset0:242 offset1:243
    v_mfma_f32_16x16x32_bf16 v[208:211], v[80:83], v[96:99], v[208:211]
    ds_read_b128 v[180:183], v12 offset:1472
    v_mfma_f32_16x16x32_bf16 v[212:215], v[68:71], v[112:115], v[212:215]
    ds_read2_b32 v[152:153], v11 offset0:112 offset1:113
    v_mfma_f32_16x16x32_bf16 v[212:215], v[80:83], v[100:103], v[212:215]
    ds_read2_b32 v[154:155], v11 offset0:114 offset1:115
    v_mfma_f32_16x16x32_bf16 v[216:219], v[72:75], v[112:115], v[216:219]
    ds_read_b128 v[184:187], v12 offset:960
    v_mfma_f32_16x16x32_bf16 v[216:219], v[80:83], v[104:107], v[216:219]
    ds_read2_b32 v[156:157], v11 offset0:240 offset1:241
    v_mfma_f32_16x16x32_bf16 v[220:223], v[76:79], v[112:115], v[220:223]
    ds_read2_b32 v[158:159], v11 offset0:242 offset1:243
    v_mfma_f32_16x16x32_bf16 v[220:223], v[80:83], v[108:111], v[220:223]
    ds_read_b128 v[188:191], v12 offset:448
    v_mfma_f32_16x16x32_bf16 v[212:215], v[64:67], v[116:119], v[212:215]
    v_mfma_f32_16x16x32_bf16 v[212:215], v[84:87], v[96:99], v[212:215]
    v_mfma_f32_16x16x32_bf16 v[216:219], v[68:71], v[116:119], v[216:219]
    v_mfma_f32_16x16x32_bf16 v[216:219], v[84:87], v[100:103], v[216:219]
    v_mfma_f32_16x16x32_bf16 v[220:223], v[72:75], v[116:119], v[220:223]
    v_mfma_f32_16x16x32_bf16 v[220:223], v[84:87], v[104:107], v[220:223]
    v_mfma_f32_16x16x32_bf16 v[216:219], v[64:67], v[120:123], v[216:219]
    v_mfma_f32_16x16x32_bf16 v[216:219], v[88:91], v[96:99], v[216:219]
    v_mfma_f32_16x16x32_bf16 v[220:223], v[68:71], v[120:123], v[220:223]
    v_mfma_f32_16x16x32_bf16 v[220:223], v[88:91], v[100:103], v[220:223]
    v_mfma_f32_16x16x32_bf16 v[220:223], v[64:67], v[124:127], v[220:223]
    v_mfma_f32_16x16x32_bf16 v[220:223], v[92:95], v[96:99], v[220:223]
    s_waitcnt lgkmcnt(0)
    v_mfma_f32_16x16x32_bf16 v[192:195], v[128:131], v[160:163], v[192:195]
    ds_read_b64 v[240:241], v13 offset:3584
    v_mfma_f32_16x16x32_bf16 v[196:199], v[128:131], v[164:167], v[196:199]
    ds_read_b64 v[242:243], v13 offset:3072
    v_mfma_f32_16x16x32_bf16 v[196:199], v[132:135], v[160:163], v[196:199]
    ds_read_b64 v[244:245], v13 offset:2560
    v_mfma_f32_16x16x32_bf16 v[200:203], v[132:135], v[164:167], v[200:203]
    ds_read_b64 v[246:247], v13 offset:2048
    v_mfma_f32_16x16x32_bf16 v[200:203], v[128:131], v[168:171], v[200:203]
    ds_read_b64 v[248:249], v13 offset:1536
    v_mfma_f32_16x16x32_bf16 v[200:203], v[136:139], v[160:163], v[200:203]
    ds_read_b64 v[250:251], v13 offset:1024
    v_mfma_f32_16x16x32_bf16 v[204:207], v[132:135], v[168:171], v[204:207]
    ds_read_b64 v[252:253], v13 offset:512
    v_mfma_f32_16x16x32_bf16 v[204:207], v[136:139], v[164:167], v[204:207]
    ds_read_b64 v[254:255], v13 offset:0
    v_mfma_f32_16x16x32_bf16 v[208:211], v[136:139], v[168:171], v[208:211]
    v_mfma_f32_16x16x32_bf16 v[204:207], v[128:131], v[172:175], v[204:207]
    v_mfma_f32_16x16x32_bf16 v[204:207], v[140:143], v[160:163], v[204:207]
    v_mfma_f32_16x16x32_bf16 v[208:211], v[132:135], v[172:175], v[208:211]
    v_mfma_f32_16x16x32_bf16 v[208:211], v[140:143], v[164:167], v[208:211]
    v_mfma_f32_16x16x32_bf16 v[212:215], v[136:139], v[172:175], v[212:215]
    v_mfma_f32_16x16x32_bf16 v[212:215], v[140:143], v[168:171], v[212:215]
    v_mfma_f32_16x16x32_bf16 v[216:219], v[140:143], v[172:175], v[216:219]
    v_mfma_f32_16x16x32_bf16 v[208:211], v[128:131], v[176:179], v[208:211]
    v_mfma_f32_16x16x32_bf16 v[208:211], v[144:147], v[160:163], v[208:211]
    v_mfma_f32_16x16x32_bf16 v[212:215], v[132:135], v[176:179], v[212:215]
    v_mfma_f32_16x16x32_bf16 v[212:215], v[144:147], v[164:167], v[212:215]
    v_mfma_f32_16x16x32_bf16 v[216:219], v[136:139], v[176:179], v[216:219]
    v_mfma_f32_16x16x32_bf16 v[216:219], v[144:147], v[168:171], v[216:219]
    v_mfma_f32_16x16x32_bf16 v[220:223], v[140:143], v[176:179], v[220:223]
    v_mfma_f32_16x16x32_bf16 v[220:223], v[144:147], v[172:175], v[220:223]
    v_mfma_f32_16x16x32_bf16 v[212:215], v[128:131], v[180:183], v[212:215]
    v_mfma_f32_16x16x32_bf16 v[212:215], v[148:151], v[160:163], v[212:215]
    v_mfma_f32_16x16x32_bf16 v[216:219], v[132:135], v[180:183], v[216:219]
    v_mfma_f32_16x16x32_bf16 v[216:219], v[148:151], v[164:167], v[216:219]
    v_mfma_f32_16x16x32_bf16 v[220:223], v[136:139], v[180:183], v[220:223]
    v_mfma_f32_16x16x32_bf16 v[220:223], v[148:151], v[168:171], v[220:223]
    v_mfma_f32_16x16x32_bf16 v[216:219], v[128:131], v[184:187], v[216:219]
    v_mfma_f32_16x16x32_bf16 v[216:219], v[152:155], v[160:163], v[216:219]
    v_mfma_f32_16x16x32_bf16 v[220:223], v[132:135], v[184:187], v[220:223]
    v_mfma_f32_16x16x32_bf16 v[220:223], v[152:155], v[164:167], v[220:223]
    v_mfma_f32_16x16x32_bf16 v[220:223], v[128:131], v[188:191], v[220:223]
    v_mfma_f32_16x16x32_bf16 v[220:223], v[156:159], v[160:163], v[220:223]
    s_waitcnt lgkmcnt(0) vmcnt(0)
    s_nop 3
    v_and_b32 v24, 0xffff0000, v241
    v_lshlrev_b32 v25, 16, v241
    v_and_b32 v26, 0xffff0000, v240
    v_lshlrev_b32 v27, 16, v240
    v_fmac_f32 v192, s41, v24
    v_fmac_f32 v193, s41, v25
    v_fmac_f32 v194, s41, v26
    v_fmac_f32 v195, s41, v27
    v_lshlrev_b32 v24, 16, v224
    v_and_b32 v25, 0xffff0000, v224
    v_lshlrev_b32 v26, 16, v225
    v_and_b32 v27, 0xffff0000, v225
    v_mul_f32 v192, v192, v24
    v_mul_f32 v193, v193, v25
    v_mul_f32 v194, v194, v26
    v_mul_f32 v195, v195, v27
    v_cvt_pk_bf16_f32 v28, v192, v193
    v_cvt_pk_bf16_f32 v29, v194, v195
    ds_write_b64 v14, v[28:29] offset:0
    v_and_b32 v24, 0xffff0000, v243
    v_lshlrev_b32 v25, 16, v243
    v_and_b32 v26, 0xffff0000, v242
    v_lshlrev_b32 v27, 16, v242
    v_fmac_f32 v196, s41, v24
    v_fmac_f32 v197, s41, v25
    v_fmac_f32 v198, s41, v26
    v_fmac_f32 v199, s41, v27
    v_lshlrev_b32 v24, 16, v226
    v_and_b32 v25, 0xffff0000, v226
    v_lshlrev_b32 v26, 16, v227
    v_and_b32 v27, 0xffff0000, v227
    v_mul_f32 v196, v196, v24
    v_mul_f32 v197, v197, v25
    v_mul_f32 v198, v198, v26
    v_mul_f32 v199, v199, v27
    v_cvt_pk_bf16_f32 v30, v196, v197
    v_cvt_pk_bf16_f32 v31, v198, v199
    ds_write_b64 v14, v[30:31] offset:512
    v_and_b32 v24, 0xffff0000, v245
    v_lshlrev_b32 v25, 16, v245
    v_and_b32 v26, 0xffff0000, v244
    v_lshlrev_b32 v27, 16, v244
    v_fmac_f32 v200, s41, v24
    v_fmac_f32 v201, s41, v25
    v_fmac_f32 v202, s41, v26
    v_fmac_f32 v203, s41, v27
    v_lshlrev_b32 v24, 16, v228
    v_and_b32 v25, 0xffff0000, v228
    v_lshlrev_b32 v26, 16, v229
    v_and_b32 v27, 0xffff0000, v229
    v_mul_f32 v200, v200, v24
    v_mul_f32 v201, v201, v25
    v_mul_f32 v202, v202, v26
    v_mul_f32 v203, v203, v27
    v_cvt_pk_bf16_f32 v28, v200, v201
    v_cvt_pk_bf16_f32 v29, v202, v203
    ds_write_b64 v14, v[28:29] offset:1024
    v_and_b32 v24, 0xffff0000, v247
    v_lshlrev_b32 v25, 16, v247
    v_and_b32 v26, 0xffff0000, v246
    v_lshlrev_b32 v27, 16, v246
    v_fmac_f32 v204, s41, v24
    v_fmac_f32 v205, s41, v25
    v_fmac_f32 v206, s41, v26
    v_fmac_f32 v207, s41, v27
    v_lshlrev_b32 v24, 16, v230
    v_and_b32 v25, 0xffff0000, v230
    v_lshlrev_b32 v26, 16, v231
    v_and_b32 v27, 0xffff0000, v231
    v_mul_f32 v204, v204, v24
    v_mul_f32 v205, v205, v25
    v_mul_f32 v206, v206, v26
    v_mul_f32 v207, v207, v27
    v_cvt_pk_bf16_f32 v30, v204, v205
    v_cvt_pk_bf16_f32 v31, v206, v207
    ds_write_b64 v14, v[30:31] offset:1536
    v_and_b32 v24, 0xffff0000, v249
    v_lshlrev_b32 v25, 16, v249
    v_and_b32 v26, 0xffff0000, v248
    v_lshlrev_b32 v27, 16, v248
    v_fmac_f32 v208, s41, v24
    v_fmac_f32 v209, s41, v25
    v_fmac_f32 v210, s41, v26
    v_fmac_f32 v211, s41, v27
    v_lshlrev_b32 v24, 16, v232
    v_and_b32 v25, 0xffff0000, v232
    v_lshlrev_b32 v26, 16, v233
    v_and_b32 v27, 0xffff0000, v233
    v_mul_f32 v208, v208, v24
    v_mul_f32 v209, v209, v25
    v_mul_f32 v210, v210, v26
    v_mul_f32 v211, v211, v27
    v_cvt_pk_bf16_f32 v28, v208, v209
    v_cvt_pk_bf16_f32 v29, v210, v211
    ds_write_b64 v14, v[28:29] offset:2048
    v_and_b32 v24, 0xffff0000, v251
    v_lshlrev_b32 v25, 16, v251
    v_and_b32 v26, 0xffff0000, v250
    v_lshlrev_b32 v27, 16, v250
    v_fmac_f32 v212, s41, v24
    v_fmac_f32 v213, s41, v25
    v_fmac_f32 v214, s41, v26
    v_fmac_f32 v215, s41, v27
    v_lshlrev_b32 v24, 16, v234
    v_and_b32 v25, 0xffff0000, v234
    v_lshlrev_b32 v26, 16, v235
    v_and_b32 v27, 0xffff0000, v235
    v_mul_f32 v212, v212, v24
    v_mul_f32 v213, v213, v25
    v_mul_f32 v214, v214, v26
    v_mul_f32 v215, v215, v27
    v_cvt_pk_bf16_f32 v30, v212, v213
    v_cvt_pk_bf16_f32 v31, v214, v215
    ds_write_b64 v14, v[30:31] offset:2560
    v_and_b32 v24, 0xffff0000, v253
    v_lshlrev_b32 v25, 16, v253
    v_and_b32 v26, 0xffff0000, v252
    v_lshlrev_b32 v27, 16, v252
    v_fmac_f32 v216, s41, v24
    v_fmac_f32 v217, s41, v25
    v_fmac_f32 v218, s41, v26
    v_fmac_f32 v219, s41, v27
    v_lshlrev_b32 v24, 16, v236
    v_and_b32 v25, 0xffff0000, v236
    v_lshlrev_b32 v26, 16, v237
    v_and_b32 v27, 0xffff0000, v237
    v_mul_f32 v216, v216, v24
    v_mul_f32 v217, v217, v25
    v_mul_f32 v218, v218, v26
    v_mul_f32 v219, v219, v27
    v_cvt_pk_bf16_f32 v28, v216, v217
    v_cvt_pk_bf16_f32 v29, v218, v219
    ds_write_b64 v14, v[28:29] offset:3072
    v_and_b32 v24, 0xffff0000, v255
    v_lshlrev_b32 v25, 16, v255
    v_and_b32 v26, 0xffff0000, v254
    v_lshlrev_b32 v27, 16, v254
    v_fmac_f32 v220, s41, v24
    v_fmac_f32 v221, s41, v25
    v_fmac_f32 v222, s41, v26
    v_fmac_f32 v223, s41, v27
    v_lshlrev_b32 v24, 16, v238
    v_and_b32 v25, 0xffff0000, v238
    v_lshlrev_b32 v26, 16, v239
    v_and_b32 v27, 0xffff0000, v239
    v_mul_f32 v220, v220, v24
    v_mul_f32 v221, v221, v25
    v_mul_f32 v222, v222, v26
    v_mul_f32 v223, v223, v27
    v_cvt_pk_bf16_f32 v30, v220, v221
    v_cvt_pk_bf16_f32 v31, v222, v223
    ds_write_b64 v14, v[30:31] offset:3584
    v_bfe_u32 v16, v1, 2, 2
    v_mul_u32_u24 v16, 12928, v16
    v_lshrrev_b32 v17, 4, v1
    v_lshl_add_u32 v16, v17, 5, v16
    v_and_b32 v17, 3, v1
    v_lshl_add_u32 v16, v17, 3, v16
    s_lshl_b32 s37, s32, 10
    s_add_u32 s37, s37, 78336
    v_add_u32 v16, s37, v16
    s_lshl_b32 s37, s32, 9
    v_add_u32 v17, s37, v1
    v_mul_u32_u24 v17, 2304, v17
    s_lshl_b32 s37, s50, 3
    v_mov_b32 v18, 155520
    v_mov_b32 v19, 1
    s_waitcnt lgkmcnt(0)
    s_mov_b64 exec, 1
    ds_add_u32 v18, v19
    s_mov_b64 exec, -1
    s_mov_b32 s39, 0
ka_kernel_csp_66:
    ds_read_b32 v19, v18
    s_add_u32 s39, s39, 1
    s_waitcnt lgkmcnt(0)
    v_readfirstlane_b32 s38, v19
    s_cmp_ge_u32 s38, 4
    s_cbranch_scc1 ka_kernel_cso_67
    s_cmp_lt_u32 s39, 0x400000
    s_cbranch_scc1 ka_kernel_csp_66
ka_kernel_cso_67:
    ds_read_b64_tr_b16 v[32:33], v16 offset:0
    ds_read_b64_tr_b16 v[34:35], v16 offset:128
    ds_read_b64_tr_b16 v[36:37], v16 offset:256
    ds_read_b64_tr_b16 v[38:39], v16 offset:384
    ds_read_b64_tr_b16 v[40:41], v16 offset:512
    ds_read_b64_tr_b16 v[42:43], v16 offset:640
    ds_read_b64_tr_b16 v[44:45], v16 offset:768
    ds_read_b64_tr_b16 v[46:47], v16 offset:896
    s_waitcnt lgkmcnt(7)
    buffer_store_dwordx2 v[32:33], v17, s[20:23], s37 offen
    s_add_u32 s37, s37, 147456
    s_waitcnt lgkmcnt(6)
    buffer_store_dwordx2 v[34:35], v17, s[20:23], s37 offen
    s_add_u32 s37, s37, 147456
    s_waitcnt lgkmcnt(5)
    buffer_store_dwordx2 v[36:37], v17, s[20:23], s37 offen
    s_add_u32 s37, s37, 147456
    s_waitcnt lgkmcnt(4)
    buffer_store_dwordx2 v[38:39], v17, s[20:23], s37 offen
    s_add_u32 s37, s37, 147456
    s_waitcnt lgkmcnt(3)
    buffer_store_dwordx2 v[40:41], v17, s[20:23], s37 offen
    s_add_u32 s37, s37, 147456
    s_waitcnt lgkmcnt(2)
    buffer_store_dwordx2 v[42:43], v17, s[20:23], s37 offen
    s_add_u32 s37, s37, 147456
    s_waitcnt lgkmcnt(1)
    buffer_store_dwordx2 v[44:45], v17, s[20:23], s37 offen
    s_add_u32 s37, s37, 147456
    s_waitcnt lgkmcnt(0)
    buffer_store_dwordx2 v[46:47], v17, s[20:23], s37 offen
    s_add_u32 s37, s37, 147456
ka_kernel_fin:
ka_kernel_end:
    s_endpgm
ka_kernel_h_3:
    s_mov_b32 s46, s6
    s_mov_b32 s47, s7
    s_mov_b32 s37, 209715200
    s_mov_b32 s48, 1024
    s_sub_u32 s38, s3, 0
    s_lshl_b32 s39, s38, 16
    s_add_u32 s39, s39, 1572864
    s_add_u32 s39, s39, s59
    s_cmp_lt_u32 s38, 16
    s_cselect_b32 s37, s39, s37
    s_cselect_b32 s46, s66, s46
    s_cselect_b32 s47, s67, s47
    s_cselect_b32 s48, 8192, s48
    s_sub_u32 s38, s3, 16
    s_lshl_b32 s39, s38, 16
    s_add_u32 s39, s39, 1572864
    s_add_u32 s39, s39, s59
    s_cmp_lt_u32 s38, 16
    s_cselect_b32 s37, s39, s37
    s_cselect_b32 s46, s68, s46
    s_cselect_b32 s47, s69, s47
    s_cselect_b32 s48, 8192, s48
    s_add_u32 s46, s46, s37
    s_addc_u32 s47, s47, 0
    v_lshrrev_b32 v19, 3, v1
    v_and_b32 v20, 7, v1
    v_lshlrev_b32 v20, 7, v20
    v_mad_u32_u24 v19, v19, s48, v20
    global_load_dword v3, v19, s[46:47]
ka_kernel_tsk_68:
    s_branch ka_kernel_r_2
ka_kernel_h_5:
    s_mov_b32 s46, s6
    s_mov_b32 s47, s7
    s_mov_b32 s37, 209715200
    s_mov_b32 s48, 1024
    s_sub_u32 s38, s3, 0
    s_lshl_b32 s39, s38, 16
    s_add_u32 s39, s39, 2621440
    s_add_u32 s39, s39, s59
    s_cmp_lt_u32 s38, 16
    s_cselect_b32 s37, s39, s37
    s_cselect_b32 s46, s66, s46
    s_cselect_b32 s47, s67, s47
    s_cselect_b32 s48, 8192, s48
    s_sub_u32 s38, s3, 16
    s_lshl_b32 s39, s38, 16
    s_add_u32 s39, s39, 2621440
    s_add_u32 s39, s39, s59
    s_cmp_lt_u32 s38, 16
    s_cselect_b32 s37, s39, s37
    s_cselect_b32 s46, s68, s46
    s_cselect_b32 s47, s69, s47
    s_cselect_b32 s48, 8192, s48
    s_cmp_eq_u32 s37, 209715200
    s_cbranch_scc1 ka_kernel_tsk_69
    s_add_u32 s46, s46, s37
    s_addc_u32 s47, s47, 0
    v_lshrrev_b32 v19, 3, v1
    v_and_b32 v20, 7, v1
    v_lshlrev_b32 v20, 7, v20
    v_mad_u32_u24 v19, v19, s48, v20
    global_load_dword v3, v19, s[46:47]
ka_kernel_tsk_69:
    s_branch ka_kernel_r_4
ka_kernel_h_6:
    s_add_u32 s37, s3, 8
    s_and_b32 s37, s37, 31
    s_andn2_b32 s3, s3, 31
    s_or_b32 s3, s3, s37
    s_mov_b32 s46, s6
    s_mov_b32 s47, s7
    s_mov_b32 s37, 209715200
    s_mov_b32 s48, 1024
    s_sub_u32 s38, s3, 0
    s_lshl_b32 s39, s38, 16
    s_add_u32 s39, s39, 3670016
    s_add_u32 s39, s39, s59
    s_cmp_lt_u32 s38, 8
    s_cselect_b32 s37, s39, s37
    s_cselect_b32 s46, s66, s46
    s_cselect_b32 s47, s67, s47
    s_cselect_b32 s48, 8192, s48
    s_sub_u32 s38, s3, 8
    s_lshl_b32 s39, s38, 16
    s_add_u32 s39, s39, 3670016
    s_add_u32 s39, s39, s59
    s_cmp_lt_u32 s38, 8
    s_cselect_b32 s37, s39, s37
    s_cselect_b32 s46, s68, s46
    s_cselect_b32 s47, s69, s47
    s_cselect_b32 s48, 8192, s48
    s_sub_u32 s38, s3, 16
    s_lshl_b32 s39, s38, 13
    s_mul_i32 s58, s59, 288
    s_add_u32 s39, s39, s58
    s_cmp_lt_u32 s38, 36
    s_cselect_b32 s37, s39, s37
    s_cselect_b32 s46, s60, s46
    s_cselect_b32 s47, s61, s47
    s_cmp_eq_u32 s37, 209715200
    s_cbranch_scc1 ka_kernel_tsk_70
    s_add_u32 s46, s46, s37
    s_addc_u32 s47, s47, 0
    v_lshrrev_b32 v19, 3, v1
    v_and_b32 v20, 7, v1
    v_lshlrev_b32 v20, 7, v20
    v_mad_u32_u24 v19, v19, s48, v20
    global_load_dword v3, v19, s[46:47]
ka_kernel_tsk_70:
    s_branch ka_kernel_r_4
ka_kernel_h_7:
    s_add_u32 s37, s3, 8
    s_and_b32 s37, s37, 31
    s_andn2_b32 s3, s3, 31
    s_or_b32 s3, s3, s37
    s_add_u32 s37, s3, 8
    s_and_b32 s37, s37, 31
    s_andn2_b32 s3, s3, 31
    s_or_b32 s3, s3, s37
    s_mov_b32 s46, s6
    s_mov_b32 s47, s7
    s_mov_b32 s37, 209715200
    s_mov_b32 s48, 1024
    s_sub_u32 s38, s3, 0
    s_lshl_b32 s39, s38, 16
    s_add_u32 s39, s39, s59
    s_cmp_lt_u32 s38, 36
    s_cselect_b32 s37, s39, s37
    s_cselect_b32 s46, s64, s46
    s_cselect_b32 s47, s65, s47
    s_cselect_b32 s48, 8192, s48
    s_cmp_eq_u32 s37, 209715200
    s_cbranch_scc1 ka_kernel_tsk_71
    s_add_u32 s46, s46, s37
    s_addc_u32 s47, s47, 0
    v_lshrrev_b32 v19, 3, v1
    v_and_b32 v20, 7, v1
    v_lshlrev_b32 v20, 7, v20
    v_mad_u32_u24 v19, v19, s48, v20
    global_load_dword v3, v19, s[46:47]
ka_kernel_tsk_71:
    s_branch ka_kernel_r_4
ka_kernel_h_8:
    s_add_u32 s37, s3, 8
    s_and_b32 s37, s37, 31
    s_andn2_b32 s3, s3, 31
    s_or_b32 s3, s3, s37
    s_mov_b32 s46, s6
    s_mov_b32 s47, s7
    s_mov_b32 s37, 209715200
    s_mov_b32 s48, 1024
    s_sub_u32 s38, s3, 0
    s_lshl_b32 s39, s38, 16
    s_add_u32 s39, s39, 2359296
    s_add_u32 s39, s39, s59
    s_cmp_lt_u32 s38, 36
    s_cselect_b32 s37, s39, s37
    s_cselect_b32 s46, s64, s46
    s_cselect_b32 s47, s65, s47
    s_cselect_b32 s48, 8192, s48
    s_cmp_eq_u32 s37, 209715200
    s_cbranch_scc1 ka_kernel_tsk_72
    s_add_u32 s46, s46, s37
    s_addc_u32 s47, s47, 0
    v_lshrrev_b32 v19, 3, v1
    v_and_b32 v20, 7, v1
    v_lshlrev_b32 v20, 7, v20
    v_mad_u32_u24 v19, v19, s48, v20
    global_load_dword v3, v19, s[46:47]
ka_kernel_tsk_72:
    s_branch ka_kernel_r_4
ka_kernel_mask_14:
    s_lshl_b32 s37, s51, 5
    v_subrev_u32 v10, s37, v7
    v_subrev_u32 v9, s37, v0
    v_cmp_le_i32 s[56:57], 0, v10
    v_cmp_le_i32 s[58:59], 1, v10
    v_cmp_le_i32 s[60:61], 2, v10
    v_cmp_le_i32 s[62:63], 3, v10
    v_cndmask_b32 v128, v8, v128, s[56:57]
    v_cndmask_b32 v129, v8, v129, s[58:59]
    v_cndmask_b32 v130, v8, v130, s[60:61]
    v_cndmask_b32 v131, v8, v131, s[62:63]
    v_cmp_le_i32 s[56:57], 0, v9
    v_cmp_le_i32 s[58:59], 1, v9
    v_cmp_le_i32 s[60:61], 2, v9
    v_cmp_le_i32 s[62:63], 3, v9
    v_cndmask_b32 v132, v8, v132, s[56:57]
    v_cndmask_b32 v133, v8, v133, s[58:59]
    v_cndmask_b32 v134, v8, v134, s[60:61]
    v_cndmask_b32 v135, v8, v135, s[62:63]
    v_cmp_le_i32 s[56:57], 16, v10
    v_cmp_le_i32 s[58:59], 17, v10
    v_cmp_le_i32 s[60:61], 18, v10
    v_cmp_le_i32 s[62:63], 19, v10
    v_cndmask_b32 v136, v8, v136, s[56:57]
    v_cndmask_b32 v137, v8, v137, s[58:59]
    v_cndmask_b32 v138, v8, v138, s[60:61]
    v_cndmask_b32 v139, v8, v139, s[62:63]
    v_cmp_le_i32 s[56:57], 16, v9
    v_cmp_le_i32 s[58:59], 17, v9
    v_cmp_le_i32 s[60:61], 18, v9
    v_cmp_le_i32 s[62:63], 19, v9
    v_cndmask_b32 v140, v8, v140, s[56:57]
    v_cndmask_b32 v141, v8, v141, s[58:59]
    v_cndmask_b32 v142, v8, v142, s[60:61]
    v_cndmask_b32 v143, v8, v143, s[62:63]
    s_branch ka_kernel_mret_15
ka_kernel_rare_17:
    s_nop 7
    v_max3_f32 v19, v144, v145, v146
    v_max3_f32 v19, v19, v147, v152
    v_max3_f32 v19, v19, v153, v154
    v_max3_f32 v19, v19, v155, 0
    v_mov_b32 v23, v19
    s_nop 1
    v_permlane16_swap_b32 v19, v23
    v_max_f32 v19, v19, v23
    v_mov_b32 v23, v19
    s_nop 1
    v_permlane32_swap_b32 v19, v23
    v_max_f32 v19, v19, v23
    v_sub_f32 v21, 0, v19
    v_exp_f32 v21, v21
    v_sub_f32 v144, v144, v19
    v_sub_f32 v145, v145, v19
    v_sub_f32 v146, v146, v19
    v_sub_f32 v147, v147, v19
    v_sub_f32 v152, v152, v19
    v_sub_f32 v153, v153, v19
    v_sub_f32 v154, v154, v19
    v_sub_f32 v155, v155, v19
    v_sub_f32 v128, v128, v19
    v_sub_f32 v129, v129, v19
    v_sub_f32 v130, v130, v19
    v_sub_f32 v131, v131, v19
    v_sub_f32 v136, v136, v19
    v_sub_f32 v137, v137, v19
    v_sub_f32 v138, v138, v19
    v_sub_f32 v139, v139, v19
    v_sub_f32 v104, v104, v19
    v_sub_f32 v105, v105, v19
    v_sub_f32 v106, v106, v19
    v_sub_f32 v107, v107, v19
    v_add_f32 v42, v42, v19
    v_mul_f32 v40, v40, v21
    v_mul_f32 v192, v192, v21
    v_mul_f32 v193, v193, v21
    v_mul_f32 v194, v194, v21
    v_mul_f32 v195, v195, v21
    v_mul_f32 v200, v200, v21
    v_mul_f32 v201, v201, v21
    v_mul_f32 v202, v202, v21
    v_mul_f32 v203, v203, v21
    v_mul_f32 v208, v208, v21
    v_mul_f32 v209, v209, v21
    v_mul_f32 v210, v210, v21
    v_mul_f32 v211, v211, v21
    v_mul_f32 v216, v216, v21
    v_mul_f32 v217, v217, v21
    v_mul_f32 v218, v218, v21
    v_mul_f32 v219, v219, v21
    v_mul_f32 v224, v224, v21
    v_mul_f32 v225, v225, v21
    v_mul_f32 v226, v226, v21
    v_mul_f32 v227, v227, v21
    v_mul_f32 v232, v232, v21
    v_mul_f32 v233, v233, v21
    v_mul_f32 v234, v234, v21
    v_mul_f32 v235, v235, v21
    v_mul_f32 v240, v240, v21
    v_mul_f32 v241, v241, v21
    v_mul_f32 v242, v242, v21
    v_mul_f32 v243, v243, v21
    v_mul_f32 v248, v248, v21
    v_mul_f32 v249, v249, v21
    v_mul_f32 v250, v250, v21
    v_mul_f32 v251, v251, v21
    v_max3_f32 v20, v148, v149, v150
    v_max3_f32 v20, v20, v151, v156
    v_max3_f32 v20, v20, v157, v158
    v_max3_f32 v20, v20, v159, 0
    v_mov_b32 v23, v20
    s_nop 1
    v_permlane16_swap_b32 v20, v23
    v_max_f32 v20, v20, v23
    v_mov_b32 v23, v20
    s_nop 1
    v_permlane32_swap_b32 v20, v23
    v_max_f32 v20, v20, v23
    v_sub_f32 v22, 0, v20
    v_exp_f32 v22, v22
    v_sub_f32 v148, v148, v20
    v_sub_f32 v149, v149, v20
    v_sub_f32 v150, v150, v20
    v_sub_f32 v151, v151, v20
    v_sub_f32 v156, v156, v20
    v_sub_f32 v157, v157, v20
    v_sub_f32 v158, v158, v20
    v_sub_f32 v159, v159, v20
    v_sub_f32 v132, v132, v20
    v_sub_f32 v133, v133, v20
    v_sub_f32 v134, v134, v20
    v_sub_f32 v135, v135, v20
    v_sub_f32 v140, v140, v20
    v_sub_f32 v141, v141, v20
    v_sub_f32 v142, v142, v20
    v_sub_f32 v143, v143, v20
    v_sub_f32 v108, v108, v20
    v_sub_f32 v109, v109, v20
    v_sub_f32 v110, v110, v20
    v_sub_f32 v111, v111, v20
    v_add_f32 v43, v43, v20
    v_mul_f32 v41, v41, v22
    v_mul_f32 v196, v196, v22
    v_mul_f32 v197, v197, v22
    v_mul_f32 v198, v198, v22
    v_mul_f32 v199, v199, v22
    v_mul_f32 v204, v204, v22
    v_mul_f32 v205, v205, v22
    v_mul_f32 v206, v206, v22
    v_mul_f32 v207, v207, v22
    v_mul_f32 v212, v212, v22
    v_mul_f32 v213, v213, v22
    v_mul_f32 v214, v214, v22
    v_mul_f32 v215, v215, v22
    v_mul_f32 v220, v220, v22
    v_mul_f32 v221, v221, v22
    v_mul_f32 v222, v222, v22
    v_mul_f32 v223, v223, v22
    v_mul_f32 v228, v228, v22
    v_mul_f32 v229, v229, v22
    v_mul_f32 v230, v230, v22
    v_mul_f32 v231, v231, v22
    v_mul_f32 v236, v236, v22
    v_mul_f32 v237, v237, v22
    v_mul_f32 v238, v238, v22
    v_mul_f32 v239, v239, v22
    v_mul_f32 v244, v244, v22
    v_mul_f32 v245, v245, v22
    v_mul_f32 v246, v246, v22
    v_mul_f32 v247, v247, v22
    v_mul_f32 v252, v252, v22
    v_mul_f32 v253, v253, v22
    v_mul_f32 v254, v254, v22
    v_mul_f32 v255, v255, v22
    v_exp_f32 v46, v144
    v_exp_f32 v47, v145
    v_exp_f32 v48, v146
    v_add_f32 v44, v46, v47
    v_exp_f32 v49, v147
    v_cvt_pk_bf16_f32 v120, v46, v47
    v_exp_f32 v50, v152
    v_add_f32 v44, v44, v48
    v_exp_f32 v51, v153
    v_cvt_pk_bf16_f32 v121, v48, v49
    v_add_f32 v44, v44, v49
    v_exp_f32 v52, v154
    v_add_f32 v44, v44, v50
    v_exp_f32 v53, v155
    v_cvt_pk_bf16_f32 v122, v50, v51
    v_add_f32 v44, v44, v51
    v_exp_f32 v46, v148
    v_add_f32 v44, v44, v52
    v_exp_f32 v47, v149
    v_cvt_pk_bf16_f32 v123, v52, v53
    v_add_f32 v44, v44, v53
    v_exp_f32 v48, v150
    v_add_f32 v45, v46, v47
    v_exp_f32 v49, v151
    v_cvt_pk_bf16_f32 v124, v46, v47
    v_exp_f32 v50, v156
    v_add_f32 v45, v45, v48
    v_exp_f32 v51, v157
    v_cvt_pk_bf16_f32 v125, v48, v49
    v_add_f32 v45, v45, v49
    v_exp_f32 v52, v158
    v_add_f32 v45, v45, v50
    v_exp_f32 v53, v159
    v_cvt_pk_bf16_f32 v126, v50, v51
    v_add_f32 v45, v45, v51
    s_nop 0
    v_add_f32 v45, v45, v52
    v_cvt_pk_bf16_f32 v127, v52, v53
    v_add_f32 v45, v45, v53
    s_nop 1
    s_branch ka_kernel_ret_18
ka_kernel_rare_19:
    s_nop 7
    v_max3_f32 v19, v128, v129, v130
    v_max3_f32 v19, v19, v131, v136
    v_max3_f32 v19, v19, v137, v138
    v_max3_f32 v19, v19, v139, 0
    v_mov_b32 v23, v19
    s_nop 1
    v_permlane16_swap_b32 v19, v23
    v_max_f32 v19, v19, v23
    v_mov_b32 v23, v19
    s_nop 1
    v_permlane32_swap_b32 v19, v23
    v_max_f32 v19, v19, v23
    v_sub_f32 v21, 0, v19
    v_exp_f32 v21, v21
    v_sub_f32 v128, v128, v19
    v_sub_f32 v129, v129, v19
    v_sub_f32 v130, v130, v19
    v_sub_f32 v131, v131, v19
    v_sub_f32 v136, v136, v19
    v_sub_f32 v137, v137, v19
    v_sub_f32 v138, v138, v19
    v_sub_f32 v139, v139, v19
    v_sub_f32 v144, v144, v19
    v_sub_f32 v145, v145, v19
    v_sub_f32 v146, v146, v19
    v_sub_f32 v147, v147, v19
    v_sub_f32 v152, v152, v19
    v_sub_f32 v153, v153, v19
    v_sub_f32 v154, v154, v19
    v_sub_f32 v155, v155, v19
    v_sub_f32 v104, v104, v19
    v_sub_f32 v105, v105, v19
    v_sub_f32 v106, v106, v19
    v_sub_f32 v107, v107, v19
    v_add_f32 v42, v42, v19
    v_mul_f32 v40, v40, v21
    v_mul_f32 v192, v192, v21
    v_mul_f32 v193, v193, v21
    v_mul_f32 v194, v194, v21
    v_mul_f32 v195, v195, v21
    v_mul_f32 v200, v200, v21
    v_mul_f32 v201, v201, v21
    v_mul_f32 v202, v202, v21
    v_mul_f32 v203, v203, v21
    v_mul_f32 v208, v208, v21
    v_mul_f32 v209, v209, v21
    v_mul_f32 v210, v210, v21
    v_mul_f32 v211, v211, v21
    v_mul_f32 v216, v216, v21
    v_mul_f32 v217, v217, v21
    v_mul_f32 v218, v218, v21
    v_mul_f32 v219, v219, v21
    v_mul_f32 v224, v224, v21
    v_mul_f32 v225, v225, v21
    v_mul_f32 v226, v226, v21
    v_mul_f32 v227, v227, v21
    v_mul_f32 v232, v232, v21
    v_mul_f32 v233, v233, v21
    v_mul_f32 v234, v234, v21
    v_mul_f32 v235, v235, v21
    v_mul_f32 v240, v240, v21
    v_mul_f32 v241, v241, v21
    v_mul_f32 v242, v242, v21
    v_mul_f32 v243, v243, v21
    v_mul_f32 v248, v248, v21
    v_mul_f32 v249, v249, v21
    v_mul_f32 v250, v250, v21
    v_mul_f32 v251, v251, v21
    v_max3_f32 v20, v132, v133, v134
    v_max3_f32 v20, v20, v135, v140
    v_max3_f32 v20, v20, v141, v142
    v_max3_f32 v20, v20, v143, 0
    v_mov_b32 v23, v20
    s_nop 1
    v_permlane16_swap_b32 v20, v23
    v_max_f32 v20, v20, v23
    v_mov_b32 v23, v20
    s_nop 1
    v_permlane32_swap_b32 v20, v23
    v_max_f32 v20, v20, v23
    v_sub_f32 v22, 0, v20
    v_exp_f32 v22, v22
    v_sub_f32 v132, v132, v20
    v_sub_f32 v133, v133, v20
    v_sub_f32 v134, v134, v20
    v_sub_f32 v135, v135, v20
    v_sub_f32 v140, v140, v20
    v_sub_f32 v141, v141, v20
    v_sub_f32 v142, v142, v20
    v_sub_f32 v143, v143, v20
    v_sub_f32 v148, v148, v20
    v_sub_f32 v149, v149, v20
    v_sub_f32 v150, v150, v20
    v_sub_f32 v151, v151, v20
    v_sub_f32 v156, v156, v20
    v_sub_f32 v157, v157, v20
    v_sub_f32 v158, v158, v20
    v_sub_f32 v159, v159, v20
    v_sub_f32 v108, v108, v20
    v_sub_f32 v109, v109, v20
    v_sub_f32 v110, v110, v20
    v_sub_f32 v111, v111, v20
    v_add_f32 v43, v43, v20
    v_mul_f32 v41, v41, v22
    v_mul_f32 v196, v196, v22
    v_mul_f32 v197, v197, v22
    v_mul_f32 v198, v198, v22
    v_mul_f32 v199, v199, v22
    v_mul_f32 v204, v204, v22
    v_mul_f32 v205, v205, v22
    v_mul_f32 v206, v206, v22
    v_mul_f32 v207, v207, v22
    v_mul_f32 v212, v212, v22
    v_mul_f32 v213, v213, v22
    v_mul_f32 v214, v214, v22
    v_mul_f32 v215, v215, v22
    v_mul_f32 v220, v220, v22
    v_mul_f32 v221, v221, v22
    v_mul_f32 v222, v222, v22
    v_mul_f32 v223, v223, v22
    v_mul_f32 v228, v228, v22
    v_mul_f32 v229, v229, v22
    v_mul_f32 v230, v230, v22
    v_mul_f32 v231, v231, v22
    v_mul_f32 v236, v236, v22
    v_mul_f32 v237, v237, v22
    v_mul_f32 v238, v238, v22
    v_mul_f32 v239, v239, v22
    v_mul_f32 v244, v244, v22
    v_mul_f32 v245, v245, v22
    v_mul_f32 v246, v246, v22
    v_mul_f32 v247, v247, v22
    v_mul_f32 v252, v252, v22
    v_mul_f32 v253, v253, v22
    v_mul_f32 v254, v254, v22
    v_mul_f32 v255, v255, v22
    v_exp_f32 v46, v128
    v_exp_f32 v47, v129
    v_exp_f32 v48, v130
    v_add_f32 v44, v46, v47
    v_exp_f32 v49, v131
    v_cvt_pk_bf16_f32 v112, v46, v47
    v_exp_f32 v50, v136
    v_add_f32 v44, v44, v48
    v_exp_f32 v51, v137
    v_cvt_pk_bf16_f32 v113, v48, v49
    v_add_f32 v44, v44, v49
    v_exp_f32 v52, v138
    v_add_f32 v44, v44, v50
    v_exp_f32 v53, v139
    v_cvt_pk_bf16_f32 v114, v50, v51
    v_add_f32 v44, v44, v51
    v_exp_f32 v46, v132
    v_add_f32 v44, v44, v52
    v_exp_f32 v47, v133
    v_cvt_pk_bf16_f32 v115, v52, v53
    v_add_f32 v44, v44, v53
    v_exp_f32 v48, v134
    v_add_f32 v45, v46, v47
    v_exp_f32 v49, v135
    v_cvt_pk_bf16_f32 v116, v46, v47
    v_exp_f32 v50, v140
    v_add_f32 v45, v45, v48
    v_exp_f32 v51, v141
    v_cvt_pk_bf16_f32 v117, v48, v49
    v_add_f32 v45, v45, v49
    v_exp_f32 v52, v142
    v_add_f32 v45, v45, v50
    v_exp_f32 v53, v143
    v_cvt_pk_bf16_f32 v118, v50, v51
    v_add_f32 v45, v45, v51
    s_nop 0
    v_add_f32 v45, v45, v52
    v_cvt_pk_bf16_f32 v119, v52, v53
    v_add_f32 v45, v45, v53
    s_nop 1
    s_branch ka_kernel_ret_20
ka_kernel_side_21:
    s_cmp_eq_u32 s65, 1
    s_cbranch_scc1 ka_kernel_ev_74
    s_cmp_eq_u32 s65, 2
    s_cbranch_scc1 ka_kernel_ev_75
    s_cmp_eq_u32 s65, 3
    s_cbranch_scc1 ka_kernel_ev_76
    s_cmp_eq_u32 s65, 4
    s_cbranch_scc1 ka_kernel_ev_77
    s_cmp_eq_u32 s65, 5
    s_cbranch_scc1 ka_kernel_ev_78
    s_add_u32 s64, s64, 2
    s_mov_b32 s65, 1
    s_load_dwordx8 s[56:63], s[0:1], 0
    s_and_b32 s67, s2, 7
    s_lshl_b32 s67, s67, 3
    s_lshr_b32 s37, s2, 5
    s_add_u32 s67, s67, s37
    s_bfe_u32 s37, s2, 0x20003
    s_mul_i32 s38, s37, 9
    s_add_u32 s38, s38, 1
    s_lshr_b32 s38, s38, 1
    s_add_u32 s68, s38, s32
    s_and_b32 s38, s37, 1
    s_sub_u32 s38, 5, s38
    s_cmp_lt_u32 s32, s38
    s_cselect_b32 s66, 1, 0
    s_waitcnt lgkmcnt(0)
    s_cmp_eq_u32 s66, 0
    s_cbranch_scc1 ka_kernel_sle_79
    s_mov_b32 s24, s56
    s_and_b32 s25, s57, 0xffff
    s_mov_b32 s26, 2359296
    s_mov_b32 s27, 0x20000
    s_mov_b32 s8, s58
    s_and_b32 s9, s59, 0xffff
    s_mov_b32 s10, 2359296
    s_mov_b32 s11, 0x20000
    s_mov_b32 s12, s60
    s_and_b32 s13, s61, 0xffff
    s_mov_b32 s14, 2359296
    s_mov_b32 s15, 0x20000
    s_mov_b32 s60, s62
    s_and_b32 s61, s63, 0xffff
    s_mov_b32 s62, 4608
    s_mov_b32 s63, 0x20000
    v_lshrrev_b32 v19, 4, v1
    v_and_b32 v20, 15, v1
    s_lshl_b32 s37, s67, 5
    v_lshl_add_u32 v19, v19, 3, s37
    v_mul_u32_u24 v19, 1152, v19
    v_lshl_add_u32 v19, v20, 2, v19
    s_lshl_b32 s37, s68, 6
    v_add_u32 v19, s37, v19
    v_add_u32 v21, 4294963840, v19
    v_add_u32 v22, 4608, v19
    v_lshlrev_b32 v20, 4, v20
    s_lshl_b32 s37, s68, 8
    buffer_load_dword v54, v21, s[8:11], 0 offen offset:0
    buffer_load_dword v55, v21, s[8:11], 0 offen offset:1152
    buffer_load_dword v56, v21, s[8:11], 0 offen offset:2304
    buffer_load_dword v57, v19, s[8:11], 0 offen offset:0
    buffer_load_dword v58, v19, s[8:11], 0 offen offset:1152
    buffer_load_dword v59, v19, s[8:11], 0 offen offset:2304
    buffer_load_dword v60, v19, s[8:11], 0 offen offset:3456
    buffer_load_dword v61, v22, s[8:11], 0 offen offset:0
    buffer_load_dword v62, v22, s[8:11], 0 offen offset:1152
    buffer_load_dword v63, v22, s[8:11], 0 offen offset:2304
    buffer_load_dword v64, v22, s[8:11], 0 offen offset:3456
    buffer_load_dword v28, v19, s[12:15], 0 offen offset:0
    buffer_load_dword v29, v19, s[12:15], 0 offen offset:1152
    buffer_load_dword v30, v19, s[12:15], 0 offen offset:2304
    buffer_load_dword v31, v19, s[12:15], 0 offen offset:3456
    buffer_load_dword v32, v22, s[12:15], 0 offen offset:0
    buffer_load_dword v33, v22, s[12:15], 0 offen offset:1152
    buffer_load_dword v34, v22, s[12:15], 0 offen offset:2304
    buffer_load_dword v35, v22, s[12:15], 0 offen offset:3456
    buffer_load_dword v11, v19, s[24:27], 0 offen offset:0
    buffer_load_dword v12, v19, s[24:27], 0 offen offset:1152
    buffer_load_dword v13, v19, s[24:27], 0 offen offset:2304
    buffer_load_dword v14, v19, s[24:27], 0 offen offset:3456
    buffer_load_dword v15, v22, s[24:27], 0 offen offset:0
    buffer_load_dword v16, v22, s[24:27], 0 offen offset:1152
    buffer_load_dword v17, v22, s[24:27], 0 offen offset:2304
    buffer_load_dword v18, v22, s[24:27], 0 offen offset:3456
    buffer_load_dwordx4 v[36:39], v20, s[60:63], s37 offen
ka_kernel_sle_79:
    s_branch ka_kernel_sret_22
ka_kernel_ev_74:
    s_mov_b32 s64, 99
    s_cmp_eq_u32 s66, 0
    s_cbranch_scc1 ka_kernel_sce_81
    s_mov_b32 s38, 0x05040100
    s_mov_b32 s39, 0x07060302
    v_lshrrev_b32 v19, 4, v1
    v_and_b32 v20, 15, v1
    s_add_u32 s70, s6, 58720256
    s_addc_u32 s71, s7, 0
    s_mov_b32 s8, s70
    s_and_b32 s9, s71, 0xffff
    s_mov_b32 s10, 2359296
    s_mov_b32 s11, 0x20000
    s_add_u32 s70, s6, 62914560
    s_addc_u32 s71, s7, 0
    s_mov_b32 s12, s70
    s_and_b32 s13, s71, 0xffff
    s_mov_b32 s14, 2359296
    s_mov_b32 s15, 0x20000
    s_lshl_b32 s37, s67, 6
    v_lshl_add_u32 v19, v19, 4, s37
    v_lshlrev_b32 v20, 13, v20
    v_sub_u32 v21, 4080, v19
    v_add_u32 v21, v21, v20
    v_add_u32 v19, v19, v20
    s_lshl_b32 s37, s68, 17
    v_perm_b32 v68, v12, v11, s38
    v_perm_b32 v69, v14, v13, s38
    v_perm_b32 v70, v16, v15, s38
    v_perm_b32 v71, v18, v17, s38
    buffer_store_dwordx4 v[68:71], v19, s[12:15], s37 offen sc1
    v_perm_b32 v46, v58, v59, s38
    v_perm_b32 v47, v59, v60, s38
    v_perm_b32 v48, v60, v61, s38
    v_perm_b32 v49, v61, v62, s38
    v_perm_b32 v50, v62, v63, s38
    v_perm_b32 v51, v63, v64, s38
    v_dot2_f32_bf16 v22, v48, v36, 0
    v_dot2_f32_bf16 v23, v49, v36, 0
    v_dot2_f32_bf16 v24, v50, v36, 0
    v_dot2_f32_bf16 v25, v51, v36, 0
    v_dot2_f32_bf16 v22, v46, v37, v22
    v_dot2_f32_bf16 v23, v47, v37, v23
    v_dot2_f32_bf16 v24, v48, v37, v24
    v_dot2_f32_bf16 v25, v49, v37, v25
    v_lshlrev_b32 v46, 16, v32
    v_lshlrev_b32 v47, 16, v33
    v_lshlrev_b32 v48, 16, v34
    v_lshlrev_b32 v49, 16, v35
    v_mul_f32 v22, v22, v46
    v_mul_f32 v23, v23, v47
    v_mul_f32 v24, v24, v48
    v_mul_f32 v25, v25, v49
    v_cvt_pk_bf16_f32 v68, v25, v24
    v_cvt_pk_bf16_f32 v69, v23, v22
    v_perm_b32 v46, v54, v55, s38
    v_perm_b32 v47, v55, v56, s38
    v_perm_b32 v48, v56, v57, s38
    v_perm_b32 v49, v57, v58, s38
    v_perm_b32 v50, v58, v59, s38
    v_perm_b32 v51, v59, v60, s38
    v_dot2_f32_bf16 v22, v48, v36, 0
    v_dot2_f32_bf16 v23, v49, v36, 0
    v_dot2_f32_bf16 v24, v50, v36, 0
    v_dot2_f32_bf16 v25, v51, v36, 0
    v_dot2_f32_bf16 v22, v46, v37, v22
    v_dot2_f32_bf16 v23, v47, v37, v23
    v_dot2_f32_bf16 v24, v48, v37, v24
    v_dot2_f32_bf16 v25, v49, v37, v25
    v_lshlrev_b32 v46, 16, v28
    v_lshlrev_b32 v47, 16, v29
    v_lshlrev_b32 v48, 16, v30
    v_lshlrev_b32 v49, 16, v31
    v_mul_f32 v22, v22, v46
    v_mul_f32 v23, v23, v47
    v_mul_f32 v24, v24, v48
    v_mul_f32 v25, v25, v49
    v_cvt_pk_bf16_f32 v70, v25, v24
    v_cvt_pk_bf16_f32 v71, v23, v22
    buffer_store_dwordx4 v[68:71], v21, s[8:11], s37 offen sc1
    s_add_u32 s37, s37, 4096
    s_nop 0
    v_perm_b32 v68, v12, v11, s39
    v_perm_b32 v69, v14, v13, s39
    v_perm_b32 v70, v16, v15, s39
    v_perm_b32 v71, v18, v17, s39
    buffer_store_dwordx4 v[68:71], v19, s[12:15], s37 offen sc1
    v_perm_b32 v46, v58, v59, s39
    v_perm_b32 v47, v59, v60, s39
    v_perm_b32 v48, v60, v61, s39
    v_perm_b32 v49, v61, v62, s39
    v_perm_b32 v50, v62, v63, s39
    v_perm_b32 v51, v63, v64, s39
    v_dot2_f32_bf16 v22, v48, v38, 0
    v_dot2_f32_bf16 v23, v49, v38, 0
    v_dot2_f32_bf16 v24, v50, v38, 0
    v_dot2_f32_bf16 v25, v51, v38, 0
    v_dot2_f32_bf16 v22, v46, v39, v22
    v_dot2_f32_bf16 v23, v47, v39, v23
    v_dot2_f32_bf16 v24, v48, v39, v24
    v_dot2_f32_bf16 v25, v49, v39, v25
    v_and_b32 v46, 0xffff0000, v32
    v_and_b32 v47, 0xffff0000, v33
    v_and_b32 v48, 0xffff0000, v34
    v_and_b32 v49, 0xffff0000, v35
    v_mul_f32 v22, v22, v46
    v_mul_f32 v23, v23, v47
    v_mul_f32 v24, v24, v48
    v_mul_f32 v25, v25, v49
    v_cvt_pk_bf16_f32 v68, v25, v24
    v_cvt_pk_bf16_f32 v69, v23, v22
    v_perm_b32 v46, v54, v55, s39
    v_perm_b32 v47, v55, v56, s39
    v_perm_b32 v48, v56, v57, s39
    v_perm_b32 v49, v57, v58, s39
    v_perm_b32 v50, v58, v59, s39
    v_perm_b32 v51, v59, v60, s39
    v_dot2_f32_bf16 v22, v48, v38, 0
    v_dot2_f32_bf16 v23, v49, v38, 0
    v_dot2_f32_bf16 v24, v50, v38, 0
    v_dot2_f32_bf16 v25, v51, v38, 0
    v_dot2_f32_bf16 v22, v46, v39, v22
    v_dot2_f32_bf16 v23, v47, v39, v23
    v_dot2_f32_bf16 v24, v48, v39, v24
    v_dot2_f32_bf16 v25, v49, v39, v25
    v_and_b32 v46, 0xffff0000, v28
    v_and_b32 v47, 0xffff0000, v29
    v_and_b32 v48, 0xffff0000, v30
    v_and_b32 v49, 0xffff0000, v31
    v_mul_f32 v22, v22, v46
    v_mul_f32 v23, v23, v47
    v_mul_f32 v24, v24, v48
    v_mul_f32 v25, v25, v49
    v_cvt_pk_bf16_f32 v70, v25, v24
    v_cvt_pk_bf16_f32 v71, v23, v22
    buffer_store_dwordx4 v[68:71], v21, s[8:11], s37 offen sc1
    s_add_u32 s37, s37, 4096
    s_nop 0
ka_kernel_sce_81:
    s_branch ka_kernel_sret_22
ka_kernel_ev_75:
ka_kernel_ev_76:
    s_mov_b32 s65, 4
    s_lshl_b32 s38, s34, 1
    s_add_u32 s38, s38, 4
    s_add_u32 s64, s64, 1
    s_max_u32 s64, s64, s38
    v_mov_b32 v19, s69
    v_mov_b32 v20, 0
    s_lshl_b32 s38, s2, 2
    s_add_u32 s38, s38, 32768
    s_mov_b64 exec, 1
    buffer_store_dword v19, v20, s[72:75], s38 offen sc1
    s_mov_b64 exec, -1
    s_branch ka_kernel_sret_22
ka_kernel_ev_78:
    s_load_dwordx2 s[8:9], s[0:1], 88
    s_load_dwordx2 s[10:11], s[0:1], 32
    s_mov_b32 s64, 99
    v_lshlrev_b32 v19, 7, v1
    s_lshl_b32 s37, s2, 13
    v_add_u32 v19, s37, v19
    s_min_u32 s38, s2, 63
    s_min_u32 s39, s2, 31
    s_sub_u32 s38, s38, s2
    s_sub_u32 s39, s39, s2
    s_lshl_b32 s38, s38, 13
    s_lshl_b32 s39, s39, 13
    v_add_u32 v20, 2097152, v19
    v_add_u32 v21, s38, v20
    v_add_u32 v21, 2097152, v21
    v_add_u32 v22, s39, v20
    s_waitcnt lgkmcnt(0)
    global_load_dword v3, v19, s[8:9]
    global_load_dword v3, v20, s[8:9]
    global_load_dword v3, v21, s[8:9]
    global_load_dword v3, v19, s[10:11]
    global_load_dword v3, v22, s[10:11]
    s_branch ka_kernel_sret_22
ka_kernel_ev_77:
    s_mov_b32 s64, 99
    v_mov_b32 v19, s69
    v_mov_b32 v20, 0
    s_lshl_b32 s38, s34, 7
    s_lshl_b32 s39, s33, 2
    s_add_u32 s38, s38, s39
    s_add_u32 s38, s38, 36864
    s_mov_b64 exec, 1
    buffer_store_dword v19, v20, s[72:75], s38 offen sc1
    s_mov_b64 exec, -1
    s_branch ka_kernel_sret_22
ka_kernel_mask_23:
    s_lshl_b32 s37, s51, 5
    v_subrev_u32 v10, s37, v7
    v_subrev_u32 v9, s37, v0
    v_cmp_le_i32 s[56:57], 0, v10
    v_cmp_le_i32 s[58:59], 1, v10
    v_cmp_le_i32 s[60:61], 2, v10
    v_cmp_le_i32 s[62:63], 3, v10
    v_cndmask_b32 v144, v8, v144, s[56:57]
    v_cndmask_b32 v145, v8, v145, s[58:59]
    v_cndmask_b32 v146, v8, v146, s[60:61]
    v_cndmask_b32 v147, v8, v147, s[62:63]
    v_cmp_le_i32 s[56:57], 0, v9
    v_cmp_le_i32 s[58:59], 1, v9
    v_cmp_le_i32 s[60:61], 2, v9
    v_cmp_le_i32 s[62:63], 3, v9
    v_cndmask_b32 v148, v8, v148, s[56:57]
    v_cndmask_b32 v149, v8, v149, s[58:59]
    v_cndmask_b32 v150, v8, v150, s[60:61]
    v_cndmask_b32 v151, v8, v151, s[62:63]
    v_cmp_le_i32 s[56:57], 16, v10
    v_cmp_le_i32 s[58:59], 17, v10
    v_cmp_le_i32 s[60:61], 18, v10
    v_cmp_le_i32 s[62:63], 19, v10
    v_cndmask_b32 v152, v8, v152, s[56:57]
    v_cndmask_b32 v153, v8, v153, s[58:59]
    v_cndmask_b32 v154, v8, v154, s[60:61]
    v_cndmask_b32 v155, v8, v155, s[62:63]
    v_cmp_le_i32 s[56:57], 16, v9
    v_cmp_le_i32 s[58:59], 17, v9
    v_cmp_le_i32 s[60:61], 18, v9
    v_cmp_le_i32 s[62:63], 19, v9
    v_cndmask_b32 v156, v8, v156, s[56:57]
    v_cndmask_b32 v157, v8, v157, s[58:59]
    v_cndmask_b32 v158, v8, v158, s[60:61]
    v_cndmask_b32 v159, v8, v159, s[62:63]
    s_branch ka_kernel_mret_24
ka_kernel_mask_25:
    s_lshl_b32 s37, s51, 5
    v_subrev_u32 v10, s37, v7
    v_subrev_u32 v9, s37, v0
    v_cmp_le_i32 s[56:57], 0, v10
    v_cmp_le_i32 s[58:59], 1, v10
    v_cmp_le_i32 s[60:61], 2, v10
    v_cmp_le_i32 s[62:63], 3, v10
    v_cndmask_b32 v128, v8, v128, s[56:57]
    v_cndmask_b32 v129, v8, v129, s[58:59]
    v_cndmask_b32 v130, v8, v130, s[60:61]
    v_cndmask_b32 v131, v8, v131, s[62:63]
    v_cmp_le_i32 s[56:57], 0, v9
    v_cmp_le_i32 s[58:59], 1, v9
    v_cmp_le_i32 s[60:61], 2, v9
    v_cmp_le_i32 s[62:63], 3, v9
    v_cndmask_b32 v132, v8, v132, s[56:57]
    v_cndmask_b32 v133, v8, v133, s[58:59]
    v_cndmask_b32 v134, v8, v134, s[60:61]
    v_cndmask_b32 v135, v8, v135, s[62:63]
    v_cmp_le_i32 s[56:57], 16, v10
    v_cmp_le_i32 s[58:59], 17, v10
    v_cmp_le_i32 s[60:61], 18, v10
    v_cmp_le_i32 s[62:63], 19, v10
    v_cndmask_b32 v136, v8, v136, s[56:57]
    v_cndmask_b32 v137, v8, v137, s[58:59]
    v_cndmask_b32 v138, v8, v138, s[60:61]
    v_cndmask_b32 v139, v8, v139, s[62:63]
    v_cmp_le_i32 s[56:57], 16, v9
    v_cmp_le_i32 s[58:59], 17, v9
    v_cmp_le_i32 s[60:61], 18, v9
    v_cmp_le_i32 s[62:63], 19, v9
    v_cndmask_b32 v140, v8, v140, s[56:57]
    v_cndmask_b32 v141, v8, v141, s[58:59]
    v_cndmask_b32 v142, v8, v142, s[60:61]
    v_cndmask_b32 v143, v8, v143, s[62:63]
    s_branch ka_kernel_mret_26
ka_kernel_rare_27:
    s_nop 7
    v_max3_f32 v19, v144, v145, v146
    v_max3_f32 v19, v19, v147, v152
    v_max3_f32 v19, v19, v153, v154
    v_max3_f32 v19, v19, v155, 0
    v_mov_b32 v23, v19
    s_nop 1
    v_permlane16_swap_b32 v19, v23
    v_max_f32 v19, v19, v23
    v_mov_b32 v23, v19
    s_nop 1
    v_permlane32_swap_b32 v19, v23
    v_max_f32 v19, v19, v23
    v_sub_f32 v21, 0, v19
    v_exp_f32 v21, v21
    v_sub_f32 v144, v144, v19
    v_sub_f32 v145, v145, v19
    v_sub_f32 v146, v146, v19
    v_sub_f32 v147, v147, v19
    v_sub_f32 v152, v152, v19
    v_sub_f32 v153, v153, v19
    v_sub_f32 v154, v154, v19
    v_sub_f32 v155, v155, v19
    v_sub_f32 v128, v128, v19
    v_sub_f32 v129, v129, v19
    v_sub_f32 v130, v130, v19
    v_sub_f32 v131, v131, v19
    v_sub_f32 v136, v136, v19
    v_sub_f32 v137, v137, v19
    v_sub_f32 v138, v138, v19
    v_sub_f32 v139, v139, v19
    v_sub_f32 v104, v104, v19
    v_sub_f32 v105, v105, v19
    v_sub_f32 v106, v106, v19
    v_sub_f32 v107, v107, v19
    v_add_f32 v42, v42, v19
    v_mul_f32 v40, v40, v21
    v_mul_f32 v192, v192, v21
    v_mul_f32 v193, v193, v21
    v_mul_f32 v194, v194, v21
    v_mul_f32 v195, v195, v21
    v_mul_f32 v200, v200, v21
    v_mul_f32 v201, v201, v21
    v_mul_f32 v202, v202, v21
    v_mul_f32 v203, v203, v21
    v_mul_f32 v208, v208, v21
    v_mul_f32 v209, v209, v21
    v_mul_f32 v210, v210, v21
    v_mul_f32 v211, v211, v21
    v_mul_f32 v216, v216, v21
    v_mul_f32 v217, v217, v21
    v_mul_f32 v218, v218, v21
    v_mul_f32 v219, v219, v21
    v_mul_f32 v224, v224, v21
    v_mul_f32 v225, v225, v21
    v_mul_f32 v226, v226, v21
    v_mul_f32 v227, v227, v21
    v_mul_f32 v232, v232, v21
    v_mul_f32 v233, v233, v21
    v_mul_f32 v234, v234, v21
    v_mul_f32 v235, v235, v21
    v_mul_f32 v240, v240, v21
    v_mul_f32 v241, v241, v21
    v_mul_f32 v242, v242, v21
    v_mul_f32 v243, v243, v21
    v_mul_f32 v248, v248, v21
    v_mul_f32 v249, v249, v21
    v_mul_f32 v250, v250, v21
    v_mul_f32 v251, v251, v21
    v_max3_f32 v20, v148, v149, v150
    v_max3_f32 v20, v20, v151, v156
    v_max3_f32 v20, v20, v157, v158
    v_max3_f32 v20, v20, v159, 0
    v_mov_b32 v23, v20
    s_nop 1
    v_permlane16_swap_b32 v20, v23
    v_max_f32 v20, v20, v23
    v_mov_b32 v23, v20
    s_nop 1
    v_permlane32_swap_b32 v20, v23
    v_max_f32 v20, v20, v23
    v_sub_f32 v22, 0, v20
    v_exp_f32 v22, v22
    v_sub_f32 v148, v148, v20
    v_sub_f32 v149, v149, v20
    v_sub_f32 v150, v150, v20
    v_sub_f32 v151, v151, v20
    v_sub_f32 v156, v156, v20
    v_sub_f32 v157, v157, v20
    v_sub_f32 v158, v158, v20
    v_sub_f32 v159, v159, v20
    v_sub_f32 v132, v132, v20
    v_sub_f32 v133, v133, v20
    v_sub_f32 v134, v134, v20
    v_sub_f32 v135, v135, v20
    v_sub_f32 v140, v140, v20
    v_sub_f32 v141, v141, v20
    v_sub_f32 v142, v142, v20
    v_sub_f32 v143, v143, v20
    v_sub_f32 v108, v108, v20
    v_sub_f32 v109, v109, v20
    v_sub_f32 v110, v110, v20
    v_sub_f32 v111, v111, v20
    v_add_f32 v43, v43, v20
    v_mul_f32 v41, v41, v22
    v_mul_f32 v196, v196, v22
    v_mul_f32 v197, v197, v22
    v_mul_f32 v198, v198, v22
    v_mul_f32 v199, v199, v22
    v_mul_f32 v204, v204, v22
    v_mul_f32 v205, v205, v22
    v_mul_f32 v206, v206, v22
    v_mul_f32 v207, v207, v22
    v_mul_f32 v212, v212, v22
    v_mul_f32 v213, v213, v22
    v_mul_f32 v214, v214, v22
    v_mul_f32 v215, v215, v22
    v_mul_f32 v220, v220, v22
    v_mul_f32 v221, v221, v22
    v_mul_f32 v222, v222, v22
    v_mul_f32 v223, v223, v22
    v_mul_f32 v228, v228, v22
    v_mul_f32 v229, v229, v22
    v_mul_f32 v230, v230, v22
    v_mul_f32 v231, v231, v22
    v_mul_f32 v236, v236, v22
    v_mul_f32 v237, v237, v22
    v_mul_f32 v238, v238, v22
    v_mul_f32 v239, v239, v22
    v_mul_f32 v244, v244, v22
    v_mul_f32 v245, v245, v22
    v_mul_f32 v246, v246, v22
    v_mul_f32 v247, v247, v22
    v_mul_f32 v252, v252, v22
    v_mul_f32 v253, v253, v22
    v_mul_f32 v254, v254, v22
    v_mul_f32 v255, v255, v22
    v_exp_f32 v46, v144
    v_exp_f32 v47, v145
    v_exp_f32 v48, v146
    v_add_f32 v44, v46, v47
    v_exp_f32 v49, v147
    v_cvt_pk_bf16_f32 v120, v46, v47
    v_exp_f32 v50, v152
    v_add_f32 v44, v44, v48
    v_exp_f32 v51, v153
    v_cvt_pk_bf16_f32 v121, v48, v49
    v_add_f32 v44, v44, v49
    v_exp_f32 v52, v154
    v_add_f32 v44, v44, v50
    v_exp_f32 v53, v155
    v_cvt_pk_bf16_f32 v122, v50, v51
    v_add_f32 v44, v44, v51
    v_exp_f32 v46, v148
    v_add_f32 v44, v44, v52
    v_exp_f32 v47, v149
    v_cvt_pk_bf16_f32 v123, v52, v53
    v_add_f32 v44, v44, v53
    v_exp_f32 v48, v150
    v_add_f32 v45, v46, v47
    v_exp_f32 v49, v151
    v_cvt_pk_bf16_f32 v124, v46, v47
    v_exp_f32 v50, v156
    v_add_f32 v45, v45, v48
    v_exp_f32 v51, v157
    v_cvt_pk_bf16_f32 v125, v48, v49
    v_add_f32 v45, v45, v49
    v_exp_f32 v52, v158
    v_add_f32 v45, v45, v50
    v_exp_f32 v53, v159
    v_cvt_pk_bf16_f32 v126, v50, v51
    v_add_f32 v45, v45, v51
    s_nop 0
    v_add_f32 v45, v45, v52
    v_cvt_pk_bf16_f32 v127, v52, v53
    v_add_f32 v45, v45, v53
    s_nop 1
    s_branch ka_kernel_ret_28
ka_kernel_rare_29:
    s_nop 7
    v_max3_f32 v19, v128, v129, v130
    v_max3_f32 v19, v19, v131, v136
    v_max3_f32 v19, v19, v137, v138
    v_max3_f32 v19, v19, v139, 0
    v_mov_b32 v23, v19
    s_nop 1
    v_permlane16_swap_b32 v19, v23
    v_max_f32 v19, v19, v23
    v_mov_b32 v23, v19
    s_nop 1
    v_permlane32_swap_b32 v19, v23
    v_max_f32 v19, v19, v23
    v_sub_f32 v21, 0, v19
    v_exp_f32 v21, v21
    v_sub_f32 v128, v128, v19
    v_sub_f32 v129, v129, v19
    v_sub_f32 v130, v130, v19
    v_sub_f32 v131, v131, v19
    v_sub_f32 v136, v136, v19
    v_sub_f32 v137, v137, v19
    v_sub_f32 v138, v138, v19
    v_sub_f32 v139, v139, v19
    v_sub_f32 v144, v144, v19
    v_sub_f32 v145, v145, v19
    v_sub_f32 v146, v146, v19
    v_sub_f32 v147, v147, v19
    v_sub_f32 v152, v152, v19
    v_sub_f32 v153, v153, v19
    v_sub_f32 v154, v154, v19
    v_sub_f32 v155, v155, v19
    v_sub_f32 v104, v104, v19
    v_sub_f32 v105, v105, v19
    v_sub_f32 v106, v106, v19
    v_sub_f32 v107, v107, v19
    v_add_f32 v42, v42, v19
    v_mul_f32 v40, v40, v21
    v_mul_f32 v192, v192, v21
    v_mul_f32 v193, v193, v21
    v_mul_f32 v194, v194, v21
    v_mul_f32 v195, v195, v21
    v_mul_f32 v200, v200, v21
    v_mul_f32 v201, v201, v21
    v_mul_f32 v202, v202, v21
    v_mul_f32 v203, v203, v21
    v_mul_f32 v208, v208, v21
    v_mul_f32 v209, v209, v21
    v_mul_f32 v210, v210, v21
    v_mul_f32 v211, v211, v21
    v_mul_f32 v216, v216, v21
    v_mul_f32 v217, v217, v21
    v_mul_f32 v218, v218, v21
    v_mul_f32 v219, v219, v21
    v_mul_f32 v224, v224, v21
    v_mul_f32 v225, v225, v21
    v_mul_f32 v226, v226, v21
    v_mul_f32 v227, v227, v21
    v_mul_f32 v232, v232, v21
    v_mul_f32 v233, v233, v21
    v_mul_f32 v234, v234, v21
    v_mul_f32 v235, v235, v21
    v_mul_f32 v240, v240, v21
    v_mul_f32 v241, v241, v21
    v_mul_f32 v242, v242, v21
    v_mul_f32 v243, v243, v21
    v_mul_f32 v248, v248, v21
    v_mul_f32 v249, v249, v21
    v_mul_f32 v250, v250, v21
    v_mul_f32 v251, v251, v21
    v_max3_f32 v20, v132, v133, v134
    v_max3_f32 v20, v20, v135, v140
    v_max3_f32 v20, v20, v141, v142
    v_max3_f32 v20, v20, v143, 0
    v_mov_b32 v23, v20
    s_nop 1
    v_permlane16_swap_b32 v20, v23
    v_max_f32 v20, v20, v23
    v_mov_b32 v23, v20
    s_nop 1
    v_permlane32_swap_b32 v20, v23
    v_max_f32 v20, v20, v23
    v_sub_f32 v22, 0, v20
    v_exp_f32 v22, v22
    v_sub_f32 v132, v132, v20
    v_sub_f32 v133, v133, v20
    v_sub_f32 v134, v134, v20
    v_sub_f32 v135, v135, v20
    v_sub_f32 v140, v140, v20
    v_sub_f32 v141, v141, v20
    v_sub_f32 v142, v142, v20
    v_sub_f32 v143, v143, v20
    v_sub_f32 v148, v148, v20
    v_sub_f32 v149, v149, v20
    v_sub_f32 v150, v150, v20
    v_sub_f32 v151, v151, v20
    v_sub_f32 v156, v156, v20
    v_sub_f32 v157, v157, v20
    v_sub_f32 v158, v158, v20
    v_sub_f32 v159, v159, v20
    v_sub_f32 v108, v108, v20
    v_sub_f32 v109, v109, v20
    v_sub_f32 v110, v110, v20
    v_sub_f32 v111, v111, v20
    v_add_f32 v43, v43, v20
    v_mul_f32 v41, v41, v22
    v_mul_f32 v196, v196, v22
    v_mul_f32 v197, v197, v22
    v_mul_f32 v198, v198, v22
    v_mul_f32 v199, v199, v22
    v_mul_f32 v204, v204, v22
    v_mul_f32 v205, v205, v22
    v_mul_f32 v206, v206, v22
    v_mul_f32 v207, v207, v22
    v_mul_f32 v212, v212, v22
    v_mul_f32 v213, v213, v22
    v_mul_f32 v214, v214, v22
    v_mul_f32 v215, v215, v22
    v_mul_f32 v220, v220, v22
    v_mul_f32 v221, v221, v22
    v_mul_f32 v222, v222, v22
    v_mul_f32 v223, v223, v22
    v_mul_f32 v228, v228, v22
    v_mul_f32 v229, v229, v22
    v_mul_f32 v230, v230, v22
    v_mul_f32 v231, v231, v22
    v_mul_f32 v236, v236, v22
    v_mul_f32 v237, v237, v22
    v_mul_f32 v238, v238, v22
    v_mul_f32 v239, v239, v22
    v_mul_f32 v244, v244, v22
    v_mul_f32 v245, v245, v22
    v_mul_f32 v246, v246, v22
    v_mul_f32 v247, v247, v22
    v_mul_f32 v252, v252, v22
    v_mul_f32 v253, v253, v22
    v_mul_f32 v254, v254, v22
    v_mul_f32 v255, v255, v22
    v_exp_f32 v46, v128
    v_exp_f32 v47, v129
    v_exp_f32 v48, v130
    v_add_f32 v44, v46, v47
    v_exp_f32 v49, v131
    v_cvt_pk_bf16_f32 v112, v46, v47
    v_exp_f32 v50, v136
    v_add_f32 v44, v44, v48
    v_exp_f32 v51, v137
    v_cvt_pk_bf16_f32 v113, v48, v49
    v_add_f32 v44, v44, v49
    v_exp_f32 v52, v138
    v_add_f32 v44, v44, v50
    v_exp_f32 v53, v139
    v_cvt_pk_bf16_f32 v114, v50, v51
    v_add_f32 v44, v44, v51
    v_exp_f32 v46, v132
    v_add_f32 v44, v44, v52
    v_exp_f32 v47, v133
    v_cvt_pk_bf16_f32 v115, v52, v53
    v_add_f32 v44, v44, v53
    v_exp_f32 v48, v134
    v_add_f32 v45, v46, v47
    v_exp_f32 v49, v135
    v_cvt_pk_bf16_f32 v116, v46, v47
    v_exp_f32 v50, v140
    v_add_f32 v45, v45, v48
    v_exp_f32 v51, v141
    v_cvt_pk_bf16_f32 v117, v48, v49
    v_add_f32 v45, v45, v49
    v_exp_f32 v52, v142
    v_add_f32 v45, v45, v50
    v_exp_f32 v53, v143
    v_cvt_pk_bf16_f32 v118, v50, v51
    v_add_f32 v45, v45, v51
    s_nop 0
    v_add_f32 v45, v45, v52
    v_cvt_pk_bf16_f32 v119, v52, v53
    v_add_f32 v45, v45, v53
    s_nop 1
    s_branch ka_kernel_ret_30
ka_kernel_mask_31:
    s_lshl_b32 s37, s51, 5
    v_subrev_u32 v10, s37, v7
    v_subrev_u32 v9, s37, v0
    v_cmp_le_i32 s[56:57], 0, v10
    v_cmp_le_i32 s[58:59], 1, v10
    v_cmp_le_i32 s[60:61], 2, v10
    v_cmp_le_i32 s[62:63], 3, v10
    v_cndmask_b32 v144, v8, v144, s[56:57]
    v_cndmask_b32 v145, v8, v145, s[58:59]
    v_cndmask_b32 v146, v8, v146, s[60:61]
    v_cndmask_b32 v147, v8, v147, s[62:63]
    v_cmp_le_i32 s[56:57], 0, v9
    v_cmp_le_i32 s[58:59], 1, v9
    v_cmp_le_i32 s[60:61], 2, v9
    v_cmp_le_i32 s[62:63], 3, v9
    v_cndmask_b32 v148, v8, v148, s[56:57]
    v_cndmask_b32 v149, v8, v149, s[58:59]
    v_cndmask_b32 v150, v8, v150, s[60:61]
    v_cndmask_b32 v151, v8, v151, s[62:63]
    v_cmp_le_i32 s[56:57], 16, v10
    v_cmp_le_i32 s[58:59], 17, v10
    v_cmp_le_i32 s[60:61], 18, v10
    v_cmp_le_i32 s[62:63], 19, v10
    v_cndmask_b32 v152, v8, v152, s[56:57]
    v_cndmask_b32 v153, v8, v153, s[58:59]
    v_cndmask_b32 v154, v8, v154, s[60:61]
    v_cndmask_b32 v155, v8, v155, s[62:63]
    v_cmp_le_i32 s[56:57], 16, v9
    v_cmp_le_i32 s[58:59], 17, v9
    v_cmp_le_i32 s[60:61], 18, v9
    v_cmp_le_i32 s[62:63], 19, v9
    v_cndmask_b32 v156, v8, v156, s[56:57]
    v_cndmask_b32 v157, v8, v157, s[58:59]
    v_cndmask_b32 v158, v8, v158, s[60:61]
    v_cndmask_b32 v159, v8, v159, s[62:63]
    s_branch ka_kernel_mret_32
ka_kernel_rare_33:
    s_nop 7
    v_max3_f32 v19, v144, v145, v146
    v_max3_f32 v19, v19, v147, v152
    v_max3_f32 v19, v19, v153, v154
    v_max3_f32 v19, v19, v155, 0
    v_mov_b32 v23, v19
    s_nop 1
    v_permlane16_swap_b32 v19, v23
    v_max_f32 v19, v19, v23
    v_mov_b32 v23, v19
    s_nop 1
    v_permlane32_swap_b32 v19, v23
    v_max_f32 v19, v19, v23
    v_sub_f32 v21, 0, v19
    v_exp_f32 v21, v21
    v_sub_f32 v144, v144, v19
    v_sub_f32 v145, v145, v19
    v_sub_f32 v146, v146, v19
    v_sub_f32 v147, v147, v19
    v_sub_f32 v152, v152, v19
    v_sub_f32 v153, v153, v19
    v_sub_f32 v154, v154, v19
    v_sub_f32 v155, v155, v19
    v_sub_f32 v104, v104, v19
    v_sub_f32 v105, v105, v19
    v_sub_f32 v106, v106, v19
    v_sub_f32 v107, v107, v19
    v_add_f32 v42, v42, v19
    v_mul_f32 v40, v40, v21
    v_mul_f32 v192, v192, v21
    v_mul_f32 v193, v193, v21
    v_mul_f32 v194, v194, v21
    v_mul_f32 v195, v195, v21
    v_mul_f32 v200, v200, v21
    v_mul_f32 v201, v201, v21
    v_mul_f32 v202, v202, v21
    v_mul_f32 v203, v203, v21
    v_mul_f32 v208, v208, v21
    v_mul_f32 v209, v209, v21
    v_mul_f32 v210, v210, v21
    v_mul_f32 v211, v211, v21
    v_mul_f32 v216, v216, v21
    v_mul_f32 v217, v217, v21
    v_mul_f32 v218, v218, v21
    v_mul_f32 v219, v219, v21
    v_mul_f32 v224, v224, v21
    v_mul_f32 v225, v225, v21
    v_mul_f32 v226, v226, v21
    v_mul_f32 v227, v227, v21
    v_mul_f32 v232, v232, v21
    v_mul_f32 v233, v233, v21
    v_mul_f32 v234, v234, v21
    v_mul_f32 v235, v235, v21
    v_mul_f32 v240, v240, v21
    v_mul_f32 v241, v241, v21
    v_mul_f32 v242, v242, v21
    v_mul_f32 v243, v243, v21
    v_mul_f32 v248, v248, v21
    v_mul_f32 v249, v249, v21
    v_mul_f32 v250, v250, v21
    v_mul_f32 v251, v251, v21
    v_max3_f32 v20, v148, v149, v150
    v_max3_f32 v20, v20, v151, v156
    v_max3_f32 v20, v20, v157, v158
    v_max3_f32 v20, v20, v159, 0
    v_mov_b32 v23, v20
    s_nop 1
    v_permlane16_swap_b32 v20, v23
    v_max_f32 v20, v20, v23
    v_mov_b32 v23, v20
    s_nop 1
    v_permlane32_swap_b32 v20, v23
    v_max_f32 v20, v20, v23
    v_sub_f32 v22, 0, v20
    v_exp_f32 v22, v22
    v_sub_f32 v148, v148, v20
    v_sub_f32 v149, v149, v20
    v_sub_f32 v150, v150, v20
    v_sub_f32 v151, v151, v20
    v_sub_f32 v156, v156, v20
    v_sub_f32 v157, v157, v20
    v_sub_f32 v158, v158, v20
    v_sub_f32 v159, v159, v20
    v_sub_f32 v108, v108, v20
    v_sub_f32 v109, v109, v20
    v_sub_f32 v110, v110, v20
    v_sub_f32 v111, v111, v20
    v_add_f32 v43, v43, v20
    v_mul_f32 v41, v41, v22
    v_mul_f32 v196, v196, v22
    v_mul_f32 v197, v197, v22
    v_mul_f32 v198, v198, v22
    v_mul_f32 v199, v199, v22
    v_mul_f32 v204, v204, v22
    v_mul_f32 v205, v205, v22
    v_mul_f32 v206, v206, v22
    v_mul_f32 v207, v207, v22
    v_mul_f32 v212, v212, v22
    v_mul_f32 v213, v213, v22
    v_mul_f32 v214, v214, v22
    v_mul_f32 v215, v215, v22
    v_mul_f32 v220, v220, v22
    v_mul_f32 v221, v221, v22
    v_mul_f32 v222, v222, v22
    v_mul_f32 v223, v223, v22
    v_mul_f32 v228, v228, v22
    v_mul_f32 v229, v229, v22
    v_mul_f32 v230, v230, v22
    v_mul_f32 v231, v231, v22
    v_mul_f32 v236, v236, v22
    v_mul_f32 v237, v237, v22
    v_mul_f32 v238, v238, v22
    v_mul_f32 v239, v239, v22
    v_mul_f32 v244, v244, v22
    v_mul_f32 v245, v245, v22
    v_mul_f32 v246, v246, v22
    v_mul_f32 v247, v247, v22
    v_mul_f32 v252, v252, v22
    v_mul_f32 v253, v253, v22
    v_mul_f32 v254, v254, v22
    v_mul_f32 v255, v255, v22
    v_exp_f32 v46, v144
    v_exp_f32 v47, v145
    v_exp_f32 v48, v146
    v_add_f32 v44, v46, v47
    v_exp_f32 v49, v147
    v_cvt_pk_bf16_f32 v120, v46, v47
    v_exp_f32 v50, v152
    v_add_f32 v44, v44, v48
    v_exp_f32 v51, v153
    v_cvt_pk_bf16_f32 v121, v48, v49
    v_add_f32 v44, v44, v49
    v_exp_f32 v52, v154
    v_add_f32 v44, v44, v50
    v_exp_f32 v53, v155
    v_cvt_pk_bf16_f32 v122, v50, v51
    v_add_f32 v44, v44, v51
    v_exp_f32 v46, v148
    v_add_f32 v44, v44, v52
    v_exp_f32 v47, v149
    v_cvt_pk_bf16_f32 v123, v52, v53
    v_add_f32 v44, v44, v53
    v_exp_f32 v48, v150
    v_add_f32 v45, v46, v47
    v_exp_f32 v49, v151
    v_cvt_pk_bf16_f32 v124, v46, v47
    v_exp_f32 v50, v156
    v_add_f32 v45, v45, v48
    v_exp_f32 v51, v157
    v_cvt_pk_bf16_f32 v125, v48, v49
    v_add_f32 v45, v45, v49
    v_exp_f32 v52, v158
    v_add_f32 v45, v45, v50
    v_exp_f32 v53, v159
    v_cvt_pk_bf16_f32 v126, v50, v51
    v_add_f32 v45, v45, v51
    s_nop 0
    v_add_f32 v45, v45, v52
    v_cvt_pk_bf16_f32 v127, v52, v53
    v_add_f32 v45, v45, v53
    s_nop 1
    s_branch ka_kernel_ret_34
ka_kernel_side_35:
    s_cmp_eq_u32 s65, 1
    s_cbranch_scc1 ka_kernel_ev_83
    s_cmp_eq_u32 s65, 2
    s_cbranch_scc1 ka_kernel_ev_84
    s_cmp_eq_u32 s65, 3
    s_cbranch_scc1 ka_kernel_ev_85
    s_cmp_eq_u32 s65, 4
    s_cbranch_scc1 ka_kernel_ev_86
    s_cmp_eq_u32 s65, 5
    s_cbranch_scc1 ka_kernel_ev_87
    s_add_u32 s64, s64, 2
    s_mov_b32 s65, 1
    s_load_dwordx8 s[56:63], s[0:1], 0
    s_and_b32 s67, s2, 7
    s_lshl_b32 s67, s67, 3
    s_lshr_b32 s37, s2, 5
    s_add_u32 s67, s67, s37
    s_bfe_u32 s37, s2, 0x20003
    s_mul_i32 s38, s37, 9
    s_add_u32 s38, s38, 1
    s_lshr_b32 s38, s38, 1
    s_add_u32 s68, s38, s32
    s_and_b32 s38, s37, 1
    s_sub_u32 s38, 5, s38
    s_cmp_lt_u32 s32, s38
    s_cselect_b32 s66, 1, 0
    s_waitcnt lgkmcnt(0)
    s_cmp_eq_u32 s66, 0
    s_cbranch_scc1 ka_kernel_sle_88
    s_mov_b32 s24, s56
    s_and_b32 s25, s57, 0xffff
    s_mov_b32 s26, 2359296
    s_mov_b32 s27, 0x20000
    s_mov_b32 s8, s58
    s_and_b32 s9, s59, 0xffff
    s_mov_b32 s10, 2359296
    s_mov_b32 s11, 0x20000
    s_mov_b32 s12, s60
    s_and_b32 s13, s61, 0xffff
    s_mov_b32 s14, 2359296
    s_mov_b32 s15, 0x20000
    s_mov_b32 s60, s62
    s_and_b32 s61, s63, 0xffff
    s_mov_b32 s62, 4608
    s_mov_b32 s63, 0x20000
    v_lshrrev_b32 v19, 4, v1
    v_and_b32 v20, 15, v1
    s_lshl_b32 s37, s67, 5
    v_lshl_add_u32 v19, v19, 3, s37
    v_mul_u32_u24 v19, 1152, v19
    v_lshl_add_u32 v19, v20, 2, v19
    s_lshl_b32 s37, s68, 6
    v_add_u32 v19, s37, v19
    v_add_u32 v21, 4294963840, v19
    v_add_u32 v22, 4608, v19
    v_lshlrev_b32 v20, 4, v20
    s_lshl_b32 s37, s68, 8
    buffer_load_dword v54, v21, s[8:11], 0 offen offset:0
    buffer_load_dword v55, v21, s[8:11], 0 offen offset:1152
    buffer_load_dword v56, v21, s[8:11], 0 offen offset:2304
    buffer_load_dword v57, v19, s[8:11], 0 offen offset:0
    buffer_load_dword v58, v19, s[8:11], 0 offen offset:1152
    buffer_load_dword v59, v19, s[8:11], 0 offen offset:2304
    buffer_load_dword v60, v19, s[8:11], 0 offen offset:3456
    buffer_load_dword v61, v22, s[8:11], 0 offen offset:0
    buffer_load_dword v62, v22, s[8:11], 0 offen offset:1152
    buffer_load_dword v63, v22, s[8:11], 0 offen offset:2304
    buffer_load_dword v64, v22, s[8:11], 0 offen offset:3456
    buffer_load_dword v28, v19, s[12:15], 0 offen offset:0
    buffer_load_dword v29, v19, s[12:15], 0 offen offset:1152
    buffer_load_dword v30, v19, s[12:15], 0 offen offset:2304
    buffer_load_dword v31, v19, s[12:15], 0 offen offset:3456
    buffer_load_dword v32, v22, s[12:15], 0 offen offset:0
    buffer_load_dword v33, v22, s[12:15], 0 offen offset:1152
    buffer_load_dword v34, v22, s[12:15], 0 offen offset:2304
    buffer_load_dword v35, v22, s[12:15], 0 offen offset:3456
    buffer_load_dword v11, v19, s[24:27], 0 offen offset:0
    buffer_load_dword v12, v19, s[24:27], 0 offen offset:1152
    buffer_load_dword v13, v19, s[24:27], 0 offen offset:2304
    buffer_load_dword v14, v19, s[24:27], 0 offen offset:3456
    buffer_load_dword v15, v22, s[24:27], 0 offen offset:0
    buffer_load_dword v16, v22, s[24:27], 0 offen offset:1152
    buffer_load_dword v17, v22, s[24:27], 0 offen offset:2304
    buffer_load_dword v18, v22, s[24:27], 0 offen offset:3456
    buffer_load_dwordx4 v[36:39], v20, s[60:63], s37 offen
ka_kernel_sle_88:
    s_branch ka_kernel_sret_36
ka_kernel_ev_83:
    s_mov_b32 s64, 99
    s_cmp_eq_u32 s66, 0
    s_cbranch_scc1 ka_kernel_sce_90
    s_mov_b32 s38, 0x05040100
    s_mov_b32 s39, 0x07060302
    v_lshrrev_b32 v19, 4, v1
    v_and_b32 v20, 15, v1
    s_add_u32 s70, s6, 58720256
    s_addc_u32 s71, s7, 0
    s_mov_b32 s8, s70
    s_and_b32 s9, s71, 0xffff
    s_mov_b32 s10, 2359296
    s_mov_b32 s11, 0x20000
    s_add_u32 s70, s6, 62914560
    s_addc_u32 s71, s7, 0
    s_mov_b32 s12, s70
    s_and_b32 s13, s71, 0xffff
    s_mov_b32 s14, 2359296
    s_mov_b32 s15, 0x20000
    s_lshl_b32 s37, s67, 6
    v_lshl_add_u32 v19, v19, 4, s37
    v_lshlrev_b32 v20, 13, v20
    v_sub_u32 v21, 4080, v19
    v_add_u32 v21, v21, v20
    v_add_u32 v19, v19, v20
    s_lshl_b32 s37, s68, 17
    v_perm_b32 v68, v12, v11, s38
    v_perm_b32 v69, v14, v13, s38
    v_perm_b32 v70, v16, v15, s38
    v_perm_b32 v71, v18, v17, s38
    buffer_store_dwordx4 v[68:71], v19, s[12:15], s37 offen sc1
    v_perm_b32 v46, v58, v59, s38
    v_perm_b32 v47, v59, v60, s38
    v_perm_b32 v48, v60, v61, s38
    v_perm_b32 v49, v61, v62, s38
    v_perm_b32 v50, v62, v63, s38
    v_perm_b32 v51, v63, v64, s38
    v_dot2_f32_bf16 v22, v48, v36, 0
    v_dot2_f32_bf16 v23, v49, v36, 0
    v_dot2_f32_bf16 v24, v50, v36, 0
    v_dot2_f32_bf16 v25, v51, v36, 0
    v_dot2_f32_bf16 v22, v46, v37, v22
    v_dot2_f32_bf16 v23, v47, v37, v23
    v_dot2_f32_bf16 v24, v48, v37, v24
    v_dot2_f32_bf16 v25, v49, v37, v25
    v_lshlrev_b32 v46, 16, v32
    v_lshlrev_b32 v47, 16, v33
    v_lshlrev_b32 v48, 16, v34
    v_lshlrev_b32 v49, 16, v35
    v_mul_f32 v22, v22, v46
    v_mul_f32 v23, v23, v47
    v_mul_f32 v24, v24, v48
    v_mul_f32 v25, v25, v49
    v_cvt_pk_bf16_f32 v68, v25, v24
    v_cvt_pk_bf16_f32 v69, v23, v22
    v_perm_b32 v46, v54, v55, s38
    v_perm_b32 v47, v55, v56, s38
    v_perm_b32 v48, v56, v57, s38
    v_perm_b32 v49, v57, v58, s38
    v_perm_b32 v50, v58, v59, s38
    v_perm_b32 v51, v59, v60, s38
    v_dot2_f32_bf16 v22, v48, v36, 0
    v_dot2_f32_bf16 v23, v49, v36, 0
    v_dot2_f32_bf16 v24, v50, v36, 0
    v_dot2_f32_bf16 v25, v51, v36, 0
    v_dot2_f32_bf16 v22, v46, v37, v22
    v_dot2_f32_bf16 v23, v47, v37, v23
    v_dot2_f32_bf16 v24, v48, v37, v24
    v_dot2_f32_bf16 v25, v49, v37, v25
    v_lshlrev_b32 v46, 16, v28
    v_lshlrev_b32 v47, 16, v29
    v_lshlrev_b32 v48, 16, v30
    v_lshlrev_b32 v49, 16, v31
    v_mul_f32 v22, v22, v46
    v_mul_f32 v23, v23, v47
    v_mul_f32 v24, v24, v48
    v_mul_f32 v25, v25, v49
    v_cvt_pk_bf16_f32 v70, v25, v24
    v_cvt_pk_bf16_f32 v71, v23, v22
    buffer_store_dwordx4 v[68:71], v21, s[8:11], s37 offen sc1
    s_add_u32 s37, s37, 4096
    s_nop 0
    v_perm_b32 v68, v12, v11, s39
    v_perm_b32 v69, v14, v13, s39
    v_perm_b32 v70, v16, v15, s39
    v_perm_b32 v71, v18, v17, s39
    buffer_store_dwordx4 v[68:71], v19, s[12:15], s37 offen sc1
    v_perm_b32 v46, v58, v59, s39
    v_perm_b32 v47, v59, v60, s39
    v_perm_b32 v48, v60, v61, s39
    v_perm_b32 v49, v61, v62, s39
    v_perm_b32 v50, v62, v63, s39
    v_perm_b32 v51, v63, v64, s39
    v_dot2_f32_bf16 v22, v48, v38, 0
    v_dot2_f32_bf16 v23, v49, v38, 0
    v_dot2_f32_bf16 v24, v50, v38, 0
    v_dot2_f32_bf16 v25, v51, v38, 0
    v_dot2_f32_bf16 v22, v46, v39, v22
    v_dot2_f32_bf16 v23, v47, v39, v23
    v_dot2_f32_bf16 v24, v48, v39, v24
    v_dot2_f32_bf16 v25, v49, v39, v25
    v_and_b32 v46, 0xffff0000, v32
    v_and_b32 v47, 0xffff0000, v33
    v_and_b32 v48, 0xffff0000, v34
    v_and_b32 v49, 0xffff0000, v35
    v_mul_f32 v22, v22, v46
    v_mul_f32 v23, v23, v47
    v_mul_f32 v24, v24, v48
    v_mul_f32 v25, v25, v49
    v_cvt_pk_bf16_f32 v68, v25, v24
    v_cvt_pk_bf16_f32 v69, v23, v22
    v_perm_b32 v46, v54, v55, s39
    v_perm_b32 v47, v55, v56, s39
    v_perm_b32 v48, v56, v57, s39
    v_perm_b32 v49, v57, v58, s39
    v_perm_b32 v50, v58, v59, s39
    v_perm_b32 v51, v59, v60, s39
    v_dot2_f32_bf16 v22, v48, v38, 0
    v_dot2_f32_bf16 v23, v49, v38, 0
    v_dot2_f32_bf16 v24, v50, v38, 0
    v_dot2_f32_bf16 v25, v51, v38, 0
    v_dot2_f32_bf16 v22, v46, v39, v22
    v_dot2_f32_bf16 v23, v47, v39, v23
    v_dot2_f32_bf16 v24, v48, v39, v24
    v_dot2_f32_bf16 v25, v49, v39, v25
    v_and_b32 v46, 0xffff0000, v28
    v_and_b32 v47, 0xffff0000, v29
    v_and_b32 v48, 0xffff0000, v30
    v_and_b32 v49, 0xffff0000, v31
    v_mul_f32 v22, v22, v46
    v_mul_f32 v23, v23, v47
    v_mul_f32 v24, v24, v48
    v_mul_f32 v25, v25, v49
    v_cvt_pk_bf16_f32 v70, v25, v24
    v_cvt_pk_bf16_f32 v71, v23, v22
    buffer_store_dwordx4 v[68:71], v21, s[8:11], s37 offen sc1
    s_add_u32 s37, s37, 4096
    s_nop 0
ka_kernel_sce_90:
    s_branch ka_kernel_sret_36
ka_kernel_ev_84:
ka_kernel_ev_85:
    s_mov_b32 s65, 4
    s_lshl_b32 s38, s34, 1
    s_add_u32 s38, s38, 4
    s_add_u32 s64, s64, 1
    s_max_u32 s64, s64, s38
    v_mov_b32 v19, s69
    v_mov_b32 v20, 0
    s_lshl_b32 s38, s2, 2
    s_add_u32 s38, s38, 32768
    s_mov_b64 exec, 1
    buffer_store_dword v19, v20, s[72:75], s38 offen sc1
    s_mov_b64 exec, -1
    s_branch ka_kernel_sret_36
ka_kernel_ev_87:
    s_load_dwordx2 s[8:9], s[0:1], 88
    s_load_dwordx2 s[10:11], s[0:1], 32
    s_mov_b32 s64, 99
    v_lshlrev_b32 v19, 7, v1
    s_lshl_b32 s37, s2, 13
    v_add_u32 v19, s37, v19
    s_min_u32 s38, s2, 63
    s_min_u32 s39, s2, 31
    s_sub_u32 s38, s38, s2
    s_sub_u32 s39, s39, s2
    s_lshl_b32 s38, s38, 13
    s_lshl_b32 s39, s39, 13
    v_add_u32 v20, 2097152, v19
    v_add_u32 v21, s38, v20
    v_add_u32 v21, 2097152, v21
    v_add_u32 v22, s39, v20
    s_waitcnt lgkmcnt(0)
    global_load_dword v3, v19, s[8:9]
    global_load_dword v3, v20, s[8:9]
    global_load_dword v3, v21, s[8:9]
    global_load_dword v3, v19, s[10:11]
    global_load_dword v3, v22, s[10:11]
    s_branch ka_kernel_sret_36
ka_kernel_ev_86:
    s_mov_b32 s64, 99
    v_mov_b32 v19, s69
    v_mov_b32 v20, 0
    s_lshl_b32 s38, s34, 7
    s_lshl_b32 s39, s33, 2
    s_add_u32 s38, s38, s39
    s_add_u32 s38, s38, 36864
    s_mov_b64 exec, 1
    buffer_store_dword v19, v20, s[72:75], s38 offen sc1
    s_mov_b64 exec, -1
    s_branch ka_kernel_sret_36
ka_kernel_mask_37:
    s_lshl_b32 s37, s51, 5
    v_subrev_u32 v10, s37, v7
    v_subrev_u32 v9, s37, v0
    v_cmp_le_i32 s[56:57], 0, v10
    v_cmp_le_i32 s[58:59], 1, v10
    v_cmp_le_i32 s[60:61], 2, v10
    v_cmp_le_i32 s[62:63], 3, v10
    v_cndmask_b32 v144, v8, v144, s[56:57]
    v_cndmask_b32 v145, v8, v145, s[58:59]
    v_cndmask_b32 v146, v8, v146, s[60:61]
    v_cndmask_b32 v147, v8, v147, s[62:63]
    v_cmp_le_i32 s[56:57], 0, v9
    v_cmp_le_i32 s[58:59], 1, v9
    v_cmp_le_i32 s[60:61], 2, v9
    v_cmp_le_i32 s[62:63], 3, v9
    v_cndmask_b32 v148, v8, v148, s[56:57]
    v_cndmask_b32 v149, v8, v149, s[58:59]
    v_cndmask_b32 v150, v8, v150, s[60:61]
    v_cndmask_b32 v151, v8, v151, s[62:63]
    v_cmp_le_i32 s[56:57], 16, v10
    v_cmp_le_i32 s[58:59], 17, v10
    v_cmp_le_i32 s[60:61], 18, v10
    v_cmp_le_i32 s[62:63], 19, v10
    v_cndmask_b32 v152, v8, v152, s[56:57]
    v_cndmask_b32 v153, v8, v153, s[58:59]
    v_cndmask_b32 v154, v8, v154, s[60:61]
    v_cndmask_b32 v155, v8, v155, s[62:63]
    v_cmp_le_i32 s[56:57], 16, v9
    v_cmp_le_i32 s[58:59], 17, v9
    v_cmp_le_i32 s[60:61], 18, v9
    v_cmp_le_i32 s[62:63], 19, v9
    v_cndmask_b32 v156, v8, v156, s[56:57]
    v_cndmask_b32 v157, v8, v157, s[58:59]
    v_cndmask_b32 v158, v8, v158, s[60:61]
    v_cndmask_b32 v159, v8, v159, s[62:63]
    s_branch ka_kernel_mret_38
ka_kernel_mask_39:
    s_lshl_b32 s37, s51, 5
    v_subrev_u32 v10, s37, v7
    v_subrev_u32 v9, s37, v0
    v_cmp_le_i32 s[56:57], 0, v10
    v_cmp_le_i32 s[58:59], 1, v10
    v_cmp_le_i32 s[60:61], 2, v10
    v_cmp_le_i32 s[62:63], 3, v10
    v_cndmask_b32 v128, v8, v128, s[56:57]
    v_cndmask_b32 v129, v8, v129, s[58:59]
    v_cndmask_b32 v130, v8, v130, s[60:61]
    v_cndmask_b32 v131, v8, v131, s[62:63]
    v_cmp_le_i32 s[56:57], 0, v9
    v_cmp_le_i32 s[58:59], 1, v9
    v_cmp_le_i32 s[60:61], 2, v9
    v_cmp_le_i32 s[62:63], 3, v9
    v_cndmask_b32 v132, v8, v132, s[56:57]
    v_cndmask_b32 v133, v8, v133, s[58:59]
    v_cndmask_b32 v134, v8, v134, s[60:61]
    v_cndmask_b32 v135, v8, v135, s[62:63]
    v_cmp_le_i32 s[56:57], 16, v10
    v_cmp_le_i32 s[58:59], 17, v10
    v_cmp_le_i32 s[60:61], 18, v10
    v_cmp_le_i32 s[62:63], 19, v10
    v_cndmask_b32 v136, v8, v136, s[56:57]
    v_cndmask_b32 v137, v8, v137, s[58:59]
    v_cndmask_b32 v138, v8, v138, s[60:61]
    v_cndmask_b32 v139, v8, v139, s[62:63]
    v_cmp_le_i32 s[56:57], 16, v9
    v_cmp_le_i32 s[58:59], 17, v9
    v_cmp_le_i32 s[60:61], 18, v9
    v_cmp_le_i32 s[62:63], 19, v9
    v_cndmask_b32 v140, v8, v140, s[56:57]
    v_cndmask_b32 v141, v8, v141, s[58:59]
    v_cndmask_b32 v142, v8, v142, s[60:61]
    v_cndmask_b32 v143, v8, v143, s[62:63]
    s_branch ka_kernel_mret_40
ka_kernel_rare_41:
    s_nop 7
    v_max3_f32 v19, v144, v145, v146
    v_max3_f32 v19, v19, v147, v152
    v_max3_f32 v19, v19, v153, v154
    v_max3_f32 v19, v19, v155, 0
    v_mov_b32 v23, v19
    s_nop 1
    v_permlane16_swap_b32 v19, v23
    v_max_f32 v19, v19, v23
    v_mov_b32 v23, v19
    s_nop 1
    v_permlane32_swap_b32 v19, v23
    v_max_f32 v19, v19, v23
    v_sub_f32 v21, 0, v19
    v_exp_f32 v21, v21
    v_sub_f32 v144, v144, v19
    v_sub_f32 v145, v145, v19
    v_sub_f32 v146, v146, v19
    v_sub_f32 v147, v147, v19
    v_sub_f32 v152, v152, v19
    v_sub_f32 v153, v153, v19
    v_sub_f32 v154, v154, v19
    v_sub_f32 v155, v155, v19
    v_sub_f32 v128, v128, v19
    v_sub_f32 v129, v129, v19
    v_sub_f32 v130, v130, v19
    v_sub_f32 v131, v131, v19
    v_sub_f32 v136, v136, v19
    v_sub_f32 v137, v137, v19
    v_sub_f32 v138, v138, v19
    v_sub_f32 v139, v139, v19
    v_sub_f32 v104, v104, v19
    v_sub_f32 v105, v105, v19
    v_sub_f32 v106, v106, v19
    v_sub_f32 v107, v107, v19
    v_add_f32 v42, v42, v19
    v_mul_f32 v40, v40, v21
    v_mul_f32 v192, v192, v21
    v_mul_f32 v193, v193, v21
    v_mul_f32 v194, v194, v21
    v_mul_f32 v195, v195, v21
    v_mul_f32 v200, v200, v21
    v_mul_f32 v201, v201, v21
    v_mul_f32 v202, v202, v21
    v_mul_f32 v203, v203, v21
    v_mul_f32 v208, v208, v21
    v_mul_f32 v209, v209, v21
    v_mul_f32 v210, v210, v21
    v_mul_f32 v211, v211, v21
    v_mul_f32 v216, v216, v21
    v_mul_f32 v217, v217, v21
    v_mul_f32 v218, v218, v21
    v_mul_f32 v219, v219, v21
    v_mul_f32 v224, v224, v21
    v_mul_f32 v225, v225, v21
    v_mul_f32 v226, v226, v21
    v_mul_f32 v227, v227, v21
    v_mul_f32 v232, v232, v21
    v_mul_f32 v233, v233, v21
    v_mul_f32 v234, v234, v21
    v_mul_f32 v235, v235, v21
    v_mul_f32 v240, v240, v21
    v_mul_f32 v241, v241, v21
    v_mul_f32 v242, v242, v21
    v_mul_f32 v243, v243, v21
    v_mul_f32 v248, v248, v21
    v_mul_f32 v249, v249, v21
    v_mul_f32 v250, v250, v21
    v_mul_f32 v251, v251, v21
    v_max3_f32 v20, v148, v149, v150
    v_max3_f32 v20, v20, v151, v156
    v_max3_f32 v20, v20, v157, v158
    v_max3_f32 v20, v20, v159, 0
    v_mov_b32 v23, v20
    s_nop 1
    v_permlane16_swap_b32 v20, v23
    v_max_f32 v20, v20, v23
    v_mov_b32 v23, v20
    s_nop 1
    v_permlane32_swap_b32 v20, v23
    v_max_f32 v20, v20, v23
    v_sub_f32 v22, 0, v20
    v_exp_f32 v22, v22
    v_sub_f32 v148, v148, v20
    v_sub_f32 v149, v149, v20
    v_sub_f32 v150, v150, v20
    v_sub_f32 v151, v151, v20
    v_sub_f32 v156, v156, v20
    v_sub_f32 v157, v157, v20
    v_sub_f32 v158, v158, v20
    v_sub_f32 v159, v159, v20
    v_sub_f32 v132, v132, v20
    v_sub_f32 v133, v133, v20
    v_sub_f32 v134, v134, v20
    v_sub_f32 v135, v135, v20
    v_sub_f32 v140, v140, v20
    v_sub_f32 v141, v141, v20
    v_sub_f32 v142, v142, v20
    v_sub_f32 v143, v143, v20
    v_sub_f32 v108, v108, v20
    v_sub_f32 v109, v109, v20
    v_sub_f32 v110, v110, v20
    v_sub_f32 v111, v111, v20
    v_add_f32 v43, v43, v20
    v_mul_f32 v41, v41, v22
    v_mul_f32 v196, v196, v22
    v_mul_f32 v197, v197, v22
    v_mul_f32 v198, v198, v22
    v_mul_f32 v199, v199, v22
    v_mul_f32 v204, v204, v22
    v_mul_f32 v205, v205, v22
    v_mul_f32 v206, v206, v22
    v_mul_f32 v207, v207, v22
    v_mul_f32 v212, v212, v22
    v_mul_f32 v213, v213, v22
    v_mul_f32 v214, v214, v22
    v_mul_f32 v215, v215, v22
    v_mul_f32 v220, v220, v22
    v_mul_f32 v221, v221, v22
    v_mul_f32 v222, v222, v22
    v_mul_f32 v223, v223, v22
    v_mul_f32 v228, v228, v22
    v_mul_f32 v229, v229, v22
    v_mul_f32 v230, v230, v22
    v_mul_f32 v231, v231, v22
    v_mul_f32 v236, v236, v22
    v_mul_f32 v237, v237, v22
    v_mul_f32 v238, v238, v22
    v_mul_f32 v239, v239, v22
    v_mul_f32 v244, v244, v22
    v_mul_f32 v245, v245, v22
    v_mul_f32 v246, v246, v22
    v_mul_f32 v247, v247, v22
    v_mul_f32 v252, v252, v22
    v_mul_f32 v253, v253, v22
    v_mul_f32 v254, v254, v22
    v_mul_f32 v255, v255, v22
    v_exp_f32 v46, v144
    v_exp_f32 v47, v145
    v_exp_f32 v48, v146
    v_add_f32 v44, v46, v47
    v_exp_f32 v49, v147
    v_cvt_pk_bf16_f32 v120, v46, v47
    v_exp_f32 v50, v152
    v_add_f32 v44, v44, v48
    v_exp_f32 v51, v153
    v_cvt_pk_bf16_f32 v121, v48, v49
    v_add_f32 v44, v44, v49
    v_exp_f32 v52, v154
    v_add_f32 v44, v44, v50
    v_exp_f32 v53, v155
    v_cvt_pk_bf16_f32 v122, v50, v51
    v_add_f32 v44, v44, v51
    v_exp_f32 v46, v148
    v_add_f32 v44, v44, v52
    v_exp_f32 v47, v149
    v_cvt_pk_bf16_f32 v123, v52, v53
    v_add_f32 v44, v44, v53
    v_exp_f32 v48, v150
    v_add_f32 v45, v46, v47
    v_exp_f32 v49, v151
    v_cvt_pk_bf16_f32 v124, v46, v47
    v_exp_f32 v50, v156
    v_add_f32 v45, v45, v48
    v_exp_f32 v51, v157
    v_cvt_pk_bf16_f32 v125, v48, v49
    v_add_f32 v45, v45, v49
    v_exp_f32 v52, v158
    v_add_f32 v45, v45, v50
    v_exp_f32 v53, v159
    v_cvt_pk_bf16_f32 v126, v50, v51
    v_add_f32 v45, v45, v51
    s_nop 0
    v_add_f32 v45, v45, v52
    v_cvt_pk_bf16_f32 v127, v52, v53
    v_add_f32 v45, v45, v53
    s_nop 1
    s_branch ka_kernel_ret_42
ka_kernel_rare_43:
    s_nop 7
    v_max3_f32 v19, v128, v129, v130
    v_max3_f32 v19, v19, v131, v136
    v_max3_f32 v19, v19, v137, v138
    v_max3_f32 v19, v19, v139, 0
    v_mov_b32 v23, v19
    s_nop 1
    v_permlane16_swap_b32 v19, v23
    v_max_f32 v19, v19, v23
    v_mov_b32 v23, v19
    s_nop 1
    v_permlane32_swap_b32 v19, v23
    v_max_f32 v19, v19, v23
    v_sub_f32 v21, 0, v19
    v_exp_f32 v21, v21
    v_sub_f32 v128, v128, v19
    v_sub_f32 v129, v129, v19
    v_sub_f32 v130, v130, v19
    v_sub_f32 v131, v131, v19
    v_sub_f32 v136, v136, v19
    v_sub_f32 v137, v137, v19
    v_sub_f32 v138, v138, v19
    v_sub_f32 v139, v139, v19
    v_sub_f32 v144, v144, v19
    v_sub_f32 v145, v145, v19
    v_sub_f32 v146, v146, v19
    v_sub_f32 v147, v147, v19
    v_sub_f32 v152, v152, v19
    v_sub_f32 v153, v153, v19
    v_sub_f32 v154, v154, v19
    v_sub_f32 v155, v155, v19
    v_sub_f32 v104, v104, v19
    v_sub_f32 v105, v105, v19
    v_sub_f32 v106, v106, v19
    v_sub_f32 v107, v107, v19
    v_add_f32 v42, v42, v19
    v_mul_f32 v40, v40, v21
    v_mul_f32 v192, v192, v21
    v_mul_f32 v193, v193, v21
    v_mul_f32 v194, v194, v21
    v_mul_f32 v195, v195, v21
    v_mul_f32 v200, v200, v21
    v_mul_f32 v201, v201, v21
    v_mul_f32 v202, v202, v21
    v_mul_f32 v203, v203, v21
    v_mul_f32 v208, v208, v21
    v_mul_f32 v209, v209, v21
    v_mul_f32 v210, v210, v21
    v_mul_f32 v211, v211, v21
    v_mul_f32 v216, v216, v21
    v_mul_f32 v217, v217, v21
    v_mul_f32 v218, v218, v21
    v_mul_f32 v219, v219, v21
    v_mul_f32 v224, v224, v21
    v_mul_f32 v225, v225, v21
    v_mul_f32 v226, v226, v21
    v_mul_f32 v227, v227, v21
    v_mul_f32 v232, v232, v21
    v_mul_f32 v233, v233, v21
    v_mul_f32 v234, v234, v21
    v_mul_f32 v235, v235, v21
    v_mul_f32 v240, v240, v21
    v_mul_f32 v241, v241, v21
    v_mul_f32 v242, v242, v21
    v_mul_f32 v243, v243, v21
    v_mul_f32 v248, v248, v21
    v_mul_f32 v249, v249, v21
    v_mul_f32 v250, v250, v21
    v_mul_f32 v251, v251, v21
    v_max3_f32 v20, v132, v133, v134
    v_max3_f32 v20, v20, v135, v140
    v_max3_f32 v20, v20, v141, v142
    v_max3_f32 v20, v20, v143, 0
    v_mov_b32 v23, v20
    s_nop 1
    v_permlane16_swap_b32 v20, v23
    v_max_f32 v20, v20, v23
    v_mov_b32 v23, v20
    s_nop 1
    v_permlane32_swap_b32 v20, v23
    v_max_f32 v20, v20, v23
    v_sub_f32 v22, 0, v20
    v_exp_f32 v22, v22
    v_sub_f32 v132, v132, v20
    v_sub_f32 v133, v133, v20
    v_sub_f32 v134, v134, v20
    v_sub_f32 v135, v135, v20
    v_sub_f32 v140, v140, v20
    v_sub_f32 v141, v141, v20
    v_sub_f32 v142, v142, v20
    v_sub_f32 v143, v143, v20
    v_sub_f32 v148, v148, v20
    v_sub_f32 v149, v149, v20
    v_sub_f32 v150, v150, v20
    v_sub_f32 v151, v151, v20
    v_sub_f32 v156, v156, v20
    v_sub_f32 v157, v157, v20
    v_sub_f32 v158, v158, v20
    v_sub_f32 v159, v159, v20
    v_sub_f32 v108, v108, v20
    v_sub_f32 v109, v109, v20
    v_sub_f32 v110, v110, v20
    v_sub_f32 v111, v111, v20
    v_add_f32 v43, v43, v20
    v_mul_f32 v41, v41, v22
    v_mul_f32 v196, v196, v22
    v_mul_f32 v197, v197, v22
    v_mul_f32 v198, v198, v22
    v_mul_f32 v199, v199, v22
    v_mul_f32 v204, v204, v22
    v_mul_f32 v205, v205, v22
    v_mul_f32 v206, v206, v22
    v_mul_f32 v207, v207, v22
    v_mul_f32 v212, v212, v22
    v_mul_f32 v213, v213, v22
    v_mul_f32 v214, v214, v22
    v_mul_f32 v215, v215, v22
    v_mul_f32 v220, v220, v22
    v_mul_f32 v221, v221, v22
    v_mul_f32 v222, v222, v22
    v_mul_f32 v223, v223, v22
    v_mul_f32 v228, v228, v22
    v_mul_f32 v229, v229, v22
    v_mul_f32 v230, v230, v22
    v_mul_f32 v231, v231, v22
    v_mul_f32 v236, v236, v22
    v_mul_f32 v237, v237, v22
    v_mul_f32 v238, v238, v22
    v_mul_f32 v239, v239, v22
    v_mul_f32 v244, v244, v22
    v_mul_f32 v245, v245, v22
    v_mul_f32 v246, v246, v22
    v_mul_f32 v247, v247, v22
    v_mul_f32 v252, v252, v22
    v_mul_f32 v253, v253, v22
    v_mul_f32 v254, v254, v22
    v_mul_f32 v255, v255, v22
    v_exp_f32 v46, v128
    v_exp_f32 v47, v129
    v_exp_f32 v48, v130
    v_add_f32 v44, v46, v47
    v_exp_f32 v49, v131
    v_cvt_pk_bf16_f32 v112, v46, v47
    v_exp_f32 v50, v136
    v_add_f32 v44, v44, v48
    v_exp_f32 v51, v137
    v_cvt_pk_bf16_f32 v113, v48, v49
    v_add_f32 v44, v44, v49
    v_exp_f32 v52, v138
    v_add_f32 v44, v44, v50
    v_exp_f32 v53, v139
    v_cvt_pk_bf16_f32 v114, v50, v51
    v_add_f32 v44, v44, v51
    v_exp_f32 v46, v132
    v_add_f32 v44, v44, v52
    v_exp_f32 v47, v133
    v_cvt_pk_bf16_f32 v115, v52, v53
    v_add_f32 v44, v44, v53
    v_exp_f32 v48, v134
    v_add_f32 v45, v46, v47
    v_exp_f32 v49, v135
    v_cvt_pk_bf16_f32 v116, v46, v47
    v_exp_f32 v50, v140
    v_add_f32 v45, v45, v48
    v_exp_f32 v51, v141
    v_cvt_pk_bf16_f32 v117, v48, v49
    v_add_f32 v45, v45, v49
    v_exp_f32 v52, v142
    v_add_f32 v45, v45, v50
    v_exp_f32 v53, v143
    v_cvt_pk_bf16_f32 v118, v50, v51
    v_add_f32 v45, v45, v51
    s_nop 0
    v_add_f32 v45, v45, v52
    v_cvt_pk_bf16_f32 v119, v52, v53
    v_add_f32 v45, v45, v53
    s_nop 1
    s_branch ka_kernel_ret_44
ka_kernel_mask_46:
    s_lshl_b32 s37, s51, 5
    v_subrev_u32 v10, s37, v7
    v_subrev_u32 v9, s37, v0
    v_cmp_le_i32 s[56:57], 0, v10
    v_cmp_le_i32 s[58:59], 1, v10
    v_cmp_le_i32 s[60:61], 2, v10
    v_cmp_le_i32 s[62:63], 3, v10
    v_cndmask_b32 v144, v8, v144, s[56:57]
    v_cndmask_b32 v145, v8, v145, s[58:59]
    v_cndmask_b32 v146, v8, v146, s[60:61]
    v_cndmask_b32 v147, v8, v147, s[62:63]
    v_cmp_le_i32 s[56:57], 0, v9
    v_cmp_le_i32 s[58:59], 1, v9
    v_cmp_le_i32 s[60:61], 2, v9
    v_cmp_le_i32 s[62:63], 3, v9
    v_cndmask_b32 v148, v8, v148, s[56:57]
    v_cndmask_b32 v149, v8, v149, s[58:59]
    v_cndmask_b32 v150, v8, v150, s[60:61]
    v_cndmask_b32 v151, v8, v151, s[62:63]
    v_cmp_le_i32 s[56:57], 16, v10
    v_cmp_le_i32 s[58:59], 17, v10
    v_cmp_le_i32 s[60:61], 18, v10
    v_cmp_le_i32 s[62:63], 19, v10
    v_cndmask_b32 v152, v8, v152, s[56:57]
    v_cndmask_b32 v153, v8, v153, s[58:59]
    v_cndmask_b32 v154, v8, v154, s[60:61]
    v_cndmask_b32 v155, v8, v155, s[62:63]
    v_cmp_le_i32 s[56:57], 16, v9
    v_cmp_le_i32 s[58:59], 17, v9
    v_cmp_le_i32 s[60:61], 18, v9
    v_cmp_le_i32 s[62:63], 19, v9
    v_cndmask_b32 v156, v8, v156, s[56:57]
    v_cndmask_b32 v157, v8, v157, s[58:59]
    v_cndmask_b32 v158, v8, v158, s[60:61]
    v_cndmask_b32 v159, v8, v159, s[62:63]
    s_branch ka_kernel_mret_47
ka_kernel_rare_48:
    s_nop 7
    v_max3_f32 v19, v144, v145, v146
    v_max3_f32 v19, v19, v147, v152
    v_max3_f32 v19, v19, v153, v154
    v_max3_f32 v19, v19, v155, 0
    v_mov_b32 v23, v19
    s_nop 1
    v_permlane16_swap_b32 v19, v23
    v_max_f32 v19, v19, v23
    v_mov_b32 v23, v19
    s_nop 1
    v_permlane32_swap_b32 v19, v23
    v_max_f32 v19, v19, v23
    v_sub_f32 v21, 0, v19
    v_exp_f32 v21, v21
    v_sub_f32 v144, v144, v19
    v_sub_f32 v145, v145, v19
    v_sub_f32 v146, v146, v19
    v_sub_f32 v147, v147, v19
    v_sub_f32 v152, v152, v19
    v_sub_f32 v153, v153, v19
    v_sub_f32 v154, v154, v19
    v_sub_f32 v155, v155, v19
    v_sub_f32 v104, v104, v19
    v_sub_f32 v105, v105, v19
    v_sub_f32 v106, v106, v19
    v_sub_f32 v107, v107, v19
    v_add_f32 v42, v42, v19
    v_mul_f32 v40, v40, v21
    v_mul_f32 v192, v192, v21
    v_mul_f32 v193, v193, v21
    v_mul_f32 v194, v194, v21
    v_mul_f32 v195, v195, v21
    v_mul_f32 v200, v200, v21
    v_mul_f32 v201, v201, v21
    v_mul_f32 v202, v202, v21
    v_mul_f32 v203, v203, v21
    v_mul_f32 v208, v208, v21
    v_mul_f32 v209, v209, v21
    v_mul_f32 v210, v210, v21
    v_mul_f32 v211, v211, v21
    v_mul_f32 v216, v216, v21
    v_mul_f32 v217, v217, v21
    v_mul_f32 v218, v218, v21
    v_mul_f32 v219, v219, v21
    v_mul_f32 v224, v224, v21
    v_mul_f32 v225, v225, v21
    v_mul_f32 v226, v226, v21
    v_mul_f32 v227, v227, v21
    v_mul_f32 v232, v232, v21
    v_mul_f32 v233, v233, v21
    v_mul_f32 v234, v234, v21
    v_mul_f32 v235, v235, v21
    v_mul_f32 v240, v240, v21
    v_mul_f32 v241, v241, v21
    v_mul_f32 v242, v242, v21
    v_mul_f32 v243, v243, v21
    v_mul_f32 v248, v248, v21
    v_mul_f32 v249, v249, v21
    v_mul_f32 v250, v250, v21
    v_mul_f32 v251, v251, v21
    v_max3_f32 v20, v148, v149, v150
    v_max3_f32 v20, v20, v151, v156
    v_max3_f32 v20, v20, v157, v158
    v_max3_f32 v20, v20, v159, 0
    v_mov_b32 v23, v20
    s_nop 1
    v_permlane16_swap_b32 v20, v23
    v_max_f32 v20, v20, v23
    v_mov_b32 v23, v20
    s_nop 1
    v_permlane32_swap_b32 v20, v23
    v_max_f32 v20, v20, v23
    v_sub_f32 v22, 0, v20
    v_exp_f32 v22, v22
    v_sub_f32 v148, v148, v20
    v_sub_f32 v149, v149, v20
    v_sub_f32 v150, v150, v20
    v_sub_f32 v151, v151, v20
    v_sub_f32 v156, v156, v20
    v_sub_f32 v157, v157, v20
    v_sub_f32 v158, v158, v20
    v_sub_f32 v159, v159, v20
    v_sub_f32 v108, v108, v20
    v_sub_f32 v109, v109, v20
    v_sub_f32 v110, v110, v20
    v_sub_f32 v111, v111, v20
    v_add_f32 v43, v43, v20
    v_mul_f32 v41, v41, v22
    v_mul_f32 v196, v196, v22
    v_mul_f32 v197, v197, v22
    v_mul_f32 v198, v198, v22
    v_mul_f32 v199, v199, v22
    v_mul_f32 v204, v204, v22
    v_mul_f32 v205, v205, v22
    v_mul_f32 v206, v206, v22
    v_mul_f32 v207, v207, v22
    v_mul_f32 v212, v212, v22
    v_mul_f32 v213, v213, v22
    v_mul_f32 v214, v214, v22
    v_mul_f32 v215, v215, v22
    v_mul_f32 v220, v220, v22
    v_mul_f32 v221, v221, v22
    v_mul_f32 v222, v222, v22
    v_mul_f32 v223, v223, v22
    v_mul_f32 v228, v228, v22
    v_mul_f32 v229, v229, v22
    v_mul_f32 v230, v230, v22
    v_mul_f32 v231, v231, v22
    v_mul_f32 v236, v236, v22
    v_mul_f32 v237, v237, v22
    v_mul_f32 v238, v238, v22
    v_mul_f32 v239, v239, v22
    v_mul_f32 v244, v244, v22
    v_mul_f32 v245, v245, v22
    v_mul_f32 v246, v246, v22
    v_mul_f32 v247, v247, v22
    v_mul_f32 v252, v252, v22
    v_mul_f32 v253, v253, v22
    v_mul_f32 v254, v254, v22
    v_mul_f32 v255, v255, v22
    v_exp_f32 v46, v144
    v_exp_f32 v47, v145
    v_exp_f32 v48, v146
    v_add_f32 v44, v46, v47
    v_exp_f32 v49, v147
    v_cvt_pk_bf16_f32 v120, v46, v47
    v_exp_f32 v50, v152
    v_add_f32 v44, v44, v48
    v_exp_f32 v51, v153
    v_cvt_pk_bf16_f32 v121, v48, v49
    v_add_f32 v44, v44, v49
    v_exp_f32 v52, v154
    v_add_f32 v44, v44, v50
    v_exp_f32 v53, v155
    v_cvt_pk_bf16_f32 v122, v50, v51
    v_add_f32 v44, v44, v51
    v_exp_f32 v46, v148
    v_add_f32 v44, v44, v52
    v_exp_f32 v47, v149
    v_cvt_pk_bf16_f32 v123, v52, v53
    v_add_f32 v44, v44, v53
    v_exp_f32 v48, v150
    v_add_f32 v45, v46, v47
    v_exp_f32 v49, v151
    v_cvt_pk_bf16_f32 v124, v46, v47
    v_exp_f32 v50, v156
    v_add_f32 v45, v45, v48
    v_exp_f32 v51, v157
    v_cvt_pk_bf16_f32 v125, v48, v49
    v_add_f32 v45, v45, v49
    v_exp_f32 v52, v158
    v_add_f32 v45, v45, v50
    v_exp_f32 v53, v159
    v_cvt_pk_bf16_f32 v126, v50, v51
    v_add_f32 v45, v45, v51
    s_nop 0
    v_add_f32 v45, v45, v52
    v_cvt_pk_bf16_f32 v127, v52, v53
    v_add_f32 v45, v45, v53
    s_nop 1
    s_branch ka_kernel_ret_49
ka_kernel_code_end:
    s_endpgm
.section .rodata,"a"
.p2align 6
.amdhsa_kernel concat_heads__ssm_conv_h3__compressed_kv_cla__prompt_kernel
  .amdhsa_next_free_vgpr 256
  .amdhsa_next_free_sgpr 102
  .amdhsa_accum_offset 256
  .amdhsa_group_segment_fixed_size 0
  .amdhsa_kernarg_size 120
  .amdhsa_user_sgpr_count 2
  .amdhsa_user_sgpr_kernarg_segment_ptr 1
  .amdhsa_system_sgpr_workgroup_id_x 1
.end_amdhsa_kernel
```
